```python
import torch

def _softmax(x, axis=-1):
    return torch.softmax(x, dim=axis)
def _gelu(x):
    return torch.nn.functional.gelu(x, approximate="tanh")
def _silu(x):
    return torch.nn.functional.silu(x)
def _sigmoid(x):
    return torch.sigmoid(x)
def _layernorm(x, axis=-1, eps=1e-5):
    m = x.mean(dim=axis, keepdim=True)
    v = x.var(dim=axis, keepdim=True, unbiased=False)
    return (x - m) / torch.sqrt(v + eps)
def _scatter_add(tgt, idx, src, axis=0):
    return tgt.clone().index_add_(axis, idx, src)
def _segment_sum(src, seg, n):
    out = torch.zeros((n,) + src.shape[1:], dtype=src.dtype)
    return out.index_add_(0, seg, src)
def _pad(x, pw):
    flat = tuple(v for pair in reversed(pw) for v in pair)
    return torch.nn.functional.pad(x, flat)

kernel_name = 'interleave_layers__linear_kernel_hedgehog__glu_gated_reglu__prompt'

def setup_inputs():

    _w = (lambda a: (lambda t: t.to(torch.bfloat16) if t.is_floating_point() else t)(torch.as_tensor(a)))
    def _A_setup():
        B, S, D, H = 1, 2048, 640, 32
        Dh = D // H
        return {
            "x": _w((lambda *s: torch.randn(*s, dtype=torch.bfloat16) * 0.05)(B, S, D)),
            "wqkv": _w((lambda *s: torch.randn(*s, dtype=torch.bfloat16) * 0.4)(D, 3 * D)),
            "w_phi": _w((lambda *s: torch.randn(*s, dtype=torch.bfloat16) * 0.4)(H, Dh, Dh) * (Dh ** -0.5)),
            "wo": _w((lambda *s: torch.randn(*s, dtype=torch.bfloat16) * 0.05)(D, D)),
        }
    _A_in = _A_setup()

    def _B_setup():
        B, S, D, F = 1, 2048, 640, 1536
        return {
            "x": _w((lambda *s: torch.randn(*s, dtype=torch.bfloat16) * 0.05)(B, S, D)),
            "W_gate": _w((lambda *s: torch.randn(*s, dtype=torch.bfloat16) * 1.6)(D, F) * (2.0 / D) ** 0.5),
            "W_up": _w((lambda *s: torch.randn(*s, dtype=torch.bfloat16) * 1.6)(D, F) * (2.0 / D) ** 0.5),
            "W_down": _w((lambda *s: torch.randn(*s, dtype=torch.bfloat16) * 1.6)(F, D) * (1.0 / F) ** 0.5),
        }
    _B_in = _B_setup()

    return {
        "A_x": _A_in["x"],
        "A_wqkv": _A_in["wqkv"],
        "A_w_phi": _A_in["w_phi"],
        "A_wo": _A_in["wo"],
        "B_x": _B_in["x"],
        "B_W_gate": _B_in["W_gate"],
        "B_W_up": _B_in["W_up"],
        "B_W_down": _B_in["W_down"],
    }

def reference(A_x, A_wqkv, A_w_phi, A_wo, B_x, B_W_gate, B_W_up, B_W_down):
    def _A_ref(x, wqkv, w_phi, wo):
        B, S, D = x.shape
        H = 32; Dh = D // H
        qkv = (lambda x, *d: x.permute(*d))((x @ wqkv).reshape(B, S, 3, H, Dh), 2, 0, 3, 1, 4)
        q, k, v = qkv[0], qkv[1], qkv[2]
        pq = torch.einsum("bhsd,hdf->bhsf", q, w_phi)
        pk = torch.einsum("bhsd,hdf->bhsf", k, w_phi)
        phi_q = torch.concatenate([_softmax(pq, axis=-1), _softmax(-pq, axis=-1)], axis=-1)
        phi_k = torch.concatenate([_softmax(pk, axis=-1), _softmax(-pk, axis=-1)], axis=-1)
        kv = torch.einsum("bhsf,bhsd->bhfd", phi_k, v)
        z  = torch.einsum("bhsf->bhf", phi_k)
        num = torch.einsum("bhqf,bhfd->bhqd", phi_q, kv)
        den = torch.einsum("bhqf,bhf->bhq", phi_q, z)[..., None] + 1e-6
        o = num / den
        return (lambda x, *d: x.permute(*d))(o, 0, 2, 1, 3).reshape(B, S, D) @ wo

    def _B_ref(x, W_gate, W_up, W_down):
        gate = torch.einsum("bsd,df->bsf", x, W_gate)
        up = torch.einsum("bsd,df->bsf", x, W_up)
        gate = gate * (lambda x, dt: x.to(dt))(gate > 0, gate.dtype)
        h = gate * up
        return torch.einsum("bsf,fd->bsd", h, W_down)

    x = A_x
    x = x + _A_ref(_layernorm(x, axis=-1), A_wqkv, A_w_phi, A_wo)
    x = x + _B_ref(_layernorm(x, axis=-1), B_W_gate, B_W_up, B_W_down)
    x = x + _A_ref(_layernorm(x, axis=-1), A_wqkv, A_w_phi, A_wo)
    x = x + _B_ref(_layernorm(x, axis=-1), B_W_gate, B_W_up, B_W_down)
    return x
```

```asm
; @launch grid=(256,1,1) block=(256,1,1) lds=163840
.amdgcn_target "amdgcn-amd-amdhsa--gfx950"
.text
.globl interleave_layers__linear_kernel_hedgehog__glu_gated_reglu__prompt_kernel
.p2align 8
.type interleave_layers__linear_kernel_hedgehog__glu_gated_reglu__prompt_kernel,@function
interleave_layers__linear_kernel_hedgehog__glu_gated_reglu__prompt_kernel:
	s_cmp_ge_u32 s2, 0x100
	s_cbranch_scc1 M_end
	s_memrealtime s[92:93]
	s_load_dwordx16 s[40:55], s[0:1], 0
	s_load_dwordx4 s[56:59], s[0:1], 64
	s_load_dwordx2 s[62:63], s[0:1], 0x50
	v_and_b32 v1, 63, v0
	v_lshlrev_b32 v2, 4, v1
	v_lshrrev_b32 v9, 6, v0
	v_and_b32 v3, 31, v0
	v_readfirstlane_b32 s20, v9
	v_lshrrev_b32 v4, 5, v1
	v_lshrrev_b32 v5, 3, v3
	v_bfe_u32 v6, v3, 2, 1
	v_and_b32 v7, 3, v3
	v_and_b32 v8, 19, v3
	v_lshl_or_b32 v8, v6, 3, v8
	v_bfe_u32 v9, v3, 3, 1
	v_lshl_or_b32 v8, v9, 2, v8
	s_cmp_ge_u32 s2, 0xfe
	s_cbranch_scc1 PP_fillonly
	s_cmp_ge_u32 s2, 0xd0
	s_cbranch_scc1 PP_w24
	s_cmp_ge_u32 s2, 0x90
	s_cbranch_scc1 PP_x
	s_cmp_ge_u32 s2, 48
	s_cbranch_scc1 PP_w3
	s_waitcnt lgkmcnt(0)
	s_mov_b32 s8, s62
	s_mov_b32 s9, s63
	s_mov_b32 s10, 0x2692000
	s_mov_b32 s11, 0x20000
	s_mov_b32 s84, s58
	s_mov_b32 s85, s59
	s_mov_b32 s86, 0x100
	s_mov_b32 s87, 0x20000
	s_cmp_lg_u32 s2, 0
	s_cbranch_scc1 nononce_1
	v_lshlrev_b32 v10, 8, v0
	s_or_b32 s98, s92, 1
	v_mov_b32 v9, s98
	buffer_store_dword v9, v10, s[84:87], 0 offen sc1
nononce_1:
	s_mov_b32 s12, s42
	s_mov_b32 s13, s43
	s_mov_b32 s14, 0x258000
	s_mov_b32 s15, 0x20000
	s_mov_b32 s16, s44
	s_mov_b32 s17, s45
	s_mov_b32 s18, 0x6400
	s_mov_b32 s19, 0x20000
	s_and_b32 s21, s2, 7
	s_lshl_b32 s21, s21, 1
	s_bfe_u32 s26, s2, 0x10003
	s_add_u32 s21, s21, s26
	s_lshr_b32 s22, s2, 4
	s_add_u32 s26, s22, 1
	s_mul_i32 s26, s26, 0x500
	s_cmp_eq_u32 s22, 2
	s_cselect_b32 s26, 0, s26
	s_mul_i32 s27, s21, 0x50
	s_add_u32 s23, s26, s27
	s_mul_i32 s27, s20, 0x96000
	s_add_u32 s23, s23, s27
	s_mul_i32 s27, s21, 0x640
	v_mov_b32 v12, 0x40000000
	s_mov_b32 m0, 0xf000
	v_cmp_gt_u32 vcc, 50, v1
	s_nop 1
	v_cndmask_b32 v9, v12, v2, vcc
	buffer_load_dwordx4 v9, s[16:19], s27 offen lds
	s_mov_b32 m0, 0xf400
	v_subrev_u32 v10, 0x60, v2
	v_cmp_lt_u32 vcc, 55, v1
	s_nop 1
	v_cndmask_b32 v9, v12, v10, vcc
	buffer_load_dwordx4 v9, s[16:19], s27 offen lds
	s_mov_b32 m0, 0xf800
	v_add_u32 v10, 0x3a0, v2
	v_cmp_gt_u32 vcc, 42, v1
	s_nop 1
	v_cndmask_b32 v9, v12, v10, vcc
	buffer_load_dwordx4 v9, s[16:19], s27 offen lds
	s_mul_i32 s30, s20, 0x3400
	v_add_u32 v9, 0, v1
	v_mul_u32_u24 v10, 0xcd, v9
	v_lshrrev_b32 v10, 10, v10
	v_mul_u32_u24 v11, 5, v10
	v_sub_u32 v11, v9, v11
	v_mul_u32_u24 v10, 0xf00, v10
	v_lshl_add_u32 v13, v11, 4, v10
	s_mov_b32 m0, s30
	s_nop 0
	buffer_load_dwordx4 v13, s[12:15], s23 offen lds
	s_add_u32 s30, s30, 0x400
	v_add_u32 v9, 64, v1
	v_mul_u32_u24 v10, 0xcd, v9
	v_lshrrev_b32 v10, 10, v10
	v_mul_u32_u24 v11, 5, v10
	v_sub_u32 v11, v9, v11
	v_mul_u32_u24 v10, 0xf00, v10
	v_lshl_add_u32 v14, v11, 4, v10
	s_mov_b32 m0, s30
	s_nop 0
	buffer_load_dwordx4 v14, s[12:15], s23 offen lds
	s_add_u32 s30, s30, 0x400
	v_add_u32 v9, 0x80, v1
	v_mul_u32_u24 v10, 0xcd, v9
	v_lshrrev_b32 v10, 10, v10
	v_mul_u32_u24 v11, 5, v10
	v_sub_u32 v11, v9, v11
	v_mul_u32_u24 v10, 0xf00, v10
	v_lshl_add_u32 v15, v11, 4, v10
	s_mov_b32 m0, s30
	s_nop 0
	buffer_load_dwordx4 v15, s[12:15], s23 offen lds
	s_add_u32 s30, s30, 0x400
	v_add_u32 v9, 0xc0, v1
	v_mul_u32_u24 v10, 0xcd, v9
	v_lshrrev_b32 v10, 10, v10
	v_mul_u32_u24 v11, 5, v10
	v_sub_u32 v11, v9, v11
	v_mul_u32_u24 v10, 0xf00, v10
	v_lshl_add_u32 v16, v11, 4, v10
	s_mov_b32 m0, s30
	s_nop 0
	buffer_load_dwordx4 v16, s[12:15], s23 offen lds
	s_add_u32 s30, s30, 0x400
	v_add_u32 v9, 0x100, v1
	v_mul_u32_u24 v10, 0xcd, v9
	v_lshrrev_b32 v10, 10, v10
	v_mul_u32_u24 v11, 5, v10
	v_sub_u32 v11, v9, v11
	v_mul_u32_u24 v10, 0xf00, v10
	v_lshl_add_u32 v17, v11, 4, v10
	s_mov_b32 m0, s30
	s_nop 0
	buffer_load_dwordx4 v17, s[12:15], s23 offen lds
	s_add_u32 s30, s30, 0x400
	s_add_u32 s23, s23, 0x3c000
	s_mov_b32 m0, s30
	s_nop 0
	buffer_load_dwordx4 v13, s[12:15], s23 offen lds
	s_add_u32 s30, s30, 0x400
	s_mov_b32 m0, s30
	s_nop 0
	buffer_load_dwordx4 v14, s[12:15], s23 offen lds
	s_add_u32 s30, s30, 0x400
	s_mov_b32 m0, s30
	s_nop 0
	buffer_load_dwordx4 v15, s[12:15], s23 offen lds
	s_add_u32 s30, s30, 0x400
	s_mov_b32 m0, s30
	s_nop 0
	buffer_load_dwordx4 v16, s[12:15], s23 offen lds
	s_add_u32 s30, s30, 0x400
	s_mov_b32 m0, s30
	s_nop 0
	buffer_load_dwordx4 v17, s[12:15], s23 offen lds
	s_add_u32 s30, s30, 0x400
	s_add_u32 s23, s23, 0x3c000
	s_mov_b32 m0, s30
	s_nop 0
	buffer_load_dwordx4 v13, s[12:15], s23 offen lds
	s_add_u32 s30, s30, 0x400
	s_mov_b32 m0, s30
	s_nop 0
	buffer_load_dwordx4 v14, s[12:15], s23 offen lds
	s_add_u32 s30, s30, 0x400
	s_mov_b32 m0, s30
	s_nop 0
	buffer_load_dwordx4 v15, s[12:15], s23 offen lds
	s_add_u32 s30, s30, 0x400
	s_and_b32 s31, s2, 7
	s_lshl_b32 s31, s31, 1
	s_lshr_b32 s32, s2, 7
	s_add_u32 s31, s31, s32
	s_bfe_u32 s32, s2, 0x40003
	v_mov_b32 v28, -1
	v_mov_b32 v24, 0
	v_mov_b32 v29, -1
	v_mov_b32 v25, 0
	v_mov_b32 v30, -1
	v_mov_b32 v26, 0
	v_mov_b32 v31, -1
	v_mov_b32 v27, 0
	s_lshl_b32 s95, s32, 4
	s_add_u32 s95, s95, s31
	s_mul_i32 s95, s95, 0xd80
	s_add_u32 s95, s95, 0x2468000
	v_lshlrev_b32 v9, 4, v0
	v_cmp_gt_u32 vcc, 0xd8, v0
	v_mov_b32 v10, 0x40000000
	s_nop 0
	v_cndmask_b32 v9, v10, v9, vcc
	buffer_store_dwordx4 v[28:31], v9, s[8:11], s95 offen sc1
	s_add_u32 s95, s95, 0xd8000
	buffer_store_dwordx4 v[28:31], v9, s[8:11], s95 offen sc1
	v_cmp_gt_u32 vcc, 16, v0
	s_nop 1
	v_cndmask_b32 v9, v10, v9, vcc
	s_lshl_b32 s31, s31, 8
	s_lshl_b32 s95, s32, 12
	s_add_u32 s95, s95, s31
	s_add_u32 s95, s95, 0x2618000
	s_cmp_lt_u32 s32, 8
	s_cselect_b32 s95, s95, 0x40000000
	buffer_store_dwordx4 v[24:27], v9, s[8:11], s95 offen sc1
	buffer_load_dword v255, v24, s[84:87], 0 offen sc1
	s_getpc_b64 s[98:99]
pc_2:
	s_lshr_b32 s31, s2, 3
	s_lshl_b32 s31, s31, 11
	v_and_b32 v9, 15, v0
	v_lshl_add_u32 v9, v9, 7, s31
	v_add_u32 v9, PP_done-pc_2, v9
	v_min_u32 v9, M_codeend-pc_2-4, v9
	v_mov_b32 v253, s99
	v_add_co_u32 v252, vcc, s98, v9
	s_nop 1
	v_addc_co_u32 v253, vcc, 0, v253, vcc
	global_load_dword v254, v[252:253], off
	v_mul_u32_u24 v9, 20, v6
	v_lshlrev_b32 v18, 3, v4
	v_sub_u32 v18, v18, v9
	v_lshl_add_u32 v19, v5, 2, v7
	v_add_u32 v20, 16, v19
	s_cmp_eq_u32 s22, 1
	s_cbranch_scc1 PP_w1_v
	s_waitcnt vmcnt(18)
	v_mul_u32_u24 v21, 0x780, v6
	v_lshl_add_u32 v21, v19, 1, v21
	v_mul_i32_i24 v9, 40, v18
	s_mov_b32 s26, 0xf000
	v_add3_u32 v21, v21, v9, s26
	ds_read_u16 v32, v21 offset:0
	ds_read_u16 v33, v21 offset:40
	ds_read_u16 v34, v21 offset:80
	ds_read_u16 v35, v21 offset:120
	ds_read_u16 v36, v21 offset:160
	ds_read_u16 v37, v21 offset:200
	ds_read_u16 v38, v21 offset:240
	ds_read_u16 v39, v21 offset:280
	ds_read_u16 v40, v21 offset:640
	ds_read_u16 v41, v21 offset:680
	ds_read_u16 v42, v21 offset:720
	ds_read_u16 v43, v21 offset:760
	ds_read_u16 v44, v21 offset:800
	ds_read_u16 v45, v21 offset:840
	ds_read_u16 v46, v21 offset:880
	s_waitcnt lgkmcnt(7)
	ds_read_u16 v47, v21 offset:920
	ds_read_u16 v48, v21 offset:1280
	ds_read_u16 v49, v21 offset:1320
	ds_read_u16 v50, v21 offset:1360
	ds_read_u16 v51, v21 offset:1400
	ds_read_u16 v52, v21 offset:1440
	ds_read_u16 v53, v21 offset:1480
	ds_read_u16 v54, v21 offset:1520
	s_waitcnt lgkmcnt(7)
	ds_read_u16 v55, v21 offset:1560
	ds_read_u16 v56, v21 offset:32
	ds_read_u16 v57, v21 offset:72
	ds_read_u16 v58, v21 offset:112
	ds_read_u16 v59, v21 offset:152
	ds_read_u16 v60, v21 offset:192
	ds_read_u16 v61, v21 offset:232
	ds_read_u16 v62, v21 offset:272
	s_waitcnt lgkmcnt(7)
	ds_read_u16 v63, v21 offset:312
	ds_read_u16 v64, v21 offset:672
	ds_read_u16 v65, v21 offset:712
	ds_read_u16 v66, v21 offset:752
	ds_read_u16 v67, v21 offset:792
	ds_read_u16 v68, v21 offset:832
	ds_read_u16 v69, v21 offset:872
	ds_read_u16 v70, v21 offset:912
	s_waitcnt lgkmcnt(7)
	ds_read_u16 v71, v21 offset:952
	ds_read_u16 v72, v21 offset:1312
	ds_read_u16 v73, v21 offset:1352
	ds_read_u16 v74, v21 offset:1392
	ds_read_u16 v75, v21 offset:1432
	ds_read_u16 v76, v21 offset:1472
	ds_read_u16 v77, v21 offset:1512
	ds_read_u16 v78, v21 offset:1552
	s_waitcnt lgkmcnt(7)
	ds_read_u16 v79, v21 offset:1592
	s_waitcnt lgkmcnt(0)
	v_lshl_or_b32 v216, v33, 16, v32
	v_lshl_or_b32 v217, v35, 16, v34
	v_lshl_or_b32 v218, v37, 16, v36
	v_lshl_or_b32 v219, v39, 16, v38
	v_lshl_or_b32 v220, v41, 16, v40
	v_lshl_or_b32 v221, v43, 16, v42
	v_lshl_or_b32 v222, v45, 16, v44
	v_lshl_or_b32 v223, v47, 16, v46
	v_lshl_or_b32 v224, v49, 16, v48
	v_lshl_or_b32 v225, v51, 16, v50
	v_lshl_or_b32 v226, v53, 16, v52
	v_lshl_or_b32 v227, v55, 16, v54
	v_lshl_or_b32 v228, v57, 16, v56
	v_lshl_or_b32 v229, v59, 16, v58
	v_lshl_or_b32 v230, v61, 16, v60
	v_lshl_or_b32 v231, v63, 16, v62
	v_lshl_or_b32 v232, v65, 16, v64
	v_lshl_or_b32 v233, v67, 16, v66
	v_lshl_or_b32 v234, v69, 16, v68
	v_lshl_or_b32 v235, v71, 16, v70
	v_lshl_or_b32 v236, v73, 16, v72
	v_lshl_or_b32 v237, v75, 16, v74
	v_lshl_or_b32 v238, v77, 16, v76
	v_lshl_or_b32 v239, v79, 16, v78
	s_branch PP_w1_go
PP_w1_v:
	v_cmp_gt_u32 vcc, 20, v19
	v_sub_u32 v9, v19, v18
	v_mov_b32 v10, 0xfffffc18
	v_cndmask_b32 v21, v10, v9, vcc
	v_and_b32 v9, 1, v21
	v_lshlrev_b32 v9, 4, v9
	v_mov_b32 v10, 0x3f80
	v_lshlrev_b32 v9, v9, v10
	v_ashrrev_i32 v10, 1, v21
	v_cmp_eq_u32 vcc, 0, v10
	s_nop 1
	v_cndmask_b32 v216, 0, v9, vcc
	v_cmp_eq_u32 vcc, 1, v10
	s_nop 1
	v_cndmask_b32 v217, 0, v9, vcc
	v_cmp_eq_u32 vcc, 2, v10
	s_nop 1
	v_cndmask_b32 v218, 0, v9, vcc
	v_cmp_eq_u32 vcc, 3, v10
	s_nop 1
	v_cndmask_b32 v219, 0, v9, vcc
	v_subrev_u32 v21, 16, v21
	v_and_b32 v9, 1, v21
	v_lshlrev_b32 v9, 4, v9
	v_mov_b32 v10, 0x3f80
	v_lshlrev_b32 v9, v9, v10
	v_ashrrev_i32 v10, 1, v21
	v_cmp_eq_u32 vcc, 0, v10
	s_nop 1
	v_cndmask_b32 v220, 0, v9, vcc
	v_cmp_eq_u32 vcc, 1, v10
	s_nop 1
	v_cndmask_b32 v221, 0, v9, vcc
	v_cmp_eq_u32 vcc, 2, v10
	s_nop 1
	v_cndmask_b32 v222, 0, v9, vcc
	v_cmp_eq_u32 vcc, 3, v10
	s_nop 1
	v_cndmask_b32 v223, 0, v9, vcc
	v_subrev_u32 v21, 16, v21
	v_and_b32 v9, 1, v21
	v_lshlrev_b32 v9, 4, v9
	v_mov_b32 v10, 0x3f80
	v_lshlrev_b32 v9, v9, v10
	v_ashrrev_i32 v10, 1, v21
	v_cmp_eq_u32 vcc, 0, v10
	s_nop 1
	v_cndmask_b32 v224, 0, v9, vcc
	v_cmp_eq_u32 vcc, 1, v10
	s_nop 1
	v_cndmask_b32 v225, 0, v9, vcc
	v_cmp_eq_u32 vcc, 2, v10
	s_nop 1
	v_cndmask_b32 v226, 0, v9, vcc
	v_cmp_eq_u32 vcc, 3, v10
	s_nop 1
	v_cndmask_b32 v227, 0, v9, vcc
	v_cmp_gt_u32 vcc, 20, v20
	v_sub_u32 v9, v20, v18
	v_mov_b32 v10, 0xfffffc18
	v_cndmask_b32 v21, v10, v9, vcc
	v_and_b32 v9, 1, v21
	v_lshlrev_b32 v9, 4, v9
	v_mov_b32 v10, 0x3f80
	v_lshlrev_b32 v9, v9, v10
	v_ashrrev_i32 v10, 1, v21
	v_cmp_eq_u32 vcc, 0, v10
	s_nop 1
	v_cndmask_b32 v228, 0, v9, vcc
	v_cmp_eq_u32 vcc, 1, v10
	s_nop 1
	v_cndmask_b32 v229, 0, v9, vcc
	v_cmp_eq_u32 vcc, 2, v10
	s_nop 1
	v_cndmask_b32 v230, 0, v9, vcc
	v_cmp_eq_u32 vcc, 3, v10
	s_nop 1
	v_cndmask_b32 v231, 0, v9, vcc
	v_subrev_u32 v21, 16, v21
	v_and_b32 v9, 1, v21
	v_lshlrev_b32 v9, 4, v9
	v_mov_b32 v10, 0x3f80
	v_lshlrev_b32 v9, v9, v10
	v_ashrrev_i32 v10, 1, v21
	v_cmp_eq_u32 vcc, 0, v10
	s_nop 1
	v_cndmask_b32 v232, 0, v9, vcc
	v_cmp_eq_u32 vcc, 1, v10
	s_nop 1
	v_cndmask_b32 v233, 0, v9, vcc
	v_cmp_eq_u32 vcc, 2, v10
	s_nop 1
	v_cndmask_b32 v234, 0, v9, vcc
	v_cmp_eq_u32 vcc, 3, v10
	s_nop 1
	v_cndmask_b32 v235, 0, v9, vcc
	v_subrev_u32 v21, 16, v21
	v_and_b32 v9, 1, v21
	v_lshlrev_b32 v9, 4, v9
	v_mov_b32 v10, 0x3f80
	v_lshlrev_b32 v9, v9, v10
	v_ashrrev_i32 v10, 1, v21
	v_cmp_eq_u32 vcc, 0, v10
	s_nop 1
	v_cndmask_b32 v236, 0, v9, vcc
	v_cmp_eq_u32 vcc, 1, v10
	s_nop 1
	v_cndmask_b32 v237, 0, v9, vcc
	v_cmp_eq_u32 vcc, 2, v10
	s_nop 1
	v_cndmask_b32 v238, 0, v9, vcc
	v_cmp_eq_u32 vcc, 3, v10
	s_nop 1
	v_cndmask_b32 v239, 0, v9, vcc
	s_waitcnt vmcnt(18)
PP_w1_go:
	s_mul_i32 s26, s20, 0x3400
	v_mul_u32_u24 v9, 0x50, v8
	v_lshl_add_u32 v9, v4, 4, v9
	v_add_u32 v21, s26, v9
	s_waitcnt vmcnt(15)
	ds_read_b128 v[192:195], v21 offset:0
	ds_read_b128 v[196:199], v21 offset:32
	ds_read_b128 v[200:203], v21 offset:64
	s_waitcnt vmcnt(12)
	ds_read_b128 v[204:207], v21 offset:2560
	ds_read_b128 v[208:211], v21 offset:2592
	ds_read_b128 v[212:215], v21 offset:2624
	s_waitcnt lgkmcnt(5)
	v_mfma_f32_32x32x16_bf16 v[32:47], v[192:195], v[216:219], 0
	v_mfma_f32_32x32x16_bf16 v[112:127], v[192:195], v[228:231], 0
	s_waitcnt lgkmcnt(4)
	v_mfma_f32_32x32x16_bf16 v[32:47], v[196:199], v[220:223], v[32:47]
	v_mfma_f32_32x32x16_bf16 v[112:127], v[196:199], v[232:235], v[112:127]
	s_waitcnt lgkmcnt(3)
	v_mfma_f32_32x32x16_bf16 v[32:47], v[200:203], v[224:227], v[32:47]
	v_mfma_f32_32x32x16_bf16 v[112:127], v[200:203], v[236:239], v[112:127]
	s_waitcnt vmcnt(10)
	ds_read_b128 v[192:195], v21 offset:5120
	ds_read_b128 v[196:199], v21 offset:5152
	ds_read_b128 v[200:203], v21 offset:5184
	s_waitcnt lgkmcnt(5)
	v_mfma_f32_32x32x16_bf16 v[48:63], v[204:207], v[216:219], 0
	v_mfma_f32_32x32x16_bf16 v[128:143], v[204:207], v[228:231], 0
	s_waitcnt lgkmcnt(4)
	v_mfma_f32_32x32x16_bf16 v[48:63], v[208:211], v[220:223], v[48:63]
	v_mfma_f32_32x32x16_bf16 v[128:143], v[208:211], v[232:235], v[128:143]
	s_waitcnt lgkmcnt(3)
	v_mfma_f32_32x32x16_bf16 v[48:63], v[212:215], v[224:227], v[48:63]
	v_mfma_f32_32x32x16_bf16 v[128:143], v[212:215], v[236:239], v[128:143]
	s_waitcnt vmcnt(7)
	ds_read_b128 v[204:207], v21 offset:7680
	ds_read_b128 v[208:211], v21 offset:7712
	ds_read_b128 v[212:215], v21 offset:7744
	s_waitcnt lgkmcnt(5)
	v_mfma_f32_32x32x16_bf16 v[64:79], v[192:195], v[216:219], 0
	v_mfma_f32_32x32x16_bf16 v[144:159], v[192:195], v[228:231], 0
	s_waitcnt lgkmcnt(4)
	v_mfma_f32_32x32x16_bf16 v[64:79], v[196:199], v[220:223], v[64:79]
	v_mfma_f32_32x32x16_bf16 v[144:159], v[196:199], v[232:235], v[144:159]
	s_waitcnt lgkmcnt(3)
	v_mfma_f32_32x32x16_bf16 v[64:79], v[200:203], v[224:227], v[64:79]
	v_mfma_f32_32x32x16_bf16 v[144:159], v[200:203], v[236:239], v[144:159]
	s_waitcnt vmcnt(5)
	ds_read_b128 v[192:195], v21 offset:10240
	ds_read_b128 v[196:199], v21 offset:10272
	ds_read_b128 v[200:203], v21 offset:10304
	s_waitcnt lgkmcnt(5)
	v_mfma_f32_32x32x16_bf16 v[80:95], v[204:207], v[216:219], 0
	v_mfma_f32_32x32x16_bf16 v[160:175], v[204:207], v[228:231], 0
	s_waitcnt lgkmcnt(4)
	v_mfma_f32_32x32x16_bf16 v[80:95], v[208:211], v[220:223], v[80:95]
	v_mfma_f32_32x32x16_bf16 v[160:175], v[208:211], v[232:235], v[160:175]
	s_waitcnt lgkmcnt(3)
	v_mfma_f32_32x32x16_bf16 v[80:95], v[212:215], v[224:227], v[80:95]
	v_mfma_f32_32x32x16_bf16 v[160:175], v[212:215], v[236:239], v[160:175]
	s_waitcnt lgkmcnt(2)
	v_mfma_f32_32x32x16_bf16 v[96:111], v[192:195], v[216:219], 0
	v_mfma_f32_32x32x16_bf16 v[176:191], v[192:195], v[228:231], 0
	s_waitcnt lgkmcnt(1)
	v_mfma_f32_32x32x16_bf16 v[96:111], v[196:199], v[220:223], v[96:111]
	v_mfma_f32_32x32x16_bf16 v[176:191], v[196:199], v[232:235], v[176:191]
	s_waitcnt lgkmcnt(0)
	v_mfma_f32_32x32x16_bf16 v[96:111], v[200:203], v[224:227], v[96:111]
	v_mfma_f32_32x32x16_bf16 v[176:191], v[200:203], v[236:239], v[176:191]
	s_mul_i32 s26, s22, 5
	s_mul_i32 s27, s21, 0x28000
	s_add_u32 s27, s27, 0
	s_mul_i32 s28, s20, 10
	v_add_u32 v9, s26, v5
	v_lshrrev_b32 v10, 2, v9
	v_and_b32 v9, 3, v9
	v_cmp_gt_u32 vcc, 2, v10
	v_mov_b32 v11, 0x800
	v_mov_b32 v12, 0x400
	v_cndmask_b32 v24, v12, v11, vcc
	v_mul_u32_u24 v11, 40, v10
	v_cndmask_b32 v10, v11, v10, vcc
	v_lshlrev_b32 v10, 10, v10
	v_mad_u32_u24 v10, v24, s28, v10
	v_and_b32 v11, 7, v3
	v_lshl_add_u32 v11, v9, 3, v11
	v_lshl_add_u32 v11, v4, 5, v11
	v_lshl_add_u32 v10, v11, 4, v10
	v_add_u32 v22, s27, v10
	v_add_u32 v9, s26, v5
	v_and_b32 v10, 7, v3
	v_lshlrev_b32 v10, 3, v10
	v_lshl_add_u32 v18, v9, 6, v10
	v_add_u32 v10, 0x100, v18
	v_mov_b32 v11, 0x40000000
	v_cmp_eq_u32 vcc, 0, v5
	s_nop 1
	v_cndmask_b32 v19, v11, v10, vcc
	s_lshl_b32 s33, s21, 10
	s_add_u32 s33, s33, 0x262a000
	s_add_u32 s29, s22, 1
	s_mul_i32 s30, s29, 40
	s_cmp_eq_u32 s22, 0
	s_cselect_b32 s30, 1, s30
	s_cselect_b32 s29, 11, 10
	s_lshl_b32 s30, s30, 10
	s_add_u32 s30, s30, s27
	s_lshl_b32 s28, s28, s29
	s_add_u32 s30, s30, s28
	s_lshl_b32 s28, s22, 7
	s_add_u32 s30, s30, s28
	v_lshrrev_b32 v9, 4, v1
	v_lshlrev_b32 v9, s29, v9
	v_and_b32 v10, 7, v1
	v_lshl_add_u32 v9, v10, 4, v9
	v_bfe_u32 v10, v1, 3, 1
	v_lshl_add_u32 v23, v10, 9, v9
	s_mul_i32 s26, s20, 0x3400
	v_and_b32 v9, 7, v3
	v_lshl_add_u32 v9, v4, 3, v9
	v_lshl_add_u32 v9, v9, 4, s26
	v_add_u32 v10, s26, v2
	v_add_u32 v11, 0x1000, v10
	v_cmp_eq_u32 vcc, 0, v5
	s_nop 1
	v_cndmask_b32 v25, v11, v9, vcc
	v_mov_b32 v26, v10
	v_cvt_pk_bf16_f32 v192, v32, v33
	v_cvt_pk_bf16_f32 v193, v34, v35
	v_cvt_pk_bf16_f32 v194, v36, v37
	v_cvt_pk_bf16_f32 v195, v38, v39
	buffer_store_dwordx4 v[192:195], v22, s[8:11], 0 offen sc1
	v_add_u32 v22, v24, v22
	v_cvt_pk_bf16_f32 v196, v40, v41
	v_cvt_pk_bf16_f32 v197, v42, v43
	v_cvt_pk_bf16_f32 v198, v44, v45
	v_cvt_pk_bf16_f32 v199, v46, v47
	buffer_store_dwordx4 v[196:199], v22, s[8:11], 0 offen sc1
	v_add_u32 v22, v24, v22
	v_cvt_pk_bf16_f32 v200, v48, v49
	v_cvt_pk_bf16_f32 v201, v50, v51
	v_cvt_pk_bf16_f32 v202, v52, v53
	v_cvt_pk_bf16_f32 v203, v54, v55
	buffer_store_dwordx4 v[200:203], v22, s[8:11], 0 offen sc1
	v_add_u32 v22, v24, v22
	v_cvt_pk_bf16_f32 v204, v56, v57
	v_cvt_pk_bf16_f32 v205, v58, v59
	v_cvt_pk_bf16_f32 v206, v60, v61
	v_cvt_pk_bf16_f32 v207, v62, v63
	buffer_store_dwordx4 v[204:207], v22, s[8:11], 0 offen sc1
	v_add_u32 v22, v24, v22
	v_cvt_pk_bf16_f32 v208, v64, v65
	v_cvt_pk_bf16_f32 v209, v66, v67
	v_cvt_pk_bf16_f32 v210, v68, v69
	v_cvt_pk_bf16_f32 v211, v70, v71
	buffer_store_dwordx4 v[208:211], v22, s[8:11], 0 offen sc1
	v_add_u32 v22, v24, v22
	v_cvt_pk_bf16_f32 v212, v72, v73
	v_cvt_pk_bf16_f32 v213, v74, v75
	v_cvt_pk_bf16_f32 v214, v76, v77
	v_cvt_pk_bf16_f32 v215, v78, v79
	buffer_store_dwordx4 v[212:215], v22, s[8:11], 0 offen sc1
	v_add_u32 v22, v24, v22
	v_cvt_pk_bf16_f32 v192, v80, v81
	v_cvt_pk_bf16_f32 v193, v82, v83
	v_cvt_pk_bf16_f32 v194, v84, v85
	v_cvt_pk_bf16_f32 v195, v86, v87
	buffer_store_dwordx4 v[192:195], v22, s[8:11], 0 offen sc1
	v_add_u32 v22, v24, v22
	v_cvt_pk_bf16_f32 v196, v88, v89
	v_cvt_pk_bf16_f32 v197, v90, v91
	v_cvt_pk_bf16_f32 v198, v92, v93
	v_cvt_pk_bf16_f32 v199, v94, v95
	buffer_store_dwordx4 v[196:199], v22, s[8:11], 0 offen sc1
	v_add_u32 v22, v24, v22
	v_cvt_pk_bf16_f32 v200, v96, v97
	v_cvt_pk_bf16_f32 v201, v98, v99
	v_cvt_pk_bf16_f32 v202, v100, v101
	v_cvt_pk_bf16_f32 v203, v102, v103
	buffer_store_dwordx4 v[200:203], v22, s[8:11], 0 offen sc1
	v_add_u32 v22, v24, v22
	v_cvt_pk_bf16_f32 v204, v104, v105
	v_cvt_pk_bf16_f32 v205, v106, v107
	v_cvt_pk_bf16_f32 v206, v108, v109
	v_cvt_pk_bf16_f32 v207, v110, v111
	buffer_store_dwordx4 v[204:207], v22, s[8:11], 0 offen sc1
	v_add_u32 v22, v24, v22
	v_cvt_pk_bf16_f32 v208, v112, v113
	v_cvt_pk_bf16_f32 v209, v114, v115
	v_cvt_pk_bf16_f32 v210, v116, v117
	v_cvt_pk_bf16_f32 v211, v118, v119
	ds_write_b128 v25, v[208:211] offset:0
	v_cvt_pk_bf16_f32 v212, v120, v121
	v_cvt_pk_bf16_f32 v213, v122, v123
	v_cvt_pk_bf16_f32 v214, v124, v125
	v_cvt_pk_bf16_f32 v215, v126, v127
	ds_write_b128 v25, v[212:215] offset:256
	v_cvt_pk_bf16_f32 v192, v128, v129
	v_cvt_pk_bf16_f32 v193, v130, v131
	v_cvt_pk_bf16_f32 v194, v132, v133
	v_cvt_pk_bf16_f32 v195, v134, v135
	ds_write_b128 v25, v[192:195] offset:512
	v_cvt_pk_bf16_f32 v196, v136, v137
	v_cvt_pk_bf16_f32 v197, v138, v139
	v_cvt_pk_bf16_f32 v198, v140, v141
	v_cvt_pk_bf16_f32 v199, v142, v143
	ds_write_b128 v25, v[196:199] offset:768
	v_cvt_pk_bf16_f32 v200, v144, v145
	v_cvt_pk_bf16_f32 v201, v146, v147
	v_cvt_pk_bf16_f32 v202, v148, v149
	v_cvt_pk_bf16_f32 v203, v150, v151
	ds_write_b128 v25, v[200:203] offset:1024
	v_cvt_pk_bf16_f32 v204, v152, v153
	v_cvt_pk_bf16_f32 v205, v154, v155
	v_cvt_pk_bf16_f32 v206, v156, v157
	v_cvt_pk_bf16_f32 v207, v158, v159
	ds_write_b128 v25, v[204:207] offset:1280
	v_cvt_pk_bf16_f32 v208, v160, v161
	v_cvt_pk_bf16_f32 v209, v162, v163
	v_cvt_pk_bf16_f32 v210, v164, v165
	v_cvt_pk_bf16_f32 v211, v166, v167
	ds_write_b128 v25, v[208:211] offset:1536
	v_cvt_pk_bf16_f32 v212, v168, v169
	v_cvt_pk_bf16_f32 v213, v170, v171
	v_cvt_pk_bf16_f32 v214, v172, v173
	v_cvt_pk_bf16_f32 v215, v174, v175
	ds_write_b128 v25, v[212:215] offset:1792
	v_cvt_pk_bf16_f32 v192, v176, v177
	v_cvt_pk_bf16_f32 v193, v178, v179
	v_cvt_pk_bf16_f32 v194, v180, v181
	v_cvt_pk_bf16_f32 v195, v182, v183
	ds_write_b128 v25, v[192:195] offset:2048
	v_cvt_pk_bf16_f32 v196, v184, v185
	v_cvt_pk_bf16_f32 v197, v186, v187
	v_cvt_pk_bf16_f32 v198, v188, v189
	v_cvt_pk_bf16_f32 v199, v190, v191
	ds_write_b128 v25, v[196:199] offset:2304
	s_waitcnt lgkmcnt(0)
	ds_read_b128 v[216:219], v26 offset:0
	ds_read_b128 v[220:223], v26 offset:1024
	ds_read_b128 v[224:227], v26 offset:2048
	s_lshl_b32 s28, 4, s29
	s_waitcnt lgkmcnt(2)
	buffer_store_dwordx4 v[216:219], v23, s[8:11], s30 offen sc1
	s_add_u32 s30, s30, s28
	s_waitcnt lgkmcnt(1)
	buffer_store_dwordx4 v[220:223], v23, s[8:11], s30 offen sc1
	s_add_u32 s30, s30, s28
	v_cmp_gt_u32 vcc, 32, v1
	v_mov_b32 v11, 0x40000000
	s_nop 0
	v_cndmask_b32 v23, v11, v23, vcc
	s_waitcnt lgkmcnt(0)
	buffer_store_dwordx4 v[224:227], v23, s[8:11], s30 offen sc1
	s_add_u32 s30, s30, s28
	v_pk_add_f32 v[240:241], v[32:33], v[34:35]
	v_pk_add_f32 v[244:245], v[36:37], v[38:39]
	v_pk_add_f32 v[240:241], v[240:241], v[40:41]
	v_pk_add_f32 v[244:245], v[244:245], v[42:43]
	v_pk_add_f32 v[240:241], v[240:241], v[44:45]
	v_pk_add_f32 v[244:245], v[244:245], v[46:47]
	v_pk_add_f32 v[240:241], v[240:241], v[48:49]
	v_pk_add_f32 v[244:245], v[244:245], v[50:51]
	v_pk_add_f32 v[240:241], v[240:241], v[52:53]
	v_pk_add_f32 v[244:245], v[244:245], v[54:55]
	v_pk_add_f32 v[240:241], v[240:241], v[56:57]
	v_pk_add_f32 v[244:245], v[244:245], v[58:59]
	v_pk_add_f32 v[240:241], v[240:241], v[60:61]
	v_pk_add_f32 v[244:245], v[244:245], v[62:63]
	v_pk_add_f32 v[240:241], v[240:241], v[64:65]
	v_pk_add_f32 v[244:245], v[244:245], v[66:67]
	v_pk_add_f32 v[240:241], v[240:241], v[68:69]
	v_pk_add_f32 v[244:245], v[244:245], v[70:71]
	v_pk_add_f32 v[240:241], v[240:241], v[72:73]
	v_pk_add_f32 v[244:245], v[244:245], v[74:75]
	v_pk_add_f32 v[240:241], v[240:241], v[76:77]
	v_pk_add_f32 v[244:245], v[244:245], v[78:79]
	v_pk_add_f32 v[240:241], v[240:241], v[80:81]
	v_pk_add_f32 v[244:245], v[244:245], v[82:83]
	v_pk_add_f32 v[240:241], v[240:241], v[84:85]
	v_pk_add_f32 v[244:245], v[244:245], v[86:87]
	v_pk_add_f32 v[240:241], v[240:241], v[88:89]
	v_pk_add_f32 v[244:245], v[244:245], v[90:91]
	v_pk_add_f32 v[240:241], v[240:241], v[92:93]
	v_pk_add_f32 v[244:245], v[244:245], v[94:95]
	v_pk_add_f32 v[240:241], v[240:241], v[96:97]
	v_pk_add_f32 v[244:245], v[244:245], v[98:99]
	v_pk_add_f32 v[240:241], v[240:241], v[100:101]
	v_pk_add_f32 v[244:245], v[244:245], v[102:103]
	v_pk_add_f32 v[240:241], v[240:241], v[104:105]
	v_pk_add_f32 v[244:245], v[244:245], v[106:107]
	v_pk_add_f32 v[240:241], v[240:241], v[108:109]
	v_pk_add_f32 v[244:245], v[244:245], v[110:111]
	v_pk_add_f32 v[240:241], v[240:241], v[244:245]
	v_add_f32 v240, v240, v241
	v_mov_b32 v241, v240
	s_nop 1
	v_permlane32_swap_b32 v240, v241
	v_add_f32 v240, v240, v241
	v_pk_add_f32 v[242:243], v[112:113], v[114:115]
	v_pk_add_f32 v[244:245], v[116:117], v[118:119]
	v_pk_add_f32 v[242:243], v[242:243], v[120:121]
	v_pk_add_f32 v[244:245], v[244:245], v[122:123]
	v_pk_add_f32 v[242:243], v[242:243], v[124:125]
	v_pk_add_f32 v[244:245], v[244:245], v[126:127]
	v_pk_add_f32 v[242:243], v[242:243], v[128:129]
	v_pk_add_f32 v[244:245], v[244:245], v[130:131]
	v_pk_add_f32 v[242:243], v[242:243], v[132:133]
	v_pk_add_f32 v[244:245], v[244:245], v[134:135]
	v_pk_add_f32 v[242:243], v[242:243], v[136:137]
	v_pk_add_f32 v[244:245], v[244:245], v[138:139]
	v_pk_add_f32 v[242:243], v[242:243], v[140:141]
	v_pk_add_f32 v[244:245], v[244:245], v[142:143]
	v_pk_add_f32 v[242:243], v[242:243], v[144:145]
	v_pk_add_f32 v[244:245], v[244:245], v[146:147]
	v_pk_add_f32 v[242:243], v[242:243], v[148:149]
	v_pk_add_f32 v[244:245], v[244:245], v[150:151]
	v_pk_add_f32 v[242:243], v[242:243], v[152:153]
	v_pk_add_f32 v[244:245], v[244:245], v[154:155]
	v_pk_add_f32 v[242:243], v[242:243], v[156:157]
	v_pk_add_f32 v[244:245], v[244:245], v[158:159]
	v_pk_add_f32 v[242:243], v[242:243], v[160:161]
	v_pk_add_f32 v[244:245], v[244:245], v[162:163]
	v_pk_add_f32 v[242:243], v[242:243], v[164:165]
	v_pk_add_f32 v[244:245], v[244:245], v[166:167]
	v_pk_add_f32 v[242:243], v[242:243], v[168:169]
	v_pk_add_f32 v[244:245], v[244:245], v[170:171]
	v_pk_add_f32 v[242:243], v[242:243], v[172:173]
	v_pk_add_f32 v[244:245], v[244:245], v[174:175]
	v_pk_add_f32 v[242:243], v[242:243], v[176:177]
	v_pk_add_f32 v[244:245], v[244:245], v[178:179]
	v_pk_add_f32 v[242:243], v[242:243], v[180:181]
	v_pk_add_f32 v[244:245], v[244:245], v[182:183]
	v_pk_add_f32 v[242:243], v[242:243], v[184:185]
	v_pk_add_f32 v[244:245], v[244:245], v[186:187]
	v_pk_add_f32 v[242:243], v[242:243], v[188:189]
	v_pk_add_f32 v[244:245], v[244:245], v[190:191]
	v_pk_add_f32 v[242:243], v[242:243], v[244:245]
	v_add_f32 v242, v242, v243
	v_mov_b32 v243, v242
	s_nop 1
	v_permlane32_swap_b32 v242, v243
	v_add_f32 v242, v242, v243
	s_lshl_b32 s26, s20, 7
	s_add_u32 s26, s26, 0x10000
	v_lshl_add_u32 v11, v3, 2, s26
	ds_write_b32 v11, v240 offset:0
	ds_write_b32 v11, v242 offset:512
	s_waitcnt lgkmcnt(0)
	s_barrier
	s_and_b32 s26, s20, 1
	s_lshl_b32 s26, s26, 9
	s_add_u32 s26, s26, 0x10000
	v_lshl_add_u32 v11, v3, 2, s26
	ds_read_b32 v244, v11 offset:0
	ds_read_b32 v245, v11 offset:128
	ds_read_b32 v246, v11 offset:256
	ds_read_b32 v247, v11 offset:384
	s_cmp_eq_u32 s20, 1
	s_cselect_b64 vcc, -1, 0
	v_cndmask_b32 v18, v18, v19, vcc
	v_mov_b32 v12, 0x40000000
	v_cmp_eq_u32 vcc, 0, v4
	s_nop 1
	v_cndmask_b32 v18, v12, v18, vcc
	s_cmp_lt_u32 s20, 2
	s_cselect_b32 s33, s33, 0x40000000
	s_waitcnt lgkmcnt(0)
	v_add_f32 v9, v244, v245
	v_add_f32 v10, v246, v247
	v_add_f32 v9, v9, v10
	v_cvt_pk_bf16_f32 v244, v9, v9
	v_lshlrev_b32 v10, 16, v244
	v_sub_f32 v10, v9, v10
	v_cvt_pk_bf16_f32 v245, v10, 0
	buffer_store_dwordx2 v[244:245], v18, s[8:11], s33 offen sc1
	s_branch PP_done
PP_w3:
	s_waitcnt lgkmcnt(0)
	s_mov_b32 s8, s62
	s_mov_b32 s9, s63
	s_mov_b32 s10, 0x2692000
	s_mov_b32 s11, 0x20000
	s_mov_b32 s84, s58
	s_mov_b32 s85, s59
	s_mov_b32 s86, 0x100
	s_mov_b32 s87, 0x20000
	s_cmp_lg_u32 s2, 0
	s_cbranch_scc1 nononce_3
	v_lshlrev_b32 v10, 8, v0
	s_or_b32 s98, s92, 1
	v_mov_b32 v9, s98
	buffer_store_dword v9, v10, s[84:87], 0 offen sc1
nononce_3:
	s_mov_b32 s16, s42
	s_mov_b32 s17, s43
	s_mov_b32 s18, 0x258000
	s_mov_b32 s19, 0x20000
	s_sub_u32 s26, s2, 48
	s_lshr_b32 s26, s26, 3
	s_add_u32 s26, s26, 0
	s_lshl_b32 s26, s26, 8
	v_add_u32 v9, s26, v0
	v_mul_u32_u24 v10, 0x2aab, v9
	v_lshrrev_b32 v10, 16, v10
	v_mul_u32_u24 v11, 6, v10
	v_sub_u32 v11, v9, v11
	v_lshrrev_b32 v12, 1, v11
	v_mul_u32_u24 v12, 0x500, v12
	v_and_b32 v11, 1, v11
	v_lshl_add_u32 v12, v11, 7, v12
	s_mov_b32 s27, 0xf00
	v_mad_u32_u24 v12, v10, s27, v12
	s_and_b32 s26, s2, 7
	s_mul_i32 s26, s26, 0xa0
	s_andn2_b32 s26, s26, 0x7f
	buffer_load_dword v254, v12, s[16:19], s26 offen
	s_sub_u32 s26, s2, 48
	s_lshr_b32 s27, s26, 4
	s_lshl_b32 s27, s27, 3
	s_and_b32 s28, s26, 7
	s_add_u32 s27, s27, s28
	s_cmp_ge_u32 s27, 24
	s_cselect_b32 s12, s52, s50
	s_cselect_b32 s13, s53, s51
	s_cselect_b32 s28, 1, 0
	s_cselect_b32 s29, 24, 0
	s_mov_b32 s14, 0x1e0000
	s_mov_b32 s15, 0x20000
	s_sub_u32 s27, s27, s29
	s_lshl_b32 s27, s27, 1
	s_bfe_u32 s26, s26, 0x10003
	s_add_u32 s27, s27, s26
	s_mul_i32 s21, s27, 43
	s_lshr_b32 s21, s21, 7
	s_mul_i32 s26, s21, 3
	s_sub_u32 s22, s27, s26
	s_lshl_b32 s23, s27, 6
	s_mul_i32 s26, s20, 0x78000
	s_add_u32 s23, s23, s26
	v_lshrrev_b32 v9, 2, v1
	v_mul_u32_u24 v9, 0xc00, v9
	v_lshrrev_b32 v10, 4, v1
	v_xor_b32 v10, v10, v1
	v_and_b32 v10, 3, v10
	v_lshl_add_u32 v13, v10, 4, v9
	s_mul_i32 s30, s20, 0x2800
	s_mov_b32 m0, s30
	s_nop 0
	buffer_load_dwordx4 v13, s[12:15], s23 offen nt lds
	s_add_u32 s30, s30, 0x400
	s_add_u32 s23, s23, 0xc000
	s_mov_b32 m0, s30
	s_nop 0
	buffer_load_dwordx4 v13, s[12:15], s23 offen nt lds
	s_add_u32 s30, s30, 0x400
	s_add_u32 s23, s23, 0xc000
	s_mov_b32 m0, s30
	s_nop 0
	buffer_load_dwordx4 v13, s[12:15], s23 offen nt lds
	s_add_u32 s30, s30, 0x400
	s_add_u32 s23, s23, 0xc000
	s_mov_b32 m0, s30
	s_nop 0
	buffer_load_dwordx4 v13, s[12:15], s23 offen nt lds
	s_add_u32 s30, s30, 0x400
	s_add_u32 s23, s23, 0xc000
	s_mov_b32 m0, s30
	s_nop 0
	buffer_load_dwordx4 v13, s[12:15], s23 offen nt lds
	s_add_u32 s30, s30, 0x400
	s_add_u32 s23, s23, 0xc000
	s_mov_b32 m0, s30
	s_nop 0
	buffer_load_dwordx4 v13, s[12:15], s23 offen nt lds
	s_add_u32 s30, s30, 0x400
	s_add_u32 s23, s23, 0xc000
	s_mov_b32 m0, s30
	s_nop 0
	buffer_load_dwordx4 v13, s[12:15], s23 offen nt lds
	s_add_u32 s30, s30, 0x400
	s_add_u32 s23, s23, 0xc000
	s_mov_b32 m0, s30
	s_nop 0
	buffer_load_dwordx4 v13, s[12:15], s23 offen nt lds
	s_add_u32 s30, s30, 0x400
	s_add_u32 s23, s23, 0xc000
	s_mov_b32 m0, s30
	s_nop 0
	buffer_load_dwordx4 v13, s[12:15], s23 offen nt lds
	s_add_u32 s30, s30, 0x400
	s_add_u32 s23, s23, 0xc000
	s_mov_b32 m0, s30
	s_nop 0
	buffer_load_dwordx4 v13, s[12:15], s23 offen nt lds
	s_add_u32 s30, s30, 0x400
	s_add_u32 s23, s23, 0xc000
	s_and_b32 s31, s2, 7
	s_lshl_b32 s31, s31, 1
	s_lshr_b32 s32, s2, 7
	s_add_u32 s31, s31, s32
	s_bfe_u32 s32, s2, 0x40003
	v_mov_b32 v28, -1
	v_mov_b32 v24, 0
	v_mov_b32 v29, -1
	v_mov_b32 v25, 0
	v_mov_b32 v30, -1
	v_mov_b32 v26, 0
	v_mov_b32 v31, -1
	v_mov_b32 v27, 0
	s_lshl_b32 s95, s32, 4
	s_add_u32 s95, s95, s31
	s_mul_i32 s95, s95, 0xd80
	s_add_u32 s95, s95, 0x2468000
	v_lshlrev_b32 v9, 4, v0
	v_cmp_gt_u32 vcc, 0xd8, v0
	v_mov_b32 v10, 0x40000000
	s_nop 0
	v_cndmask_b32 v9, v10, v9, vcc
	buffer_store_dwordx4 v[28:31], v9, s[8:11], s95 offen sc1
	s_add_u32 s95, s95, 0xd8000
	buffer_store_dwordx4 v[28:31], v9, s[8:11], s95 offen sc1
	v_cmp_gt_u32 vcc, 16, v0
	s_nop 1
	v_cndmask_b32 v9, v10, v9, vcc
	s_lshl_b32 s31, s31, 8
	s_lshl_b32 s95, s32, 12
	s_add_u32 s95, s95, s31
	s_add_u32 s95, s95, 0x2618000
	s_cmp_lt_u32 s32, 8
	s_cselect_b32 s95, s95, 0x40000000
	buffer_store_dwordx4 v[24:27], v9, s[8:11], s95 offen sc1
	buffer_load_dword v255, v24, s[84:87], 0 offen sc1
	s_getpc_b64 s[98:99]
pc_4:
	s_lshr_b32 s31, s2, 3
	s_lshl_b32 s31, s31, 11
	v_and_b32 v9, 15, v0
	v_lshl_add_u32 v9, v9, 7, s31
	v_add_u32 v9, PP_done-pc_4, v9
	v_min_u32 v9, M_codeend-pc_4-4, v9
	v_mov_b32 v253, s99
	v_add_co_u32 v252, vcc, s98, v9
	s_nop 1
	v_addc_co_u32 v253, vcc, 0, v253, vcc
	global_load_dword v254, v[252:253], off
	v_lshlrev_b32 v11, 3, v4
	v_sub_u32 v18, v8, v11
	v_and_b32 v9, 1, v18
	v_lshlrev_b32 v9, 4, v9
	v_mov_b32 v10, 0x3f80
	v_lshlrev_b32 v9, v9, v10
	v_ashrrev_i32 v10, 1, v18
	v_cmp_eq_u32 vcc, 0, v10
	s_nop 1
	v_cndmask_b32 v216, 0, v9, vcc
	v_cmp_eq_u32 vcc, 1, v10
	s_nop 1
	v_cndmask_b32 v217, 0, v9, vcc
	v_cmp_eq_u32 vcc, 2, v10
	s_nop 1
	v_cndmask_b32 v218, 0, v9, vcc
	v_cmp_eq_u32 vcc, 3, v10
	s_nop 1
	v_cndmask_b32 v219, 0, v9, vcc
	v_subrev_u32 v18, 16, v18
	v_and_b32 v9, 1, v18
	v_lshlrev_b32 v9, 4, v9
	v_mov_b32 v10, 0x3f80
	v_lshlrev_b32 v9, v9, v10
	v_ashrrev_i32 v10, 1, v18
	v_cmp_eq_u32 vcc, 0, v10
	s_nop 1
	v_cndmask_b32 v220, 0, v9, vcc
	v_cmp_eq_u32 vcc, 1, v10
	s_nop 1
	v_cndmask_b32 v221, 0, v9, vcc
	v_cmp_eq_u32 vcc, 2, v10
	s_nop 1
	v_cndmask_b32 v222, 0, v9, vcc
	v_cmp_eq_u32 vcc, 3, v10
	s_nop 1
	v_cndmask_b32 v223, 0, v9, vcc
	s_mul_i32 s26, s20, 0x2800
	v_bfe_u32 v9, v8, 2, 2
	v_xor_b32 v9, v9, v4
	v_lshlrev_b32 v9, 4, v9
	v_lshl_add_u32 v9, v8, 6, v9
	v_add_u32 v19, s26, v9
	v_xor_b32 v20, 32, v19
	s_waitcnt vmcnt(13)
	ds_read_b128 v[192:195], v19 offset:0
	ds_read_b128 v[196:199], v20 offset:0
	s_waitcnt lgkmcnt(1)
	v_mfma_f32_32x32x16_bf16 v[32:47], v[192:195], v[216:219], 0
	s_waitcnt lgkmcnt(0)
	v_mfma_f32_32x32x16_bf16 v[32:47], v[196:199], v[220:223], v[32:47]
	s_waitcnt vmcnt(11)
	ds_read_b128 v[200:203], v19 offset:2048
	ds_read_b128 v[204:207], v20 offset:2048
	s_waitcnt lgkmcnt(1)
	v_mfma_f32_32x32x16_bf16 v[48:63], v[200:203], v[216:219], 0
	s_waitcnt lgkmcnt(0)
	v_mfma_f32_32x32x16_bf16 v[48:63], v[204:207], v[220:223], v[48:63]
	s_waitcnt vmcnt(9)
	ds_read_b128 v[208:211], v19 offset:4096
	ds_read_b128 v[212:215], v20 offset:4096
	s_waitcnt lgkmcnt(1)
	v_mfma_f32_32x32x16_bf16 v[64:79], v[208:211], v[216:219], 0
	s_waitcnt lgkmcnt(0)
	v_mfma_f32_32x32x16_bf16 v[64:79], v[212:215], v[220:223], v[64:79]
	s_waitcnt vmcnt(7)
	ds_read_b128 v[192:195], v19 offset:6144
	ds_read_b128 v[196:199], v20 offset:6144
	s_waitcnt lgkmcnt(1)
	v_mfma_f32_32x32x16_bf16 v[80:95], v[192:195], v[216:219], 0
	s_waitcnt lgkmcnt(0)
	v_mfma_f32_32x32x16_bf16 v[80:95], v[196:199], v[220:223], v[80:95]
	s_waitcnt vmcnt(5)
	ds_read_b128 v[200:203], v19 offset:8192
	ds_read_b128 v[204:207], v20 offset:8192
	s_waitcnt lgkmcnt(1)
	v_mfma_f32_32x32x16_bf16 v[96:111], v[200:203], v[216:219], 0
	s_waitcnt lgkmcnt(0)
	v_mfma_f32_32x32x16_bf16 v[96:111], v[204:207], v[220:223], v[96:111]
	s_mul_i32 s24, s22, 0x50
	s_add_u32 s24, s24, s28
	s_mul_i32 s26, s20, 20
	s_add_u32 s24, s24, s26
	s_lshl_b32 s24, s24, 10
	s_mul_i32 s26, s21, 0x3c000
	s_add_u32 s24, s24, s26
	s_add_u32 s24, s24, 0x348000
	v_add_u32 v22, s24, v2
	s_lshl_b32 s33, s22, 1
	s_add_u32 s33, s33, s28
	s_lshl_b32 s33, s33, 8
	s_mul_i32 s26, s21, 0x600
	s_add_u32 s33, s33, s26
	s_add_u32 s33, s33, 0x263a000
	v_lshlrev_b32 v18, 3, v3
	v_cvt_pk_bf16_f32 v192, v32, v33
	v_cvt_pk_bf16_f32 v193, v34, v35
	v_cvt_pk_bf16_f32 v194, v36, v37
	v_cvt_pk_bf16_f32 v195, v38, v39
	buffer_store_dwordx4 v[192:195], v22, s[8:11], 0 offen sc1
	v_add_u32 v22, 0x800, v22
	v_cvt_pk_bf16_f32 v196, v40, v41
	v_cvt_pk_bf16_f32 v197, v42, v43
	v_cvt_pk_bf16_f32 v198, v44, v45
	v_cvt_pk_bf16_f32 v199, v46, v47
	buffer_store_dwordx4 v[196:199], v22, s[8:11], 0 offen sc1
	v_add_u32 v22, 0x800, v22
	v_cvt_pk_bf16_f32 v200, v48, v49
	v_cvt_pk_bf16_f32 v201, v50, v51
	v_cvt_pk_bf16_f32 v202, v52, v53
	v_cvt_pk_bf16_f32 v203, v54, v55
	buffer_store_dwordx4 v[200:203], v22, s[8:11], 0 offen sc1
	v_add_u32 v22, 0x800, v22
	v_cvt_pk_bf16_f32 v204, v56, v57
	v_cvt_pk_bf16_f32 v205, v58, v59
	v_cvt_pk_bf16_f32 v206, v60, v61
	v_cvt_pk_bf16_f32 v207, v62, v63
	buffer_store_dwordx4 v[204:207], v22, s[8:11], 0 offen sc1
	v_add_u32 v22, 0x800, v22
	v_cvt_pk_bf16_f32 v208, v64, v65
	v_cvt_pk_bf16_f32 v209, v66, v67
	v_cvt_pk_bf16_f32 v210, v68, v69
	v_cvt_pk_bf16_f32 v211, v70, v71
	buffer_store_dwordx4 v[208:211], v22, s[8:11], 0 offen sc1
	v_add_u32 v22, 0x800, v22
	v_cvt_pk_bf16_f32 v212, v72, v73
	v_cvt_pk_bf16_f32 v213, v74, v75
	v_cvt_pk_bf16_f32 v214, v76, v77
	v_cvt_pk_bf16_f32 v215, v78, v79
	buffer_store_dwordx4 v[212:215], v22, s[8:11], 0 offen sc1
	v_add_u32 v22, 0x800, v22
	v_cvt_pk_bf16_f32 v192, v80, v81
	v_cvt_pk_bf16_f32 v193, v82, v83
	v_cvt_pk_bf16_f32 v194, v84, v85
	v_cvt_pk_bf16_f32 v195, v86, v87
	buffer_store_dwordx4 v[192:195], v22, s[8:11], 0 offen sc1
	v_add_u32 v22, 0x800, v22
	v_cvt_pk_bf16_f32 v196, v88, v89
	v_cvt_pk_bf16_f32 v197, v90, v91
	v_cvt_pk_bf16_f32 v198, v92, v93
	v_cvt_pk_bf16_f32 v199, v94, v95
	buffer_store_dwordx4 v[196:199], v22, s[8:11], 0 offen sc1
	v_add_u32 v22, 0x800, v22
	v_cvt_pk_bf16_f32 v200, v96, v97
	v_cvt_pk_bf16_f32 v201, v98, v99
	v_cvt_pk_bf16_f32 v202, v100, v101
	v_cvt_pk_bf16_f32 v203, v102, v103
	buffer_store_dwordx4 v[200:203], v22, s[8:11], 0 offen sc1
	v_add_u32 v22, 0x800, v22
	v_cvt_pk_bf16_f32 v204, v104, v105
	v_cvt_pk_bf16_f32 v205, v106, v107
	v_cvt_pk_bf16_f32 v206, v108, v109
	v_cvt_pk_bf16_f32 v207, v110, v111
	buffer_store_dwordx4 v[204:207], v22, s[8:11], 0 offen sc1
	v_add_u32 v22, 0x800, v22
	v_pk_add_f32 v[240:241], v[32:33], v[34:35]
	v_pk_add_f32 v[244:245], v[36:37], v[38:39]
	v_pk_add_f32 v[240:241], v[240:241], v[40:41]
	v_pk_add_f32 v[244:245], v[244:245], v[42:43]
	v_pk_add_f32 v[240:241], v[240:241], v[44:45]
	v_pk_add_f32 v[244:245], v[244:245], v[46:47]
	v_pk_add_f32 v[240:241], v[240:241], v[48:49]
	v_pk_add_f32 v[244:245], v[244:245], v[50:51]
	v_pk_add_f32 v[240:241], v[240:241], v[52:53]
	v_pk_add_f32 v[244:245], v[244:245], v[54:55]
	v_pk_add_f32 v[240:241], v[240:241], v[56:57]
	v_pk_add_f32 v[244:245], v[244:245], v[58:59]
	v_pk_add_f32 v[240:241], v[240:241], v[60:61]
	v_pk_add_f32 v[244:245], v[244:245], v[62:63]
	v_pk_add_f32 v[240:241], v[240:241], v[64:65]
	v_pk_add_f32 v[244:245], v[244:245], v[66:67]
	v_pk_add_f32 v[240:241], v[240:241], v[68:69]
	v_pk_add_f32 v[244:245], v[244:245], v[70:71]
	v_pk_add_f32 v[240:241], v[240:241], v[72:73]
	v_pk_add_f32 v[244:245], v[244:245], v[74:75]
	v_pk_add_f32 v[240:241], v[240:241], v[76:77]
	v_pk_add_f32 v[244:245], v[244:245], v[78:79]
	v_pk_add_f32 v[240:241], v[240:241], v[80:81]
	v_pk_add_f32 v[244:245], v[244:245], v[82:83]
	v_pk_add_f32 v[240:241], v[240:241], v[84:85]
	v_pk_add_f32 v[244:245], v[244:245], v[86:87]
	v_pk_add_f32 v[240:241], v[240:241], v[88:89]
	v_pk_add_f32 v[244:245], v[244:245], v[90:91]
	v_pk_add_f32 v[240:241], v[240:241], v[92:93]
	v_pk_add_f32 v[244:245], v[244:245], v[94:95]
	v_pk_add_f32 v[240:241], v[240:241], v[96:97]
	v_pk_add_f32 v[244:245], v[244:245], v[98:99]
	v_pk_add_f32 v[240:241], v[240:241], v[100:101]
	v_pk_add_f32 v[244:245], v[244:245], v[102:103]
	v_pk_add_f32 v[240:241], v[240:241], v[104:105]
	v_pk_add_f32 v[244:245], v[244:245], v[106:107]
	v_pk_add_f32 v[240:241], v[240:241], v[108:109]
	v_pk_add_f32 v[244:245], v[244:245], v[110:111]
	v_pk_add_f32 v[240:241], v[240:241], v[244:245]
	v_add_f32 v240, v240, v241
	v_mov_b32 v241, v240
	s_nop 1
	v_permlane32_swap_b32 v240, v241
	v_add_f32 v240, v240, v241
	s_lshl_b32 s26, s20, 7
	s_add_u32 s26, s26, 0x10000
	v_lshl_add_u32 v11, v3, 2, s26
	ds_write_b32 v11, v240 offset:0
	s_waitcnt lgkmcnt(0)
	s_barrier
	s_and_b32 s26, s20, 0
	s_lshl_b32 s26, s26, 9
	s_add_u32 s26, s26, 0x10000
	v_lshl_add_u32 v11, v3, 2, s26
	ds_read_b32 v244, v11 offset:0
	ds_read_b32 v245, v11 offset:128
	ds_read_b32 v246, v11 offset:256
	ds_read_b32 v247, v11 offset:384
	v_mov_b32 v12, 0x40000000
	v_cmp_eq_u32 vcc, 0, v4
	s_nop 1
	v_cndmask_b32 v18, v12, v18, vcc
	s_cmp_lt_u32 s20, 1
	s_cselect_b32 s33, s33, 0x40000000
	s_waitcnt lgkmcnt(0)
	v_add_f32 v9, v244, v245
	v_add_f32 v10, v246, v247
	v_add_f32 v9, v9, v10
	v_cvt_pk_bf16_f32 v244, v9, v9
	v_lshlrev_b32 v10, 16, v244
	v_sub_f32 v10, v9, v10
	v_cvt_pk_bf16_f32 v245, v10, 0
	buffer_store_dwordx2 v[244:245], v18, s[8:11], s33 offen sc1
	s_branch PP_done
PP_w24:
	s_waitcnt lgkmcnt(0)
	s_mov_b32 s8, s62
	s_mov_b32 s9, s63
	s_mov_b32 s10, 0x2692000
	s_mov_b32 s11, 0x20000
	s_mov_b32 s84, s58
	s_mov_b32 s85, s59
	s_mov_b32 s86, 0x100
	s_mov_b32 s87, 0x20000
	s_cmp_lg_u32 s2, 0
	s_cbranch_scc1 nononce_5
	v_lshlrev_b32 v10, 8, v0
	s_or_b32 s98, s92, 1
	v_mov_b32 v9, s98
	buffer_store_dword v9, v10, s[84:87], 0 offen sc1
nononce_5:
	s_mov_b32 s16, s42
	s_mov_b32 s17, s43
	s_mov_b32 s18, 0x258000
	s_mov_b32 s19, 0x20000
	s_sub_u32 s26, s2, 0xd0
	s_lshr_b32 s26, s26, 3
	s_add_u32 s26, s26, 12
	s_lshl_b32 s26, s26, 8
	v_add_u32 v9, s26, v0
	v_mul_u32_u24 v10, 0x2aab, v9
	v_lshrrev_b32 v10, 16, v10
	v_mul_u32_u24 v11, 6, v10
	v_sub_u32 v11, v9, v11
	v_lshrrev_b32 v12, 1, v11
	v_mul_u32_u24 v12, 0x500, v12
	v_and_b32 v11, 1, v11
	v_lshl_add_u32 v12, v11, 7, v12
	s_mov_b32 s27, 0xf00
	v_mad_u32_u24 v12, v10, s27, v12
	s_and_b32 s26, s2, 7
	s_mul_i32 s26, s26, 0xa0
	s_andn2_b32 s26, s26, 0x7f
	buffer_load_dword v254, v12, s[16:19], s26 offen
	v_add_u32 v9, 0, v1
	v_mul_u32_u24 v10, 0xcd, v9
	v_lshrrev_b32 v32, 11, v10
	v_mul_u32_u24 v11, 10, v32
	v_sub_u32 v11, v9, v11
	v_lshlrev_b32 v37, 4, v11
	v_add_u32 v9, 64, v1
	v_mul_u32_u24 v10, 0xcd, v9
	v_lshrrev_b32 v33, 11, v10
	v_mul_u32_u24 v11, 10, v33
	v_sub_u32 v11, v9, v11
	v_lshlrev_b32 v38, 4, v11
	v_add_u32 v9, 0x80, v1
	v_mul_u32_u24 v10, 0xcd, v9
	v_lshrrev_b32 v34, 11, v10
	v_mul_u32_u24 v11, 10, v34
	v_sub_u32 v11, v9, v11
	v_lshlrev_b32 v39, 4, v11
	v_add_u32 v9, 0xc0, v1
	v_mul_u32_u24 v10, 0xcd, v9
	v_lshrrev_b32 v35, 11, v10
	v_mul_u32_u24 v11, 10, v35
	v_sub_u32 v11, v9, v11
	v_lshlrev_b32 v40, 4, v11
	v_add_u32 v9, 0x100, v1
	v_mul_u32_u24 v10, 0xcd, v9
	v_lshrrev_b32 v36, 11, v10
	v_mul_u32_u24 v11, 10, v36
	v_sub_u32 v11, v9, v11
	v_lshlrev_b32 v41, 4, v11
	s_sub_u32 s21, s2, 0xd0
	s_mul_i32 s21, s21, 12
	s_add_u32 s21, s21, s20
	s_mul_i32 s30, s20, 0x3c00
	s_cmp_ge_u32 s21, 0x180
	s_cbranch_scc1 PP_w2_6
	s_mov_b32 s36, s54
	s_mov_b32 s37, s55
	s_mov_b32 s38, 0x1e0000
	s_mov_b32 s39, 0x20000
	s_lshr_b32 s26, s21, 3
	s_and_b32 s27, s21, 7
	s_mul_i32 s33, s27, 48
	s_add_u32 s33, s33, s26
	s_mul_i32 s33, s33, 0x1400
	s_add_u32 s33, s33, 0x708000
	s_lshl_b32 s26, s26, 5
	v_add_u32 v13, s26, v32
	v_add_u32 v14, s26, v33
	v_add_u32 v15, s26, v34
	v_add_u32 v16, s26, v35
	v_add_u32 v17, s26, v36
	s_branch PP_go_7
PP_w2_6:
	s_mov_b32 s36, s46
	s_mov_b32 s37, s47
	s_mov_b32 s38, 0xc8000
	s_mov_b32 s39, 0x20000
	s_sub_u32 s28, s21, 0x180
	s_lshr_b32 s26, s28, 3
	s_and_b32 s27, s28, 7
	s_mul_i32 s33, s27, 20
	s_add_u32 s33, s33, s26
	s_mul_i32 s33, s33, 0x1400
	s_add_u32 s33, s33, 0x280000
	s_cmp_ge_u32 s21, 0x220
	s_cselect_b32 s33, 0x40000000, s33
	s_lshl_b32 s26, s26, 5
	v_add_u32 v13, s26, v32
	v_mul_u32_u24 v9, 0x667, v13
	v_lshrrev_b32 v9, 16, v9
	v_mul_u32_u24 v9, 40, v9
	v_sub_u32 v10, v13, v9
	v_lshrrev_b32 v11, 4, v10
	v_mul_u32_u24 v11, 20, v11
	v_and_b32 v12, 15, v10
	v_add_u32 v11, v11, v12
	v_bfe_u32 v12, v10, 2, 1
	v_mul_u32_u24 v12, 20, v12
	v_and_b32 v13, 3, v10
	v_add3_u32 v12, v12, v13, 16
	v_cmp_gt_u32 vcc, 32, v10
	s_nop 1
	v_cndmask_b32 v11, v12, v11, vcc
	v_add_u32 v13, v9, v11
	v_add_u32 v14, s26, v33
	v_mul_u32_u24 v9, 0x667, v14
	v_lshrrev_b32 v9, 16, v9
	v_mul_u32_u24 v9, 40, v9
	v_sub_u32 v10, v14, v9
	v_lshrrev_b32 v11, 4, v10
	v_mul_u32_u24 v11, 20, v11
	v_and_b32 v12, 15, v10
	v_add_u32 v11, v11, v12
	v_bfe_u32 v12, v10, 2, 1
	v_mul_u32_u24 v12, 20, v12
	v_and_b32 v14, 3, v10
	v_add3_u32 v12, v12, v14, 16
	v_cmp_gt_u32 vcc, 32, v10
	s_nop 1
	v_cndmask_b32 v11, v12, v11, vcc
	v_add_u32 v14, v9, v11
	v_add_u32 v15, s26, v34
	v_mul_u32_u24 v9, 0x667, v15
	v_lshrrev_b32 v9, 16, v9
	v_mul_u32_u24 v9, 40, v9
	v_sub_u32 v10, v15, v9
	v_lshrrev_b32 v11, 4, v10
	v_mul_u32_u24 v11, 20, v11
	v_and_b32 v12, 15, v10
	v_add_u32 v11, v11, v12
	v_bfe_u32 v12, v10, 2, 1
	v_mul_u32_u24 v12, 20, v12
	v_and_b32 v15, 3, v10
	v_add3_u32 v12, v12, v15, 16
	v_cmp_gt_u32 vcc, 32, v10
	s_nop 1
	v_cndmask_b32 v11, v12, v11, vcc
	v_add_u32 v15, v9, v11
	v_add_u32 v16, s26, v35
	v_mul_u32_u24 v9, 0x667, v16
	v_lshrrev_b32 v9, 16, v9
	v_mul_u32_u24 v9, 40, v9
	v_sub_u32 v10, v16, v9
	v_lshrrev_b32 v11, 4, v10
	v_mul_u32_u24 v11, 20, v11
	v_and_b32 v12, 15, v10
	v_add_u32 v11, v11, v12
	v_bfe_u32 v12, v10, 2, 1
	v_mul_u32_u24 v12, 20, v12
	v_and_b32 v16, 3, v10
	v_add3_u32 v12, v12, v16, 16
	v_cmp_gt_u32 vcc, 32, v10
	s_nop 1
	v_cndmask_b32 v11, v12, v11, vcc
	v_add_u32 v16, v9, v11
	v_add_u32 v17, s26, v36
	v_mul_u32_u24 v9, 0x667, v17
	v_lshrrev_b32 v9, 16, v9
	v_mul_u32_u24 v9, 40, v9
	v_sub_u32 v10, v17, v9
	v_lshrrev_b32 v11, 4, v10
	v_mul_u32_u24 v11, 20, v11
	v_and_b32 v12, 15, v10
	v_add_u32 v11, v11, v12
	v_bfe_u32 v12, v10, 2, 1
	v_mul_u32_u24 v12, 20, v12
	v_and_b32 v17, 3, v10
	v_add3_u32 v12, v12, v17, 16
	v_cmp_gt_u32 vcc, 32, v10
	s_nop 1
	v_cndmask_b32 v11, v12, v11, vcc
	v_add_u32 v17, v9, v11
PP_go_7:
	s_mul_i32 s23, s27, 0xa0
	s_mov_b32 s29, 0x500
	v_mad_u32_u24 v13, v13, s29, v37
	s_mov_b32 m0, s30
	s_nop 0
	buffer_load_dwordx4 v13, s[36:39], s23 offen nt lds
	s_add_u32 s30, s30, 0x400
	s_mov_b32 s29, 0x500
	v_mad_u32_u24 v14, v14, s29, v38
	s_mov_b32 m0, s30
	s_nop 0
	buffer_load_dwordx4 v14, s[36:39], s23 offen nt lds
	s_add_u32 s30, s30, 0x400
	s_mov_b32 s29, 0x500
	v_mad_u32_u24 v15, v15, s29, v39
	s_mov_b32 m0, s30
	s_nop 0
	buffer_load_dwordx4 v15, s[36:39], s23 offen nt lds
	s_add_u32 s30, s30, 0x400
	s_mov_b32 s29, 0x500
	v_mad_u32_u24 v16, v16, s29, v40
	s_mov_b32 m0, s30
	s_nop 0
	buffer_load_dwordx4 v16, s[36:39], s23 offen nt lds
	s_add_u32 s30, s30, 0x400
	s_mov_b32 s29, 0x500
	v_mad_u32_u24 v17, v17, s29, v41
	s_mov_b32 m0, s30
	s_nop 0
	buffer_load_dwordx4 v17, s[36:39], s23 offen nt lds
	s_add_u32 s30, s30, 0x400
	s_add_u32 s21, s21, 4
	s_cmp_ge_u32 s21, 0x180
	s_cbranch_scc1 PP_w2_8
	s_mov_b32 s36, s54
	s_mov_b32 s37, s55
	s_mov_b32 s38, 0x1e0000
	s_mov_b32 s39, 0x20000
	s_lshr_b32 s26, s21, 3
	s_and_b32 s27, s21, 7
	s_mul_i32 s34, s27, 48
	s_add_u32 s34, s34, s26
	s_mul_i32 s34, s34, 0x1400
	s_add_u32 s34, s34, 0x708000
	s_lshl_b32 s26, s26, 5
	v_add_u32 v13, s26, v32
	v_add_u32 v14, s26, v33
	v_add_u32 v15, s26, v34
	v_add_u32 v16, s26, v35
	v_add_u32 v17, s26, v36
	s_branch PP_go_9
PP_w2_8:
	s_mov_b32 s36, s46
	s_mov_b32 s37, s47
	s_mov_b32 s38, 0xc8000
	s_mov_b32 s39, 0x20000
	s_sub_u32 s28, s21, 0x180
	s_lshr_b32 s26, s28, 3
	s_and_b32 s27, s28, 7
	s_mul_i32 s34, s27, 20
	s_add_u32 s34, s34, s26
	s_mul_i32 s34, s34, 0x1400
	s_add_u32 s34, s34, 0x280000
	s_cmp_ge_u32 s21, 0x220
	s_cselect_b32 s34, 0x40000000, s34
	s_lshl_b32 s26, s26, 5
	v_add_u32 v13, s26, v32
	v_mul_u32_u24 v9, 0x667, v13
	v_lshrrev_b32 v9, 16, v9
	v_mul_u32_u24 v9, 40, v9
	v_sub_u32 v10, v13, v9
	v_lshrrev_b32 v11, 4, v10
	v_mul_u32_u24 v11, 20, v11
	v_and_b32 v12, 15, v10
	v_add_u32 v11, v11, v12
	v_bfe_u32 v12, v10, 2, 1
	v_mul_u32_u24 v12, 20, v12
	v_and_b32 v13, 3, v10
	v_add3_u32 v12, v12, v13, 16
	v_cmp_gt_u32 vcc, 32, v10
	s_nop 1
	v_cndmask_b32 v11, v12, v11, vcc
	v_add_u32 v13, v9, v11
	v_add_u32 v14, s26, v33
	v_mul_u32_u24 v9, 0x667, v14
	v_lshrrev_b32 v9, 16, v9
	v_mul_u32_u24 v9, 40, v9
	v_sub_u32 v10, v14, v9
	v_lshrrev_b32 v11, 4, v10
	v_mul_u32_u24 v11, 20, v11
	v_and_b32 v12, 15, v10
	v_add_u32 v11, v11, v12
	v_bfe_u32 v12, v10, 2, 1
	v_mul_u32_u24 v12, 20, v12
	v_and_b32 v14, 3, v10
	v_add3_u32 v12, v12, v14, 16
	v_cmp_gt_u32 vcc, 32, v10
	s_nop 1
	v_cndmask_b32 v11, v12, v11, vcc
	v_add_u32 v14, v9, v11
	v_add_u32 v15, s26, v34
	v_mul_u32_u24 v9, 0x667, v15
	v_lshrrev_b32 v9, 16, v9
	v_mul_u32_u24 v9, 40, v9
	v_sub_u32 v10, v15, v9
	v_lshrrev_b32 v11, 4, v10
	v_mul_u32_u24 v11, 20, v11
	v_and_b32 v12, 15, v10
	v_add_u32 v11, v11, v12
	v_bfe_u32 v12, v10, 2, 1
	v_mul_u32_u24 v12, 20, v12
	v_and_b32 v15, 3, v10
	v_add3_u32 v12, v12, v15, 16
	v_cmp_gt_u32 vcc, 32, v10
	s_nop 1
	v_cndmask_b32 v11, v12, v11, vcc
	v_add_u32 v15, v9, v11
	v_add_u32 v16, s26, v35
	v_mul_u32_u24 v9, 0x667, v16
	v_lshrrev_b32 v9, 16, v9
	v_mul_u32_u24 v9, 40, v9
	v_sub_u32 v10, v16, v9
	v_lshrrev_b32 v11, 4, v10
	v_mul_u32_u24 v11, 20, v11
	v_and_b32 v12, 15, v10
	v_add_u32 v11, v11, v12
	v_bfe_u32 v12, v10, 2, 1
	v_mul_u32_u24 v12, 20, v12
	v_and_b32 v16, 3, v10
	v_add3_u32 v12, v12, v16, 16
	v_cmp_gt_u32 vcc, 32, v10
	s_nop 1
	v_cndmask_b32 v11, v12, v11, vcc
	v_add_u32 v16, v9, v11
	v_add_u32 v17, s26, v36
	v_mul_u32_u24 v9, 0x667, v17
	v_lshrrev_b32 v9, 16, v9
	v_mul_u32_u24 v9, 40, v9
	v_sub_u32 v10, v17, v9
	v_lshrrev_b32 v11, 4, v10
	v_mul_u32_u24 v11, 20, v11
	v_and_b32 v12, 15, v10
	v_add_u32 v11, v11, v12
	v_bfe_u32 v12, v10, 2, 1
	v_mul_u32_u24 v12, 20, v12
	v_and_b32 v17, 3, v10
	v_add3_u32 v12, v12, v17, 16
	v_cmp_gt_u32 vcc, 32, v10
	s_nop 1
	v_cndmask_b32 v11, v12, v11, vcc
	v_add_u32 v17, v9, v11
PP_go_9:
	s_mul_i32 s23, s27, 0xa0
	s_mov_b32 s29, 0x500
	v_mad_u32_u24 v13, v13, s29, v37
	s_mov_b32 m0, s30
	s_nop 0
	buffer_load_dwordx4 v13, s[36:39], s23 offen nt lds
	s_add_u32 s30, s30, 0x400
	s_mov_b32 s29, 0x500
	v_mad_u32_u24 v14, v14, s29, v38
	s_mov_b32 m0, s30
	s_nop 0
	buffer_load_dwordx4 v14, s[36:39], s23 offen nt lds
	s_add_u32 s30, s30, 0x400
	s_mov_b32 s29, 0x500
	v_mad_u32_u24 v15, v15, s29, v39
	s_mov_b32 m0, s30
	s_nop 0
	buffer_load_dwordx4 v15, s[36:39], s23 offen nt lds
	s_add_u32 s30, s30, 0x400
	s_mov_b32 s29, 0x500
	v_mad_u32_u24 v16, v16, s29, v40
	s_mov_b32 m0, s30
	s_nop 0
	buffer_load_dwordx4 v16, s[36:39], s23 offen nt lds
	s_add_u32 s30, s30, 0x400
	s_mov_b32 s29, 0x500
	v_mad_u32_u24 v17, v17, s29, v41
	s_mov_b32 m0, s30
	s_nop 0
	buffer_load_dwordx4 v17, s[36:39], s23 offen nt lds
	s_add_u32 s30, s30, 0x400
	s_add_u32 s21, s21, 4
	s_cmp_ge_u32 s21, 0x180
	s_cbranch_scc1 PP_w2_10
	s_mov_b32 s36, s54
	s_mov_b32 s37, s55
	s_mov_b32 s38, 0x1e0000
	s_mov_b32 s39, 0x20000
	s_lshr_b32 s26, s21, 3
	s_and_b32 s27, s21, 7
	s_mul_i32 s35, s27, 48
	s_add_u32 s35, s35, s26
	s_mul_i32 s35, s35, 0x1400
	s_add_u32 s35, s35, 0x708000
	s_lshl_b32 s26, s26, 5
	v_add_u32 v13, s26, v32
	v_add_u32 v14, s26, v33
	v_add_u32 v15, s26, v34
	v_add_u32 v16, s26, v35
	v_add_u32 v17, s26, v36
	s_branch PP_go_11
PP_w2_10:
	s_mov_b32 s36, s46
	s_mov_b32 s37, s47
	s_mov_b32 s38, 0xc8000
	s_mov_b32 s39, 0x20000
	s_sub_u32 s28, s21, 0x180
	s_lshr_b32 s26, s28, 3
	s_and_b32 s27, s28, 7
	s_mul_i32 s35, s27, 20
	s_add_u32 s35, s35, s26
	s_mul_i32 s35, s35, 0x1400
	s_add_u32 s35, s35, 0x280000
	s_cmp_ge_u32 s21, 0x220
	s_cselect_b32 s35, 0x40000000, s35
	s_lshl_b32 s26, s26, 5
	v_add_u32 v13, s26, v32
	v_mul_u32_u24 v9, 0x667, v13
	v_lshrrev_b32 v9, 16, v9
	v_mul_u32_u24 v9, 40, v9
	v_sub_u32 v10, v13, v9
	v_lshrrev_b32 v11, 4, v10
	v_mul_u32_u24 v11, 20, v11
	v_and_b32 v12, 15, v10
	v_add_u32 v11, v11, v12
	v_bfe_u32 v12, v10, 2, 1
	v_mul_u32_u24 v12, 20, v12
	v_and_b32 v13, 3, v10
	v_add3_u32 v12, v12, v13, 16
	v_cmp_gt_u32 vcc, 32, v10
	s_nop 1
	v_cndmask_b32 v11, v12, v11, vcc
	v_add_u32 v13, v9, v11
	v_add_u32 v14, s26, v33
	v_mul_u32_u24 v9, 0x667, v14
	v_lshrrev_b32 v9, 16, v9
	v_mul_u32_u24 v9, 40, v9
	v_sub_u32 v10, v14, v9
	v_lshrrev_b32 v11, 4, v10
	v_mul_u32_u24 v11, 20, v11
	v_and_b32 v12, 15, v10
	v_add_u32 v11, v11, v12
	v_bfe_u32 v12, v10, 2, 1
	v_mul_u32_u24 v12, 20, v12
	v_and_b32 v14, 3, v10
	v_add3_u32 v12, v12, v14, 16
	v_cmp_gt_u32 vcc, 32, v10
	s_nop 1
	v_cndmask_b32 v11, v12, v11, vcc
	v_add_u32 v14, v9, v11
	v_add_u32 v15, s26, v34
	v_mul_u32_u24 v9, 0x667, v15
	v_lshrrev_b32 v9, 16, v9
	v_mul_u32_u24 v9, 40, v9
	v_sub_u32 v10, v15, v9
	v_lshrrev_b32 v11, 4, v10
	v_mul_u32_u24 v11, 20, v11
	v_and_b32 v12, 15, v10
	v_add_u32 v11, v11, v12
	v_bfe_u32 v12, v10, 2, 1
	v_mul_u32_u24 v12, 20, v12
	v_and_b32 v15, 3, v10
	v_add3_u32 v12, v12, v15, 16
	v_cmp_gt_u32 vcc, 32, v10
	s_nop 1
	v_cndmask_b32 v11, v12, v11, vcc
	v_add_u32 v15, v9, v11
	v_add_u32 v16, s26, v35
	v_mul_u32_u24 v9, 0x667, v16
	v_lshrrev_b32 v9, 16, v9
	v_mul_u32_u24 v9, 40, v9
	v_sub_u32 v10, v16, v9
	v_lshrrev_b32 v11, 4, v10
	v_mul_u32_u24 v11, 20, v11
	v_and_b32 v12, 15, v10
	v_add_u32 v11, v11, v12
	v_bfe_u32 v12, v10, 2, 1
	v_mul_u32_u24 v12, 20, v12
	v_and_b32 v16, 3, v10
	v_add3_u32 v12, v12, v16, 16
	v_cmp_gt_u32 vcc, 32, v10
	s_nop 1
	v_cndmask_b32 v11, v12, v11, vcc
	v_add_u32 v16, v9, v11
	v_add_u32 v17, s26, v36
	v_mul_u32_u24 v9, 0x667, v17
	v_lshrrev_b32 v9, 16, v9
	v_mul_u32_u24 v9, 40, v9
	v_sub_u32 v10, v17, v9
	v_lshrrev_b32 v11, 4, v10
	v_mul_u32_u24 v11, 20, v11
	v_and_b32 v12, 15, v10
	v_add_u32 v11, v11, v12
	v_bfe_u32 v12, v10, 2, 1
	v_mul_u32_u24 v12, 20, v12
	v_and_b32 v17, 3, v10
	v_add3_u32 v12, v12, v17, 16
	v_cmp_gt_u32 vcc, 32, v10
	s_nop 1
	v_cndmask_b32 v11, v12, v11, vcc
	v_add_u32 v17, v9, v11
PP_go_11:
	s_mul_i32 s23, s27, 0xa0
	s_mov_b32 s29, 0x500
	v_mad_u32_u24 v13, v13, s29, v37
	s_mov_b32 m0, s30
	s_nop 0
	buffer_load_dwordx4 v13, s[36:39], s23 offen nt lds
	s_add_u32 s30, s30, 0x400
	s_mov_b32 s29, 0x500
	v_mad_u32_u24 v14, v14, s29, v38
	s_mov_b32 m0, s30
	s_nop 0
	buffer_load_dwordx4 v14, s[36:39], s23 offen nt lds
	s_add_u32 s30, s30, 0x400
	s_mov_b32 s29, 0x500
	v_mad_u32_u24 v15, v15, s29, v39
	s_mov_b32 m0, s30
	s_nop 0
	buffer_load_dwordx4 v15, s[36:39], s23 offen nt lds
	s_add_u32 s30, s30, 0x400
	s_mov_b32 s29, 0x500
	v_mad_u32_u24 v16, v16, s29, v40
	s_mov_b32 m0, s30
	s_nop 0
	buffer_load_dwordx4 v16, s[36:39], s23 offen nt lds
	s_add_u32 s30, s30, 0x400
	s_mov_b32 s29, 0x500
	v_mad_u32_u24 v17, v17, s29, v41
	s_mov_b32 m0, s30
	s_nop 0
	buffer_load_dwordx4 v17, s[36:39], s23 offen nt lds
	s_add_u32 s30, s30, 0x400
	s_add_u32 s21, s21, 4
	s_and_b32 s31, s2, 7
	s_lshl_b32 s31, s31, 1
	s_lshr_b32 s32, s2, 7
	s_add_u32 s31, s31, s32
	s_bfe_u32 s32, s2, 0x40003
	v_mov_b32 v28, -1
	v_mov_b32 v24, 0
	v_mov_b32 v29, -1
	v_mov_b32 v25, 0
	v_mov_b32 v30, -1
	v_mov_b32 v26, 0
	v_mov_b32 v31, -1
	v_mov_b32 v27, 0
	s_lshl_b32 s95, s32, 4
	s_add_u32 s95, s95, s31
	s_mul_i32 s95, s95, 0xd80
	s_add_u32 s95, s95, 0x2468000
	v_lshlrev_b32 v9, 4, v0
	v_cmp_gt_u32 vcc, 0xd8, v0
	v_mov_b32 v10, 0x40000000
	s_nop 0
	v_cndmask_b32 v9, v10, v9, vcc
	buffer_store_dwordx4 v[28:31], v9, s[8:11], s95 offen sc1
	s_add_u32 s95, s95, 0xd8000
	buffer_store_dwordx4 v[28:31], v9, s[8:11], s95 offen sc1
	v_cmp_gt_u32 vcc, 16, v0
	s_nop 1
	v_cndmask_b32 v9, v10, v9, vcc
	s_lshl_b32 s31, s31, 8
	s_lshl_b32 s95, s32, 12
	s_add_u32 s95, s95, s31
	s_add_u32 s95, s95, 0x2618000
	s_cmp_lt_u32 s32, 8
	s_cselect_b32 s95, s95, 0x40000000
	buffer_store_dwordx4 v[24:27], v9, s[8:11], s95 offen sc1
	buffer_load_dword v255, v24, s[84:87], 0 offen sc1
	s_getpc_b64 s[98:99]
pc_12:
	s_lshr_b32 s31, s2, 3
	s_lshl_b32 s31, s31, 11
	v_and_b32 v9, 15, v0
	v_lshl_add_u32 v9, v9, 7, s31
	v_add_u32 v9, PP_done-pc_12, v9
	v_min_u32 v9, M_codeend-pc_12-4, v9
	v_mov_b32 v253, s99
	v_add_co_u32 v252, vcc, s98, v9
	s_nop 1
	v_addc_co_u32 v253, vcc, 0, v253, vcc
	global_load_dword v254, v[252:253], off
	v_bfe_u32 v15, v1, 2, 2
	v_lshrrev_b32 v16, 4, v1
	v_lshl_add_u32 v14, v15, 3, v7
	v_lshlrev_b32 v11, 3, v16
	v_sub_u32 v19, v14, v11
	v_and_b32 v9, 1, v19
	v_lshlrev_b32 v9, 4, v9
	v_mov_b32 v10, 0x3f80
	v_lshlrev_b32 v9, v9, v10
	v_ashrrev_i32 v10, 1, v19
	v_cmp_eq_u32 vcc, 0, v10
	s_nop 1
	v_cndmask_b32 v216, 0, v9, vcc
	v_cmp_eq_u32 vcc, 1, v10
	s_nop 1
	v_cndmask_b32 v217, 0, v9, vcc
	v_cmp_eq_u32 vcc, 2, v10
	s_nop 1
	v_cndmask_b32 v218, 0, v9, vcc
	v_cmp_eq_u32 vcc, 3, v10
	s_nop 1
	v_cndmask_b32 v219, 0, v9, vcc
	v_add_u32 v19, 4, v19
	v_and_b32 v9, 1, v19
	v_lshlrev_b32 v9, 4, v9
	v_mov_b32 v10, 0x3f80
	v_lshlrev_b32 v9, v9, v10
	v_ashrrev_i32 v10, 1, v19
	v_cmp_eq_u32 vcc, 0, v10
	s_nop 1
	v_cndmask_b32 v220, 0, v9, vcc
	v_cmp_eq_u32 vcc, 1, v10
	s_nop 1
	v_cndmask_b32 v221, 0, v9, vcc
	v_cmp_eq_u32 vcc, 2, v10
	s_nop 1
	v_cndmask_b32 v222, 0, v9, vcc
	v_cmp_eq_u32 vcc, 3, v10
	s_nop 1
	v_cndmask_b32 v223, 0, v9, vcc
	v_and_b32 v19, 15, v1
	v_sub_u32 v19, v19, v11
	v_and_b32 v9, 1, v19
	v_lshlrev_b32 v9, 4, v9
	v_mov_b32 v10, 0x3f80
	v_lshlrev_b32 v9, v9, v10
	v_ashrrev_i32 v10, 1, v19
	v_cmp_eq_u32 vcc, 0, v10
	s_nop 1
	v_cndmask_b32 v224, 0, v9, vcc
	v_cmp_eq_u32 vcc, 1, v10
	s_nop 1
	v_cndmask_b32 v225, 0, v9, vcc
	v_cmp_eq_u32 vcc, 2, v10
	s_nop 1
	v_cndmask_b32 v226, 0, v9, vcc
	v_cmp_eq_u32 vcc, 3, v10
	s_nop 1
	v_cndmask_b32 v227, 0, v9, vcc
	s_mul_i32 s26, s20, 0x3c00
	v_mul_u32_u24 v9, 0xa0, v14
	v_add_u32 v9, s26, v9
	v_lshl_add_u32 v19, v16, 4, v9
	v_and_b32 v10, 1, v16
	v_lshl_add_u32 v20, v10, 4, v9
	s_waitcnt vmcnt(15)
	ds_read_b128 v[192:195], v19 offset:0
	ds_read_b128 v[196:199], v19 offset:640
	ds_read_b128 v[200:203], v19 offset:64
	ds_read_b128 v[204:207], v19 offset:704
	ds_read_b128 v[208:211], v20 offset:128
	ds_read_b128 v[212:215], v20 offset:768
	s_waitcnt lgkmcnt(4)
	v_mfma_f32_16x16x32_bf16 v[48:51], v[192:195], v[216:219], 0
	v_mfma_f32_16x16x32_bf16 v[52:55], v[196:199], v[216:219], 0
	v_mfma_f32_16x16x32_bf16 v[56:59], v[192:195], v[220:223], 0
	v_mfma_f32_16x16x32_bf16 v[60:63], v[196:199], v[220:223], 0
	s_waitcnt lgkmcnt(2)
	v_mfma_f32_16x16x32_bf16 v[64:67], v[200:203], v[216:219], 0
	v_mfma_f32_16x16x32_bf16 v[68:71], v[204:207], v[216:219], 0
	v_mfma_f32_16x16x32_bf16 v[72:75], v[200:203], v[220:223], 0
	v_mfma_f32_16x16x32_bf16 v[76:79], v[204:207], v[220:223], 0
	s_waitcnt lgkmcnt(0)
	v_mfma_f32_16x16x32_bf16 v[80:83], v[208:211], v[224:227], 0
	v_mfma_f32_16x16x32_bf16 v[84:87], v[212:215], v[224:227], 0
	v_cvt_pk_bf16_f32 v96, v48, v49
	v_cvt_pk_bf16_f32 v97, v50, v51
	v_cvt_pk_bf16_f32 v98, v52, v53
	v_cvt_pk_bf16_f32 v99, v54, v55
	buffer_store_dwordx4 v[96:99], v2, s[8:11], s33 offen offset:0 sc1
	v_cvt_pk_bf16_f32 v100, v56, v57
	v_cvt_pk_bf16_f32 v101, v58, v59
	v_cvt_pk_bf16_f32 v102, v60, v61
	v_cvt_pk_bf16_f32 v103, v62, v63
	buffer_store_dwordx4 v[100:103], v2, s[8:11], s33 offen offset:1024 sc1
	v_cvt_pk_bf16_f32 v104, v64, v65
	v_cvt_pk_bf16_f32 v105, v66, v67
	v_cvt_pk_bf16_f32 v106, v68, v69
	v_cvt_pk_bf16_f32 v107, v70, v71
	buffer_store_dwordx4 v[104:107], v2, s[8:11], s33 offen offset:2048 sc1
	v_cvt_pk_bf16_f32 v108, v72, v73
	v_cvt_pk_bf16_f32 v109, v74, v75
	v_cvt_pk_bf16_f32 v110, v76, v77
	v_cvt_pk_bf16_f32 v111, v78, v79
	buffer_store_dwordx4 v[108:111], v2, s[8:11], s33 offen offset:3072 sc1
	v_cvt_pk_bf16_f32 v112, v80, v81
	v_cvt_pk_bf16_f32 v113, v82, v83
	v_cvt_pk_bf16_f32 v114, v84, v85
	v_cvt_pk_bf16_f32 v115, v86, v87
	s_add_u32 s33, s33, 0x1000
	buffer_store_dwordx4 v[112:115], v2, s[8:11], s33 offen offset:0 sc1
	s_waitcnt vmcnt(15)
	ds_read_b128 v[192:195], v19 offset:5120
	ds_read_b128 v[196:199], v19 offset:5760
	ds_read_b128 v[200:203], v19 offset:5184
	ds_read_b128 v[204:207], v19 offset:5824
	ds_read_b128 v[208:211], v20 offset:5248
	ds_read_b128 v[212:215], v20 offset:5888
	s_waitcnt lgkmcnt(4)
	v_mfma_f32_16x16x32_bf16 v[48:51], v[192:195], v[216:219], 0
	v_mfma_f32_16x16x32_bf16 v[52:55], v[196:199], v[216:219], 0
	v_mfma_f32_16x16x32_bf16 v[56:59], v[192:195], v[220:223], 0
	v_mfma_f32_16x16x32_bf16 v[60:63], v[196:199], v[220:223], 0
	s_waitcnt lgkmcnt(2)
	v_mfma_f32_16x16x32_bf16 v[64:67], v[200:203], v[216:219], 0
	v_mfma_f32_16x16x32_bf16 v[68:71], v[204:207], v[216:219], 0
	v_mfma_f32_16x16x32_bf16 v[72:75], v[200:203], v[220:223], 0
	v_mfma_f32_16x16x32_bf16 v[76:79], v[204:207], v[220:223], 0
	s_waitcnt lgkmcnt(0)
	v_mfma_f32_16x16x32_bf16 v[80:83], v[208:211], v[224:227], 0
	v_mfma_f32_16x16x32_bf16 v[84:87], v[212:215], v[224:227], 0
	v_cvt_pk_bf16_f32 v116, v48, v49
	v_cvt_pk_bf16_f32 v117, v50, v51
	v_cvt_pk_bf16_f32 v118, v52, v53
	v_cvt_pk_bf16_f32 v119, v54, v55
	buffer_store_dwordx4 v[116:119], v2, s[8:11], s34 offen offset:0 sc1
	v_cvt_pk_bf16_f32 v120, v56, v57
	v_cvt_pk_bf16_f32 v121, v58, v59
	v_cvt_pk_bf16_f32 v122, v60, v61
	v_cvt_pk_bf16_f32 v123, v62, v63
	buffer_store_dwordx4 v[120:123], v2, s[8:11], s34 offen offset:1024 sc1
	v_cvt_pk_bf16_f32 v124, v64, v65
	v_cvt_pk_bf16_f32 v125, v66, v67
	v_cvt_pk_bf16_f32 v126, v68, v69
	v_cvt_pk_bf16_f32 v127, v70, v71
	buffer_store_dwordx4 v[124:127], v2, s[8:11], s34 offen offset:2048 sc1
	v_cvt_pk_bf16_f32 v128, v72, v73
	v_cvt_pk_bf16_f32 v129, v74, v75
	v_cvt_pk_bf16_f32 v130, v76, v77
	v_cvt_pk_bf16_f32 v131, v78, v79
	buffer_store_dwordx4 v[128:131], v2, s[8:11], s34 offen offset:3072 sc1
	v_cvt_pk_bf16_f32 v132, v80, v81
	v_cvt_pk_bf16_f32 v133, v82, v83
	v_cvt_pk_bf16_f32 v134, v84, v85
	v_cvt_pk_bf16_f32 v135, v86, v87
	s_add_u32 s34, s34, 0x1000
	buffer_store_dwordx4 v[132:135], v2, s[8:11], s34 offen offset:0 sc1
	s_waitcnt vmcnt(15)
	ds_read_b128 v[192:195], v19 offset:10240
	ds_read_b128 v[196:199], v19 offset:10880
	ds_read_b128 v[200:203], v19 offset:10304
	ds_read_b128 v[204:207], v19 offset:10944
	ds_read_b128 v[208:211], v20 offset:10368
	ds_read_b128 v[212:215], v20 offset:11008
	s_waitcnt lgkmcnt(4)
	v_mfma_f32_16x16x32_bf16 v[48:51], v[192:195], v[216:219], 0
	v_mfma_f32_16x16x32_bf16 v[52:55], v[196:199], v[216:219], 0
	v_mfma_f32_16x16x32_bf16 v[56:59], v[192:195], v[220:223], 0
	v_mfma_f32_16x16x32_bf16 v[60:63], v[196:199], v[220:223], 0
	s_waitcnt lgkmcnt(2)
	v_mfma_f32_16x16x32_bf16 v[64:67], v[200:203], v[216:219], 0
	v_mfma_f32_16x16x32_bf16 v[68:71], v[204:207], v[216:219], 0
	v_mfma_f32_16x16x32_bf16 v[72:75], v[200:203], v[220:223], 0
	v_mfma_f32_16x16x32_bf16 v[76:79], v[204:207], v[220:223], 0
	s_waitcnt lgkmcnt(0)
	v_mfma_f32_16x16x32_bf16 v[80:83], v[208:211], v[224:227], 0
	v_mfma_f32_16x16x32_bf16 v[84:87], v[212:215], v[224:227], 0
	v_cvt_pk_bf16_f32 v136, v48, v49
	v_cvt_pk_bf16_f32 v137, v50, v51
	v_cvt_pk_bf16_f32 v138, v52, v53
	v_cvt_pk_bf16_f32 v139, v54, v55
	buffer_store_dwordx4 v[136:139], v2, s[8:11], s35 offen offset:0 sc1
	v_cvt_pk_bf16_f32 v140, v56, v57
	v_cvt_pk_bf16_f32 v141, v58, v59
	v_cvt_pk_bf16_f32 v142, v60, v61
	v_cvt_pk_bf16_f32 v143, v62, v63
	buffer_store_dwordx4 v[140:143], v2, s[8:11], s35 offen offset:1024 sc1
	v_cvt_pk_bf16_f32 v144, v64, v65
	v_cvt_pk_bf16_f32 v145, v66, v67
	v_cvt_pk_bf16_f32 v146, v68, v69
	v_cvt_pk_bf16_f32 v147, v70, v71
	buffer_store_dwordx4 v[144:147], v2, s[8:11], s35 offen offset:2048 sc1
	v_cvt_pk_bf16_f32 v148, v72, v73
	v_cvt_pk_bf16_f32 v149, v74, v75
	v_cvt_pk_bf16_f32 v150, v76, v77
	v_cvt_pk_bf16_f32 v151, v78, v79
	buffer_store_dwordx4 v[148:151], v2, s[8:11], s35 offen offset:3072 sc1
	v_cvt_pk_bf16_f32 v152, v80, v81
	v_cvt_pk_bf16_f32 v153, v82, v83
	v_cvt_pk_bf16_f32 v154, v84, v85
	v_cvt_pk_bf16_f32 v155, v86, v87
	s_add_u32 s35, s35, 0x1000
	buffer_store_dwordx4 v[152:155], v2, s[8:11], s35 offen offset:0 sc1
	s_branch PP_done
PP_x:
	s_waitcnt lgkmcnt(0)
	s_mov_b32 s8, s62
	s_mov_b32 s9, s63
	s_mov_b32 s10, 0x2692000
	s_mov_b32 s11, 0x20000
	s_mov_b32 s84, s58
	s_mov_b32 s85, s59
	s_mov_b32 s86, 0x100
	s_mov_b32 s87, 0x20000
	s_cmp_lg_u32 s2, 0
	s_cbranch_scc1 nononce_13
	v_lshlrev_b32 v10, 8, v0
	s_or_b32 s98, s92, 1
	v_mov_b32 v9, s98
	buffer_store_dword v9, v10, s[84:87], 0 offen sc1
nononce_13:
	s_mov_b32 s12, s40
	s_mov_b32 s13, s41
	s_mov_b32 s14, 0x280000
	s_mov_b32 s15, 0x20000
	s_sub_u32 s21, s2, 0x90
	v_lshrrev_b32 v14, 3, v1
	s_lshl_b32 s26, s20, 3
	v_add_u32 v14, s26, v14
	v_and_b32 v15, 7, v1
	v_mul_u32_u24 v9, 0x500, v14
	v_lshl_add_u32 v13, v15, 4, v9
	s_mul_i32 s23, s21, 0xa000
	buffer_load_dwordx4 v[32:35], v13, s[12:15], s23 offen offset:0 nt
	buffer_load_dwordx4 v[36:39], v13, s[12:15], s23 offen offset:128 nt
	buffer_load_dwordx4 v[40:43], v13, s[12:15], s23 offen offset:256 nt
	buffer_load_dwordx4 v[44:47], v13, s[12:15], s23 offen offset:384 nt
	buffer_load_dwordx4 v[48:51], v13, s[12:15], s23 offen offset:512 nt
	buffer_load_dwordx4 v[52:55], v13, s[12:15], s23 offen offset:640 nt
	buffer_load_dwordx4 v[56:59], v13, s[12:15], s23 offen offset:768 nt
	buffer_load_dwordx4 v[60:63], v13, s[12:15], s23 offen offset:896 nt
	buffer_load_dwordx4 v[64:67], v13, s[12:15], s23 offen offset:1024 nt
	buffer_load_dwordx4 v[68:71], v13, s[12:15], s23 offen offset:1152 nt
	s_and_b32 s31, s2, 7
	s_lshl_b32 s31, s31, 1
	s_lshr_b32 s32, s2, 7
	s_add_u32 s31, s31, s32
	s_bfe_u32 s32, s2, 0x40003
	v_mov_b32 v28, -1
	v_mov_b32 v24, 0
	v_mov_b32 v29, -1
	v_mov_b32 v25, 0
	v_mov_b32 v30, -1
	v_mov_b32 v26, 0
	v_mov_b32 v31, -1
	v_mov_b32 v27, 0
	s_lshl_b32 s95, s32, 4
	s_add_u32 s95, s95, s31
	s_mul_i32 s95, s95, 0xd80
	s_add_u32 s95, s95, 0x2468000
	v_lshlrev_b32 v9, 4, v0
	v_cmp_gt_u32 vcc, 0xd8, v0
	v_mov_b32 v10, 0x40000000
	s_nop 0
	v_cndmask_b32 v9, v10, v9, vcc
	buffer_store_dwordx4 v[28:31], v9, s[8:11], s95 offen sc1
	s_add_u32 s95, s95, 0xd8000
	buffer_store_dwordx4 v[28:31], v9, s[8:11], s95 offen sc1
	v_cmp_gt_u32 vcc, 16, v0
	s_nop 1
	v_cndmask_b32 v9, v10, v9, vcc
	s_lshl_b32 s31, s31, 8
	s_lshl_b32 s95, s32, 12
	s_add_u32 s95, s95, s31
	s_add_u32 s95, s95, 0x2618000
	s_cmp_lt_u32 s32, 8
	s_cselect_b32 s95, s95, 0x40000000
	buffer_store_dwordx4 v[24:27], v9, s[8:11], s95 offen sc1
	buffer_load_dword v255, v24, s[84:87], 0 offen sc1
	s_getpc_b64 s[98:99]
pc_14:
	s_lshr_b32 s31, s2, 3
	s_lshl_b32 s31, s31, 11
	v_and_b32 v9, 15, v0
	v_lshl_add_u32 v9, v9, 7, s31
	v_add_u32 v9, PP_done-pc_14, v9
	v_min_u32 v9, M_codeend-pc_14-4, v9
	v_mov_b32 v253, s99
	v_add_co_u32 v252, vcc, s98, v9
	s_nop 1
	v_addc_co_u32 v253, vcc, 0, v253, vcc
	global_load_dword v254, v[252:253], off
	v_lshrrev_b32 v9, 1, v15
	v_lshlrev_b32 v9, 10, v9
	v_and_b32 v10, 1, v15
	v_lshl_add_u32 v10, v10, 5, v14
	v_lshl_add_u32 v16, v10, 4, v9
	s_add_u32 s23, s23, 0x8e8000
	v_lshrrev_b32 v9, 4, v14
	v_lshlrev_b32 v9, 10, v9
	v_lshl_add_u32 v9, v15, 7, v9
	v_and_b32 v10, 15, v14
	v_lshl_add_u32 v17, v10, 3, v9
	s_lshl_b32 s26, s21, 11
	s_add_u32 s26, s26, 0x23e8000
	v_mov_b32 v18, 0x3f803f80
	v_mov_b32 v20, 0
	v_mov_b32 v21, 0
	s_waitcnt vmcnt(14)
	buffer_store_dwordx4 v[32:35], v16, s[8:11], s23 offen sc1
	s_add_u32 s23, s23, 0x1000
	v_dot2_f32_bf16 v20, v32, v18, v20
	v_dot2_f32_bf16 v21, v32, v32, v21
	v_dot2_f32_bf16 v20, v33, v18, v20
	v_dot2_f32_bf16 v21, v33, v33, v21
	v_dot2_f32_bf16 v20, v34, v18, v20
	v_dot2_f32_bf16 v21, v34, v34, v21
	v_dot2_f32_bf16 v20, v35, v18, v20
	v_dot2_f32_bf16 v21, v35, v35, v21
	s_waitcnt vmcnt(14)
	buffer_store_dwordx4 v[36:39], v16, s[8:11], s23 offen sc1
	s_add_u32 s23, s23, 0x1000
	v_dot2_f32_bf16 v20, v36, v18, v20
	v_dot2_f32_bf16 v21, v36, v36, v21
	v_dot2_f32_bf16 v20, v37, v18, v20
	v_dot2_f32_bf16 v21, v37, v37, v21
	v_dot2_f32_bf16 v20, v38, v18, v20
	v_dot2_f32_bf16 v21, v38, v38, v21
	v_dot2_f32_bf16 v20, v39, v18, v20
	v_dot2_f32_bf16 v21, v39, v39, v21
	s_waitcnt vmcnt(14)
	buffer_store_dwordx4 v[40:43], v16, s[8:11], s23 offen sc1
	s_add_u32 s23, s23, 0x1000
	v_dot2_f32_bf16 v20, v40, v18, v20
	v_dot2_f32_bf16 v21, v40, v40, v21
	v_dot2_f32_bf16 v20, v41, v18, v20
	v_dot2_f32_bf16 v21, v41, v41, v21
	v_dot2_f32_bf16 v20, v42, v18, v20
	v_dot2_f32_bf16 v21, v42, v42, v21
	v_dot2_f32_bf16 v20, v43, v18, v20
	v_dot2_f32_bf16 v21, v43, v43, v21
	s_waitcnt vmcnt(14)
	buffer_store_dwordx4 v[44:47], v16, s[8:11], s23 offen sc1
	s_add_u32 s23, s23, 0x1000
	v_dot2_f32_bf16 v20, v44, v18, v20
	v_dot2_f32_bf16 v21, v44, v44, v21
	v_dot2_f32_bf16 v20, v45, v18, v20
	v_dot2_f32_bf16 v21, v45, v45, v21
	v_dot2_f32_bf16 v20, v46, v18, v20
	v_dot2_f32_bf16 v21, v46, v46, v21
	v_dot2_f32_bf16 v20, v47, v18, v20
	v_dot2_f32_bf16 v21, v47, v47, v21
	s_waitcnt vmcnt(14)
	buffer_store_dwordx4 v[48:51], v16, s[8:11], s23 offen sc1
	s_add_u32 s23, s23, 0x1000
	v_dot2_f32_bf16 v20, v48, v18, v20
	v_dot2_f32_bf16 v21, v48, v48, v21
	v_dot2_f32_bf16 v20, v49, v18, v20
	v_dot2_f32_bf16 v21, v49, v49, v21
	v_dot2_f32_bf16 v20, v50, v18, v20
	v_dot2_f32_bf16 v21, v50, v50, v21
	v_dot2_f32_bf16 v20, v51, v18, v20
	v_dot2_f32_bf16 v21, v51, v51, v21
	s_waitcnt vmcnt(14)
	buffer_store_dwordx4 v[52:55], v16, s[8:11], s23 offen sc1
	s_add_u32 s23, s23, 0x1000
	v_dot2_f32_bf16 v20, v52, v18, v20
	v_dot2_f32_bf16 v21, v52, v52, v21
	v_dot2_f32_bf16 v20, v53, v18, v20
	v_dot2_f32_bf16 v21, v53, v53, v21
	v_dot2_f32_bf16 v20, v54, v18, v20
	v_dot2_f32_bf16 v21, v54, v54, v21
	v_dot2_f32_bf16 v20, v55, v18, v20
	v_dot2_f32_bf16 v21, v55, v55, v21
	s_waitcnt vmcnt(14)
	buffer_store_dwordx4 v[56:59], v16, s[8:11], s23 offen sc1
	s_add_u32 s23, s23, 0x1000
	v_dot2_f32_bf16 v20, v56, v18, v20
	v_dot2_f32_bf16 v21, v56, v56, v21
	v_dot2_f32_bf16 v20, v57, v18, v20
	v_dot2_f32_bf16 v21, v57, v57, v21
	v_dot2_f32_bf16 v20, v58, v18, v20
	v_dot2_f32_bf16 v21, v58, v58, v21
	v_dot2_f32_bf16 v20, v59, v18, v20
	v_dot2_f32_bf16 v21, v59, v59, v21
	s_waitcnt vmcnt(14)
	buffer_store_dwordx4 v[60:63], v16, s[8:11], s23 offen sc1
	s_add_u32 s23, s23, 0x1000
	v_dot2_f32_bf16 v20, v60, v18, v20
	v_dot2_f32_bf16 v21, v60, v60, v21
	v_dot2_f32_bf16 v20, v61, v18, v20
	v_dot2_f32_bf16 v21, v61, v61, v21
	v_dot2_f32_bf16 v20, v62, v18, v20
	v_dot2_f32_bf16 v21, v62, v62, v21
	v_dot2_f32_bf16 v20, v63, v18, v20
	v_dot2_f32_bf16 v21, v63, v63, v21
	s_waitcnt vmcnt(14)
	buffer_store_dwordx4 v[64:67], v16, s[8:11], s23 offen sc1
	s_add_u32 s23, s23, 0x1000
	v_dot2_f32_bf16 v20, v64, v18, v20
	v_dot2_f32_bf16 v21, v64, v64, v21
	v_dot2_f32_bf16 v20, v65, v18, v20
	v_dot2_f32_bf16 v21, v65, v65, v21
	v_dot2_f32_bf16 v20, v66, v18, v20
	v_dot2_f32_bf16 v21, v66, v66, v21
	v_dot2_f32_bf16 v20, v67, v18, v20
	v_dot2_f32_bf16 v21, v67, v67, v21
	s_waitcnt vmcnt(14)
	buffer_store_dwordx4 v[68:71], v16, s[8:11], s23 offen sc1
	s_add_u32 s23, s23, 0x1000
	v_dot2_f32_bf16 v20, v68, v18, v20
	v_dot2_f32_bf16 v21, v68, v68, v21
	v_dot2_f32_bf16 v20, v69, v18, v20
	v_dot2_f32_bf16 v21, v69, v69, v21
	v_dot2_f32_bf16 v20, v70, v18, v20
	v_dot2_f32_bf16 v21, v70, v70, v21
	v_dot2_f32_bf16 v20, v71, v18, v20
	v_dot2_f32_bf16 v21, v71, v71, v21
	s_nop 2
	buffer_store_dwordx2 v[20:21], v17, s[8:11], s26 offen sc1
	s_branch PP_done
PP_fillonly:
	s_waitcnt lgkmcnt(0)
	s_mov_b32 s8, s62
	s_mov_b32 s9, s63
	s_mov_b32 s10, 0x2692000
	s_mov_b32 s11, 0x20000
	s_mov_b32 s84, s58
	s_mov_b32 s85, s59
	s_mov_b32 s86, 0x100
	s_mov_b32 s87, 0x20000
	s_cmp_lg_u32 s2, 0
	s_cbranch_scc1 nononce_15
	v_lshlrev_b32 v10, 8, v0
	s_or_b32 s98, s92, 1
	v_mov_b32 v9, s98
	buffer_store_dword v9, v10, s[84:87], 0 offen sc1
nononce_15:
	s_and_b32 s31, s2, 7
	s_lshl_b32 s31, s31, 1
	s_lshr_b32 s32, s2, 7
	s_add_u32 s31, s31, s32
	s_bfe_u32 s32, s2, 0x40003
	v_mov_b32 v28, -1
	v_mov_b32 v24, 0
	v_mov_b32 v29, -1
	v_mov_b32 v25, 0
	v_mov_b32 v30, -1
	v_mov_b32 v26, 0
	v_mov_b32 v31, -1
	v_mov_b32 v27, 0
	s_lshl_b32 s95, s32, 4
	s_add_u32 s95, s95, s31
	s_mul_i32 s95, s95, 0xd80
	s_add_u32 s95, s95, 0x2468000
	v_lshlrev_b32 v9, 4, v0
	v_cmp_gt_u32 vcc, 0xd8, v0
	v_mov_b32 v10, 0x40000000
	s_nop 0
	v_cndmask_b32 v9, v10, v9, vcc
	buffer_store_dwordx4 v[28:31], v9, s[8:11], s95 offen sc1
	s_add_u32 s95, s95, 0xd8000
	buffer_store_dwordx4 v[28:31], v9, s[8:11], s95 offen sc1
	v_cmp_gt_u32 vcc, 16, v0
	s_nop 1
	v_cndmask_b32 v9, v10, v9, vcc
	s_lshl_b32 s31, s31, 8
	s_lshl_b32 s95, s32, 12
	s_add_u32 s95, s95, s31
	s_add_u32 s95, s95, 0x2618000
	s_cmp_lt_u32 s32, 8
	s_cselect_b32 s95, s95, 0x40000000
	buffer_store_dwordx4 v[24:27], v9, s[8:11], s95 offen sc1
	buffer_load_dword v255, v24, s[84:87], 0 offen sc1
	s_getpc_b64 s[98:99]
pc_16:
	s_lshr_b32 s31, s2, 3
	s_lshl_b32 s31, s31, 11
	v_and_b32 v9, 15, v0
	v_lshl_add_u32 v9, v9, 7, s31
	v_add_u32 v9, PP_done-pc_16, v9
	v_min_u32 v9, M_codeend-pc_16-4, v9
	v_mov_b32 v253, s99
	v_add_co_u32 v252, vcc, s98, v9
	s_nop 1
	v_addc_co_u32 v253, vcc, 0, v253, vcc
	global_load_dword v254, v[252:253], off
	s_branch PP_done
PP_done:
	s_getreg_b32 s46, hwreg(HW_REG_XCC_ID, 0, 4)
	v_mov_b32 v156, 0x40000000
	v_cmp_eq_u32 vcc, 0, v0
	s_nop 1
	v_cndmask_b32 v154, v156, v0, vcc
	v_mov_b32 v153, 0
	s_mov_b32 s47, 0
	s_and_b32 s60, s2, 7
	s_lshl_b32 s60, s60, 1
	s_lshr_b32 s26, s2, 7
	s_add_u32 s60, s60, s26
	s_lshl_b32 s60, s60, 2
	s_add_u32 s60, s60, s20
	s_lshl_b32 s60, s60, 7
	s_add_u32 s60, s60, 0x2625800
	buffer_load_dwordx2 v[42:43], v153, s[8:11], s60 offen sc1
	s_waitcnt vmcnt(0)
nonce_17:
	v_readfirstlane_b32 s90, v255
	s_add_u32 s47, s47, 1
	s_cmp_eq_u32 s90, 0
	s_cbranch_scc1 noncer_19
	s_sub_u32 s26, s92, s90
	s_cmp_le_i32 s26, 0x7d0
	s_cbranch_scc1 nonceok_18
	s_cmp_gt_u32 s47, 64
	s_cbranch_scc1 nonceok_18
noncer_19:
	s_cmp_gt_u32 s47, 0x80000
	s_cbranch_scc1 nonceok_18
	buffer_load_dword v255, v153, s[84:87], 0 offen sc1
	s_waitcnt vmcnt(0)
	s_branch nonce_17
nonceok_18:
	s_not_b32 s26, s90
	s_andn2_b32 s26, s26, 15
	s_or_b32 s46, s46, s26
	v_mov_b32 v38, s90
	v_mov_b32 v39, s46
	s_lshl_b32 s26, s2, 7
	s_add_u32 s26, s26, 0x2621000
	s_barrier
	buffer_store_dwordx2 v[38:39], v154, s[8:11], s26 offen sc1
PP_pubdone:
	s_mov_b32 s25, 0
	v_and_b32 v152, 63, v0
	v_lshlrev_b32 v1, 4, v152
	s_and_b32 s26, s2, 7
	s_lshr_b32 s27, s2, 3
	s_and_b32 s22, s27, 15
	s_lshr_b32 s27, s27, 4
	s_lshl_b32 s21, s26, 1
	s_add_u32 s21, s21, s27
	s_lshr_b32 s23, s22, 3
	s_and_b32 s24, s22, 7
	s_lshl_b32 s39, s20, 12
	s_mul_i32 s30, s22, 0x28000
	s_add_u32 s30, s30, s39
	s_lshl_b32 s26, s21, 2
	s_add_u32 s26, s26, s20
	s_mul_i32 s34, s26, 0xa000
	s_lshl_b32 s35, s26, 11
	v_add_u32 v2, 0x10000, v1
	v_add_u32 v3, 0x20000, v1
	v_and_b32 v153, 24, v152
	v_cmp_eq_u32 vcc, 24, v153
	s_nop 1
	v_cndmask_b32 v27, v1, v156, vcc
	s_lshr_b32 s26, s22, 1
	s_and_b32 s27, s22, 1
	s_lshl_b32 s27, s27, 3
	s_add_u32 s26, s26, s27
	v_and_b32 v153, 7, v152
	v_min_u32 v154, 2, v153
	v_lshl_add_u32 v154, v154, 4, s26
	s_lshl_b32 s26, s21, 2
	s_add_u32 s26, s26, 0x90
	v_and_b32 v155, 3, v153
	v_add_u32 v155, s26, v155
	v_cmp_gt_u32 vcc, 4, v153
	s_nop 1
	v_cndmask_b32 v154, v155, v154, vcc
	v_lshlrev_b32 v36, 7, v154
	s_mov_b32 s47, 0
	v_xor_b32 v253, s46, v43
	v_lshrrev_b32 v253, 4, v253
	v_xor_b32 v254, s90, v42
	v_or_b32 v253, v253, v254
	v_cmp_ne_u32 vcc, 0, v253
	s_cbranch_vccnz xpoll_21
xok_20:
	s_add_u32 s88, s34, 0x8e8000
	buffer_load_dwordx4 a[0:3], v1, s[8:11], s88 offen offset:0 sc1
	buffer_load_dwordx4 a[4:7], v1, s[8:11], s88 offen offset:1024 sc1
	buffer_load_dwordx4 a[8:11], v1, s[8:11], s88 offen offset:2048 sc1
	buffer_load_dwordx4 a[12:15], v1, s[8:11], s88 offen offset:3072 sc1
	s_add_u32 s88, s34, 0x8e9000
	buffer_load_dwordx4 a[16:19], v1, s[8:11], s88 offen offset:0 sc1
	buffer_load_dwordx4 a[20:23], v1, s[8:11], s88 offen offset:1024 sc1
	buffer_load_dwordx4 a[24:27], v1, s[8:11], s88 offen offset:2048 sc1
	buffer_load_dwordx4 a[28:31], v1, s[8:11], s88 offen offset:3072 sc1
	s_add_u32 s88, s34, 0x8ea000
	buffer_load_dwordx4 a[32:35], v1, s[8:11], s88 offen offset:0 sc1
	buffer_load_dwordx4 a[36:39], v1, s[8:11], s88 offen offset:1024 sc1
	buffer_load_dwordx4 a[40:43], v1, s[8:11], s88 offen offset:2048 sc1
	buffer_load_dwordx4 a[44:47], v1, s[8:11], s88 offen offset:3072 sc1
	s_mov_b32 s29, 0x2621000
	s_mov_b32 s47, 0
pfpoll_22:
	buffer_load_dwordx2 v[38:39], v36, s[8:11], s29 offen sc1
	s_add_u32 s47, s47, 1
	s_cmp_gt_u32 s47, 0x80000
	s_cbranch_scc1 pfx_23
	s_waitcnt vmcnt(0)
	v_xor_b32 v253, s46, v39
	v_lshrrev_b32 v253, 4, v253
	v_xor_b32 v254, s90, v38
	v_or_b32 v253, v253, v254
	v_cmp_ne_u32 vcc, 0, v253
	s_cbranch_vccnz pfpoll_22
pfx_23:
	s_waitcnt vmcnt(0)
	s_add_u32 s89, s30, 0
	s_add_u32 m0, s39, 0
	s_nop 0
	buffer_load_dwordx4 v1, s[8:11], s89 offen offset:0 lds
	buffer_load_dwordx4 v1, s[8:11], s89 offen offset:1024 lds
	s_add_u32 s88, s34, 0x8eb000
	buffer_load_dwordx4 a[48:51], v1, s[8:11], s88 offen offset:0 sc1
	buffer_load_dwordx4 v1, s[8:11], s89 offen offset:2048 lds
	buffer_load_dwordx4 a[52:55], v1, s[8:11], s88 offen offset:1024 sc1
	buffer_load_dwordx4 v1, s[8:11], s89 offen offset:3072 lds
	buffer_load_dwordx4 a[56:59], v1, s[8:11], s88 offen offset:2048 sc1
	s_add_u32 s89, s30, 0x4000
	s_add_u32 m0, s39, 0x4000
	s_nop 0
	buffer_load_dwordx4 v1, s[8:11], s89 offen offset:0 lds
	buffer_load_dwordx4 a[60:63], v1, s[8:11], s88 offen offset:3072 sc1
	buffer_load_dwordx4 v1, s[8:11], s89 offen offset:1024 lds
	s_add_u32 s88, s34, 0x8ec000
	buffer_load_dwordx4 a[64:67], v1, s[8:11], s88 offen offset:0 sc1
	buffer_load_dwordx4 v1, s[8:11], s89 offen offset:2048 lds
	buffer_load_dwordx4 a[68:71], v1, s[8:11], s88 offen offset:1024 sc1
	s_waitcnt vmcnt(7)
	s_barrier
	ds_read_b128 v[56:59], v1 offset:0
	ds_read_b128 v[60:63], v1 offset:1024
	ds_read_b128 v[64:67], v1 offset:2048
	ds_read_b128 v[68:71], v1 offset:3072
	s_waitcnt lgkmcnt(3)
	v_mfma_f32_32x32x16_bf16 v[72:87], v[56:59], a[0:3], 0
	s_mov_b32 s12, s56
	s_mov_b32 s13, s57
	s_mov_b32 s14, 0x280000
	s_mov_b32 s15, 0x20000
	v_lshrrev_b32 v157, 5, v152
	v_and_b32 v158, 15, v152
	buffer_load_dwordx4 v1, s[8:11], s89 offen offset:3072 lds
	ds_read_b128 v[56:59], v1 offset:4096
	s_waitcnt lgkmcnt(3)
	v_mfma_f32_32x32x16_bf16 v[88:103], v[60:63], a[0:3], 0
	v_lshrrev_b32 v159, 4, v152
	v_and_b32 v160, 31, v152
	v_lshrrev_b32 v161, 3, v160
	v_bfe_u32 v162, v160, 2, 1
	v_and_b32 v163, 3, v160
	s_mul_i32 s31, s22, 0x3c000
	s_add_u32 s89, s30, 0x8000
	s_add_u32 m0, s39, 0x8000
	s_nop 0
	buffer_load_dwordx4 v1, s[8:11], s89 offen offset:0 lds
	ds_read_b128 v[60:63], v1 offset:5120
	s_waitcnt lgkmcnt(3)
	v_mfma_f32_32x32x16_bf16 v[72:87], v[64:67], a[4:7], v[72:87]
	s_add_u32 s31, s31, s39
	s_add_u32 s31, s31, 0x348000
	s_mul_i32 s26, s24, 20
	s_mul_i32 s27, s20, 5
	s_add_u32 s26, s26, s27
	buffer_load_dwordx4 v1, s[8:11], s89 offen offset:1024 lds
	ds_read_b128 v[64:67], v1 offset:6144
	s_waitcnt lgkmcnt(3)
	v_mfma_f32_32x32x16_bf16 v[88:103], v[68:71], a[4:7], v[88:103]
	s_mul_i32 s32, s26, 0x1400
	s_add_u32 s32, s32, 0x280000
	s_mul_i32 s26, s24, 48
	s_mul_i32 s27, s20, 12
	s_add_u32 s26, s26, s27
	s_mul_i32 s33, s26, 0x1400
	ds_read_b128 v[68:71], v1 offset:7168
	s_waitcnt lgkmcnt(3)
	v_mfma_f32_32x32x16_bf16 v[72:87], v[56:59], a[8:11], v[72:87]
	s_add_u32 s33, s33, 0x708000
	s_mul_i32 s61, s22, 0x600
	s_lshl_b32 s83, s22, 10
	s_mul_i32 s37, s22, 0xd800
	s_mul_i32 s26, s21, 0xd80
	s_add_u32 s36, s37, s26
	ds_read_b128 v[56:59], v1 offset:8192
	s_waitcnt lgkmcnt(3)
	v_mfma_f32_32x32x16_bf16 v[88:103], v[60:63], a[8:11], v[88:103]
	s_lshl_b32 s38, s21, 8
	s_lshl_b32 s26, s20, 4
	s_add_u32 s26, s26, s22
	s_lshl_b32 s26, s26, 2
	s_add_u32 s44, s38, s26
	buffer_load_dwordx4 a[72:75], v1, s[8:11], s88 offen offset:2048 sc1
	ds_read_b128 v[60:63], v1 offset:9216
	s_waitcnt lgkmcnt(3)
	v_mfma_f32_32x32x16_bf16 v[72:87], v[64:67], a[12:15], v[72:87]
	s_lshl_b32 s26, s23, 2
	s_add_u32 s26, s26, s20
	s_lshl_b32 s26, s26, 3
	s_add_u32 s26, s26, s24
	s_lshl_b32 s26, s26, 2
	s_add_u32 s45, s38, s26
	ds_read_b128 v[64:67], v1 offset:10240
	s_waitcnt lgkmcnt(3)
	v_mfma_f32_32x32x16_bf16 v[88:103], v[68:71], a[12:15], v[88:103]
	s_lshl_b32 s26, s21, 2
	s_lshl_b32 s27, s23, 1
	s_add_u32 s26, s26, s27
	s_lshr_b32 s27, s20, 1
	s_add_u32 s26, s26, s27
	buffer_load_dwordx4 v1, s[8:11], s89 offen offset:2048 lds
	ds_read_b128 v[68:71], v1 offset:11264
	s_waitcnt lgkmcnt(3)
	v_mfma_f32_32x32x16_bf16 v[72:87], v[56:59], a[16:19], v[72:87]
	s_mul_i32 s40, s26, 0xa000
	s_mul_i32 s27, s24, 0x1400
	s_add_u32 s40, s40, s27
	s_lshl_b32 s41, s26, 11
	s_and_b32 s27, s20, 1
	s_lshl_b32 s27, s27, 10
	ds_read_b128 v[56:59], v1 offset:12288
	s_waitcnt lgkmcnt(3)
	v_mfma_f32_32x32x16_bf16 v[88:103], v[60:63], a[16:19], v[88:103]
	s_add_u32 s41, s41, s27
	s_lshl_b32 s27, s24, 7
	s_add_u32 s41, s41, s27
	s_mul_i32 s42, s21, 0x60000
	s_mul_i32 s43, s21, 0x60000
	s_mul_i32 s27, s22, 0xc00
	ds_read_b128 v[60:63], v1 offset:13312
	s_waitcnt lgkmcnt(3)
	v_mfma_f32_32x32x16_bf16 v[72:87], v[64:67], a[20:23], v[72:87]
	s_add_u32 s43, s43, s27
	s_add_u32 s26, s20, 0
	s_and_b32 s26, s26, 3
	s_lshl_b32 s27, s23, 2
	s_add_u32 s26, s26, s27
	buffer_load_dwordx4 a[76:79], v1, s[8:11], s88 offen offset:3072 sc1
	ds_read_b128 v[64:67], v1 offset:14336
	s_waitcnt lgkmcnt(3)
	v_mfma_f32_32x32x16_bf16 v[88:103], v[68:71], a[20:23], v[88:103]
	s_mul_i32 s27, s26, 0xc000
	s_add_u32 s48, s27, s42
	s_mul_i32 s27, s20, 0x1400
	s_add_u32 s48, s48, s27
	s_mul_i32 s27, s26, 0xc000
	s_mul_i32 s28, s21, 0x60000
	ds_read_b128 v[68:71], v1 offset:15360
	s_waitcnt lgkmcnt(3)
	v_mfma_f32_32x32x16_bf16 v[72:87], v[56:59], a[24:27], v[72:87]
	s_add_u32 s52, s27, s28
	s_mul_i32 s27, s20, 0x3000
	s_add_u32 s52, s52, s27
	s_add_u32 s26, s20, 1
	s_and_b32 s26, s26, 3
	buffer_load_dwordx4 v1, s[8:11], s89 offen offset:3072 lds
	s_add_u32 s88, s34, 0x8ed000
	buffer_load_dwordx4 a[80:83], v1, s[8:11], s88 offen offset:0 sc1
	s_waitcnt vmcnt(7)
	s_barrier
	ds_read_b128 v[56:59], v1 offset:16384
	s_waitcnt lgkmcnt(3)
	v_mfma_f32_32x32x16_bf16 v[88:103], v[60:63], a[24:27], v[88:103]
	s_mul_i32 s27, s26, 0x3c00
	s_add_u32 s27, s27, 0x1b800
	v_add_u32 v28, s27, v1
	s_lshl_b32 s27, s23, 2
	s_add_u32 s26, s26, s27
	s_mul_i32 s27, s26, 0xc000
	s_add_u32 s89, s30, 0xc000
	s_add_u32 m0, s39, 0xc000
	s_nop 0
	buffer_load_dwordx4 v1, s[8:11], s89 offen offset:0 lds
	ds_read_b128 v[60:63], v1 offset:17408
	s_waitcnt lgkmcnt(3)
	v_mfma_f32_32x32x16_bf16 v[72:87], v[64:67], a[28:31], v[72:87]
	s_add_u32 s49, s27, s42
	s_mul_i32 s27, s20, 0x1400
	s_add_u32 s49, s49, s27
	s_mul_i32 s27, s26, 0xc000
	s_mul_i32 s28, s21, 0x60000
	s_add_u32 s53, s27, s28
	ds_read_b128 v[64:67], v1 offset:18432
	s_waitcnt lgkmcnt(3)
	v_mfma_f32_32x32x16_bf16 v[88:103], v[68:71], a[28:31], v[88:103]
	s_mul_i32 s27, s20, 0x3000
	s_add_u32 s53, s53, s27
	s_add_u32 s26, s20, 2
	s_and_b32 s26, s26, 3
	s_mul_i32 s27, s26, 0x3c00
	buffer_load_dwordx4 v1, s[8:11], s89 offen offset:1024 lds
	ds_read_b128 v[68:71], v1 offset:19456
	s_waitcnt lgkmcnt(3)
	v_mfma_f32_32x32x16_bf16 v[72:87], v[56:59], a[32:35], v[72:87]
	s_add_u32 s27, s27, 0x1a400
	v_add_u32 v29, s27, v1
	s_lshl_b32 s27, s23, 2
	s_add_u32 s26, s26, s27
	s_mul_i32 s27, s26, 0xc000
	s_add_u32 s50, s27, s42
	ds_read_b128 v[56:59], v1 offset:20480
	s_waitcnt lgkmcnt(3)
	v_mfma_f32_32x32x16_bf16 v[88:103], v[60:63], a[32:35], v[88:103]
	s_mul_i32 s27, s20, 0x1400
	s_add_u32 s50, s50, s27
	s_mul_i32 s27, s26, 0xc000
	s_mul_i32 s28, s21, 0x60000
	s_add_u32 s54, s27, s28
	ds_read_b128 v[60:63], v1 offset:21504
	s_waitcnt lgkmcnt(3)
	v_mfma_f32_32x32x16_bf16 v[72:87], v[64:67], a[36:39], v[72:87]
	s_mul_i32 s27, s20, 0x3000
	s_add_u32 s54, s54, s27
	s_add_u32 s26, s20, 3
	s_and_b32 s26, s26, 3
	s_mul_i32 s27, s26, 0x3c00
	s_add_u32 s27, s27, 0x19000
	buffer_load_dwordx4 a[84:87], v1, s[8:11], s88 offen offset:1024 sc1
	ds_read_b128 v[64:67], v1 offset:22528
	s_waitcnt lgkmcnt(3)
	v_mfma_f32_32x32x16_bf16 v[88:103], v[68:71], a[36:39], v[88:103]
	v_add_u32 v30, s27, v1
	s_lshl_b32 s27, s23, 2
	s_add_u32 s26, s26, s27
	s_mul_i32 s27, s26, 0xc000
	s_add_u32 s51, s27, s42
	s_mul_i32 s27, s20, 0x1400
	ds_read_b128 v[68:71], v1 offset:23552
	s_waitcnt lgkmcnt(3)
	v_mfma_f32_32x32x16_bf16 v[72:87], v[56:59], a[40:43], v[72:87]
	s_add_u32 s51, s51, s27
	s_mul_i32 s27, s26, 0xc000
	s_mul_i32 s28, s21, 0x60000
	s_add_u32 s55, s27, s28
	s_mul_i32 s27, s20, 0x3000
	ds_read_b128 v[56:59], v1 offset:24576
	s_waitcnt lgkmcnt(3)
	v_mfma_f32_32x32x16_bf16 v[88:103], v[60:63], a[40:43], v[88:103]
	s_add_u32 s55, s55, s27
	s_mul_i32 s27, s20, 0x3c00
	s_add_u32 s27, s27, 0x19000
	v_add_u32 v26, s27, v1
	s_and_b32 s26, s20, 1
	s_lshl_b32 s26, s26, 4
	ds_read_b128 v[60:63], v1 offset:25600
	s_waitcnt lgkmcnt(3)
	v_mfma_f32_32x32x16_bf16 v[72:87], v[64:67], a[44:47], v[72:87]
	v_add_u32 v156, s26, v158
	v_lshrrev_b32 v153, 1, v159
	v_and_b32 v154, 1, v159
	v_lshl_add_u32 v155, v154, 5, v156
	v_lshlrev_b32 v155, 4, v155
	buffer_load_dwordx4 v1, s[8:11], s89 offen offset:2048 lds
	ds_read_b128 v[64:67], v1 offset:26624
	s_waitcnt lgkmcnt(3)
	v_mfma_f32_32x32x16_bf16 v[88:103], v[68:71], a[44:47], v[88:103]
	v_lshl_add_u32 v4, v153, 10, v155
	v_lshl_add_u32 v155, v153, 5, v156
	v_lshlrev_b32 v155, 4, v155
	v_lshl_add_u32 v155, v154, 3, v155
	v_add_u32 v5, 0x1000, v155
	v_lshlrev_b32 v155, 3, v158
	ds_read_b128 v[68:71], v1 offset:27648
	s_waitcnt lgkmcnt(3)
	v_mfma_f32_32x32x16_bf16 v[72:87], v[56:59], a[48:51], v[72:87]
	v_lshl_add_u32 v6, v157, 2, v155
	v_lshrrev_b32 v153, 4, v160
	v_lshl_add_u32 v155, v153, 10, v155
	v_lshl_add_u32 v7, v157, 9, v155
	s_lshl_b32 s26, s20, 1
	v_lshrrev_b32 v153, 4, v160
	buffer_load_dwordx4 v1, s[8:11], s89 offen offset:3072 lds
	ds_read_b128 v[56:59], v1 offset:28672
	s_waitcnt lgkmcnt(3)
	v_mfma_f32_32x32x16_bf16 v[88:103], v[60:63], a[48:51], v[88:103]
	v_add_u32 v153, s26, v153
	s_mov_b32 s27, 0xc000
	v_mul_lo_u32 v154, v153, s27
	v_lshl_add_u32 v154, v158, 4, v154
	v_lshl_add_u32 v11, v157, 8, v154
	ds_read_b128 v[60:63], v1 offset:29696
	s_waitcnt lgkmcnt(3)
	v_mfma_f32_32x32x16_bf16 v[72:87], v[64:67], a[52:55], v[72:87]
	v_mul_u32_u24 v153, 0xc000, v153
	v_lshl_add_u32 v153, v158, 4, v153
	s_mul_i32 s26, s22, 5
	v_lshl_add_u32 v154, v157, 1, s26
	v_lshl_add_u32 v8, v154, 8, v153
	v_lshl_add_u32 v154, v157, 1, s26
	ds_read_b128 v[64:67], v1 offset:30720
	s_waitcnt lgkmcnt(3)
	v_mfma_f32_32x32x16_bf16 v[88:103], v[68:71], a[52:55], v[88:103]
	v_add_u32 v154, 1, v154
	v_lshl_add_u32 v9, v154, 8, v153
	s_add_u32 s26, s26, 4
	s_lshl_b32 s26, s26, 8
	v_add_u32 v154, s26, v153
	v_lshl_add_u32 v10, v157, 3, v154
	buffer_load_dwordx4 a[88:91], v1, s[8:11], s88 offen offset:2048 sc1
	ds_read_b128 v[68:71], v1 offset:31744
	s_waitcnt lgkmcnt(3)
	v_mfma_f32_32x32x16_bf16 v[72:87], v[56:59], a[56:59], v[72:87]
	s_lshl_b32 s26, s21, 7
	s_lshl_b32 s27, s23, 6
	s_add_u32 s26, s26, s27
	s_lshl_b32 s27, s20, 4
	s_add_u32 s26, s26, s27
	s_waitcnt vmcnt(7)
	s_barrier
	ds_read_b128 v[56:59], v1 offset:32768
	s_waitcnt lgkmcnt(3)
	v_mfma_f32_32x32x16_bf16 v[88:103], v[60:63], a[56:59], v[88:103]
	v_add_u32 v153, s26, v158
	v_mul_u32_u24 v153, 0x500, v153
	s_mul_i32 s26, s24, 0xa0
	v_add_u32 v153, s26, v153
	v_lshl_add_u32 v12, v159, 4, v153
	v_lshl_add_u32 v153, v159, 3, v153
	s_add_u32 s89, s30, 0x10000
	s_add_u32 m0, s39, 0x10000
	s_nop 0
	buffer_load_dwordx4 v1, s[8:11], s89 offen offset:0 lds
	ds_read_b128 v[60:63], v1 offset:33792
	s_waitcnt lgkmcnt(3)
	v_mfma_f32_32x32x16_bf16 v[72:87], v[64:67], a[60:63], v[72:87]
	v_add_u32 v13, 0x80, v153
	v_bfe_u32 v153, v152, 2, 1
	s_lshl_b32 s26, s23, 1
	v_add_u32 v153, s26, v153
	v_lshlrev_b32 v153, 4, v153
	ds_read_b128 v[64:67], v1 offset:34816
	s_waitcnt lgkmcnt(3)
	v_mfma_f32_32x32x16_bf16 v[88:103], v[68:71], a[60:63], v[88:103]
	s_lshl_b32 s26, s20, 2
	v_add3_u32 v153, v153, v163, s26
	v_lshlrev_b32 v14, 2, v153
	s_lshl_b32 s26, s20, 4
	v_add_u32 v153, s26, v158
	v_lshlrev_b32 v15, 2, v153
	buffer_load_dwordx4 v1, s[8:11], s89 offen offset:1024 lds
	ds_read_b128 v[68:71], v1 offset:35840
	s_waitcnt lgkmcnt(3)
	v_mfma_f32_32x32x16_bf16 v[72:87], v[56:59], a[64:67], v[72:87]
	v_mov_b32 v156, 0x40000000
	v_cmp_eq_u32 vcc, 0, v152
	s_nop 1
	v_cndmask_b32 v16, v156, v152, vcc
	s_and_b32 s26, s20, 1
	s_lshl_b32 s26, s26, 4
	v_add_u32 v153, s26, v158
	s_lshr_b32 s27, s20, 1
	buffer_load_dwordx4 a[92:95], v1, s[8:11], s88 offen offset:3072 sc1
	ds_read_b128 v[56:59], v1 offset:36864
	s_waitcnt lgkmcnt(3)
	v_mfma_f32_32x32x16_bf16 v[88:103], v[60:63], a[64:67], v[88:103]
	s_mul_i32 s28, s27, 21
	v_add_u32 v154, s28, v153
	v_mul_u32_u24 v154, 0x50, v154
	v_cmp_gt_u32 vcc, 21, v153
	s_nop 1
	v_cndmask_b32 v154, v156, v154, vcc
	v_lshl_add_u32 v17, v159, 4, v154
	ds_read_b128 v[60:63], v1 offset:37888
	s_waitcnt lgkmcnt(3)
	v_mfma_f32_32x32x16_bf16 v[72:87], v[64:67], a[68:71], v[72:87]
	v_lshl_add_u32 v154, v159, 3, v154
	v_add_u32 v154, 64, v154
	v_cmp_gt_u32 vcc, 2, v159
	s_nop 1
	v_cndmask_b32 v18, v156, v154, vcc
	v_lshlrev_b32 v153, 4, v0
	v_add_u32 v23, 0x18000, v153
	v_cmp_gt_u32 vcc, 0xd2, v0
	s_nop 1
	v_cndmask_b32 v19, v156, v153, vcc
	ds_read_b128 v[64:67], v1 offset:38912
	s_waitcnt lgkmcnt(3)
	v_mfma_f32_32x32x16_bf16 v[88:103], v[68:71], a[68:71], v[88:103]
	s_lshl_b32 s26, s20, 5
	v_lshl_add_u32 v153, v157, 7, v160
	v_add_u32 v153, s26, v153
	v_mul_u32_u24 v20, 0xa0, v153
	s_lshl_b32 s26, s27, 7
	ds_read_b128 v[68:71], v1 offset:39936
	s_waitcnt lgkmcnt(3)
	v_mfma_f32_32x32x16_bf16 v[72:87], v[56:59], a[72:75], v[72:87]
	v_lshrrev_b32 v153, 2, v152
	v_add_u32 v153, s26, v153
	v_mul_u32_u24 v153, 0xa0, v153
	v_lshl_add_u32 v21, v163, 3, v153
	s_and_b32 s26, s20, 1
	s_lshl_b32 s26, s26, 5
	buffer_load_dwordx4 v1, s[8:11], s89 offen offset:2048 lds
	ds_read_b128 v[56:59], v1 offset:40960
	s_waitcnt lgkmcnt(3)
	v_mfma_f32_32x32x16_bf16 v[88:103], v[60:63], a[72:75], v[88:103]
	s_add_u32 s26, s26, 0x50
	v_add_u32 v22, s26, v21
	v_lshl_add_u32 v153, v161, 2, v163
	v_mul_u32_u24 v154, 21, v157
	v_add_u32 v154, v154, v153
	v_mul_u32_u24 v154, 0x50, v154
	ds_read_b128 v[60:63], v1 offset:41984
	s_waitcnt lgkmcnt(3)
	v_mfma_f32_32x32x16_bf16 v[72:87], v[64:67], a[76:79], v[72:87]
	v_add_u32 v154, 0x18000, v154
	v_mov_b32 v155, 0x18d20
	v_cmp_eq_u32 vcc, v162, v157
	s_nop 1
	v_cndmask_b32 v24, v155, v154, vcc
	v_add_u32 v154, 0x500, v154
	v_cndmask_b32 v154, v155, v154, vcc
	v_cmp_gt_u32 vcc, 5, v153
	s_nop 1
	v_cndmask_b32 v25, v155, v154, vcc
	v_mov_b32 v155, 0xffffff9c
	ds_read_b128 v[64:67], v1 offset:43008
	s_waitcnt lgkmcnt(3)
	v_mfma_f32_32x32x16_bf16 v[88:103], v[68:71], a[76:79], v[88:103]
	v_cmp_eq_u32 vcc, v162, v157
	s_nop 1
	v_cndmask_b32 v153, v155, v153, vcc
	v_and_b32 v154, 1, v153
	v_lshlrev_b32 v154, 4, v154
	v_mov_b32 v155, 0x3f80
	v_lshlrev_b32 v154, v154, v155
	v_ashrrev_i32 v155, 1, v153
	s_add_u32 s88, s34, 0x8ee000
	buffer_load_dwordx4 a[96:99], v1, s[8:11], s88 offen offset:0 sc1
	ds_read_b128 v[68:71], v1 offset:44032
	s_waitcnt lgkmcnt(3)
	s_waitcnt vmcnt(11)
	v_mfma_f32_32x32x16_bf16 v[72:87], v[56:59], a[80:83], v[72:87]
	v_cmp_eq_u32 vcc, 0, v155
	s_nop 1
	v_cndmask_b32 v32, 0, v154, vcc
	v_cmp_eq_u32 vcc, 1, v155
	s_nop 1
	v_cndmask_b32 v33, 0, v154, vcc
	v_cmp_eq_u32 vcc, 2, v155
	s_nop 1
	v_cndmask_b32 v34, 0, v154, vcc
	v_cmp_eq_u32 vcc, 3, v155
	s_nop 1
	v_cndmask_b32 v35, 0, v154, vcc
	s_bfe_u32 s26, s2, 0x10007
	buffer_load_dwordx4 v1, s[8:11], s89 offen offset:3072 lds
	ds_read_b128 v[56:59], v1 offset:45056
	s_waitcnt lgkmcnt(3)
	v_mfma_f32_32x32x16_bf16 v[88:103], v[60:63], a[80:83], v[88:103]
	s_lshl_b32 s26, s26, 7
	s_and_b32 s27, s2, 7
	s_add_u32 s26, s26, s27
	v_lshl_add_u32 v153, v158, 3, s26
	v_and_b32 v154, 7, v152
	v_bfe_u32 v155, v152, 3, 1
	ds_read_b128 v[60:63], v1 offset:46080
	s_waitcnt lgkmcnt(3)
	s_waitcnt vmcnt(9)
	v_mfma_f32_32x32x16_bf16 v[72:87], v[64:67], a[84:87], v[72:87]
	v_lshl_add_u32 v154, v155, 7, v154
	s_lshl_b32 s26, s22, 3
	v_add_u32 v154, s26, v154
	v_mov_b32 v155, 0xd0
	v_add3_u32 v155, v155, v152, -16
	v_min_u32 v155, 0xfd, v155
	ds_read_b128 v[64:67], v1 offset:47104
	s_waitcnt lgkmcnt(3)
	v_mfma_f32_32x32x16_bf16 v[88:103], v[68:71], a[84:87], v[88:103]
	s_mul_i32 s26, s22, 3
	v_min_u32 v165, 2, v163
	v_add_u32 v165, s26, v165
	v_lshrrev_b32 v166, 1, v165
	v_mad_u32_u24 v166, v162, 24, v166
	ds_read_b128 v[68:71], v1 offset:48128
	s_waitcnt lgkmcnt(3)
	buffer_load_dwordx4 a[100:103], v1, s[8:11], s88 offen offset:1024 sc1
	s_waitcnt vmcnt(7)
	v_mfma_f32_32x32x16_bf16 v[72:87], v[56:59], a[88:91], v[72:87]
	v_and_b32 v165, 1, v165
	v_lshlrev_b32 v165, 3, v165
	v_and_b32 v167, 7, v166
	v_add_u32 v165, v165, v167
	v_lshrrev_b32 v166, 3, v166
	v_lshl_add_u32 v165, v166, 4, v165
	s_add_u32 s89, s30, 0x14000
	s_add_u32 m0, s39, 0x14000
	s_nop 0
	buffer_load_dwordx4 v1, s[8:11], s89 offen offset:0 lds
	s_barrier
	ds_read_b128 v[56:59], v1 offset:49152
	s_waitcnt lgkmcnt(3)
	v_mfma_f32_32x32x16_bf16 v[88:103], v[60:63], a[88:91], v[88:103]
	v_add_u32 v165, 48, v165
	s_cmp_eq_u32 s20, 0
	s_cselect_b64 vcc, -1, 0
	v_cndmask_b32 v155, v155, v154, vcc
	s_cmp_eq_u32 s20, 3
	s_cselect_b64 vcc, -1, 0
	v_cndmask_b32 v155, v155, v165, vcc
	v_cmp_gt_u32 vcc, 16, v152
	s_nop 1
	v_cndmask_b32 v155, v155, v153, vcc
	v_lshlrev_b32 v37, 7, v155
	buffer_load_dwordx4 v1, s[8:11], s89 offen offset:1024 lds
	ds_read_b128 v[60:63], v1 offset:50176
	s_waitcnt lgkmcnt(3)
	buffer_load_dwordx4 v1, s[8:11], s89 offen offset:2048 lds
	s_waitcnt vmcnt(7)
	v_mfma_f32_32x32x16_bf16 v[72:87], v[64:67], a[92:95], v[72:87]
	buffer_load_dwordx4 a[104:107], v1, s[8:11], s88 offen offset:2048 sc1
	ds_read_b128 v[64:67], v1 offset:51200
	s_waitcnt lgkmcnt(3)
	v_mfma_f32_32x32x16_bf16 v[88:103], v[68:71], a[92:95], v[88:103]
	ds_read_b128 v[68:71], v1 offset:52224
	s_waitcnt lgkmcnt(3)
	buffer_load_dwordx4 v1, s[8:11], s89 offen offset:3072 lds
	s_waitcnt vmcnt(7)
	v_mfma_f32_32x32x16_bf16 v[72:87], v[56:59], a[96:99], v[72:87]
	s_mov_b32 s29, 0x2621000
	buffer_load_dwordx2 v[38:39], v37, s[8:11], s29 offen sc1
	buffer_load_dwordx4 a[108:111], v1, s[8:11], s88 offen offset:3072 sc1
	ds_read_b128 v[56:59], v1 offset:53248
	s_waitcnt lgkmcnt(3)
	v_mfma_f32_32x32x16_bf16 v[88:103], v[60:63], a[96:99], v[88:103]
	ds_read_b128 v[60:63], v1 offset:54272
	s_waitcnt lgkmcnt(3)
	s_add_u32 s88, s34, 0x8ef000
	buffer_load_dwordx4 a[112:115], v1, s[8:11], s88 offen offset:0 sc1
	s_waitcnt vmcnt(8)
	v_mfma_f32_32x32x16_bf16 v[72:87], v[64:67], a[100:103], v[72:87]
	s_add_u32 s89, s30, 0x18000
	s_add_u32 m0, s39, 0x18000
	s_nop 0
	buffer_load_dwordx4 v1, s[8:11], s89 offen offset:0 lds
	ds_read_b128 v[64:67], v1 offset:55296
	s_waitcnt lgkmcnt(3)
	v_mfma_f32_32x32x16_bf16 v[88:103], v[68:71], a[100:103], v[88:103]
	ds_read_b128 v[68:71], v1 offset:56320
	s_waitcnt lgkmcnt(3)
	buffer_load_dwordx4 a[116:119], v1, s[8:11], s88 offen offset:1024 sc1
	buffer_load_dwordx4 v1, s[8:11], s89 offen offset:1024 lds
	buffer_load_dwordx4 a[120:123], v1, s[8:11], s88 offen offset:2048 sc1
	s_waitcnt vmcnt(8)
	v_mfma_f32_32x32x16_bf16 v[72:87], v[56:59], a[104:107], v[72:87]
	buffer_load_dwordx4 v1, s[8:11], s89 offen offset:2048 lds
	ds_read_b128 v[56:59], v1 offset:57344
	s_waitcnt lgkmcnt(3)
	v_mfma_f32_32x32x16_bf16 v[88:103], v[60:63], a[104:107], v[88:103]
	ds_read_b128 v[60:63], v1 offset:58368
	s_waitcnt lgkmcnt(3)
	buffer_load_dwordx4 v1, s[8:11], s89 offen offset:3072 lds
	s_waitcnt vmcnt(7)
	v_mfma_f32_32x32x16_bf16 v[72:87], v[64:67], a[108:111], v[72:87]
	s_add_u32 s93, s83, 0x262a000
	v_and_b32 v253, 0x200, v1
	v_lshrrev_b32 v252, 1, v1
	v_lshl_or_b32 v253, v253, 21, v252
	buffer_load_dwordx2 v[212:213], v253, s[8:11], s93 offen offset:0
	buffer_load_dwordx2 v[214:215], v253, s[8:11], s93 offen offset:256
	buffer_load_dwordx2 v[216:217], v253, s[8:11], s93 offen offset:512
	buffer_load_dwordx2 v[218:219], v253, s[8:11], s93 offen offset:768
	ds_read_b128 v[64:67], v1 offset:59392
	s_waitcnt lgkmcnt(3)
	v_mfma_f32_32x32x16_bf16 v[88:103], v[68:71], a[108:111], v[88:103]
	s_add_u32 s93, s35, 0x23e8000
	buffer_load_dwordx2 v[184:185], v7, s[8:11], s93 offen offset:0 sc1
	buffer_load_dwordx2 v[186:187], v7, s[8:11], s93 offen offset:128 sc1
	buffer_load_dwordx2 v[188:189], v7, s[8:11], s93 offen offset:256 sc1
	buffer_load_dwordx2 v[190:191], v7, s[8:11], s93 offen offset:384 sc1
	ds_read_b128 v[68:71], v1 offset:60416
	s_waitcnt lgkmcnt(3)
	s_waitcnt vmcnt(14)
	v_mfma_f32_32x32x16_bf16 v[72:87], v[56:59], a[112:115], v[72:87]
	buffer_load_dwordx4 a[124:127], v1, s[8:11], s88 offen offset:3072 sc1
	ds_read_b128 v[56:59], v1 offset:61440
	s_waitcnt lgkmcnt(3)
	v_mfma_f32_32x32x16_bf16 v[88:103], v[60:63], a[112:115], v[88:103]
	s_add_u32 s88, s34, 0x8f0000
	buffer_load_dwordx4 a[128:131], v1, s[8:11], s88 offen offset:0 sc1
	ds_read_b128 v[60:63], v1 offset:62464
	s_waitcnt lgkmcnt(3)
	buffer_load_dwordx4 a[132:135], v1, s[8:11], s88 offen offset:1024 sc1
	s_waitcnt vmcnt(15)
	v_mfma_f32_32x32x16_bf16 v[72:87], v[64:67], a[116:119], v[72:87]
	buffer_load_dwordx4 a[136:139], v1, s[8:11], s88 offen offset:2048 sc1
	ds_read_b128 v[64:67], v1 offset:63488
	s_waitcnt lgkmcnt(3)
	v_mfma_f32_32x32x16_bf16 v[88:103], v[68:71], a[116:119], v[88:103]
	ds_read_b128 v[68:71], v1 offset:64512
	s_waitcnt lgkmcnt(3)
	buffer_load_dwordx4 a[140:143], v1, s[8:11], s88 offen offset:3072 sc1
	s_waitcnt vmcnt(15)
	v_mfma_f32_32x32x16_bf16 v[72:87], v[56:59], a[120:123], v[72:87]
	s_add_u32 s88, s34, 0x8f1000
	buffer_load_dwordx4 a[144:147], v1, s[8:11], s88 offen offset:0 sc1
	s_barrier
	ds_read_b128 v[56:59], v2 offset:0
	s_waitcnt lgkmcnt(3)
	v_mfma_f32_32x32x16_bf16 v[88:103], v[60:63], a[120:123], v[88:103]
	s_add_u32 s89, s30, 0x1c000
	s_add_u32 m0, s39, 0x1c000
	s_nop 0
	buffer_load_dwordx4 v1, s[8:11], s89 offen offset:0 lds
	ds_read_b128 v[60:63], v2 offset:1024
	s_waitcnt lgkmcnt(3)
	buffer_load_dwordx4 a[148:151], v1, s[8:11], s88 offen offset:1024 sc1
	s_waitcnt vmcnt(7)
	v_mfma_f32_32x32x16_bf16 v[72:87], v[64:67], a[124:127], v[72:87]
	buffer_load_dwordx4 v1, s[8:11], s89 offen offset:1024 lds
	ds_read_b128 v[64:67], v2 offset:2048
	s_waitcnt lgkmcnt(3)
	v_mfma_f32_32x32x16_bf16 v[88:103], v[68:71], a[124:127], v[88:103]
	ds_read_b128 v[68:71], v2 offset:3072
	s_waitcnt lgkmcnt(3)
	s_waitcnt vmcnt(7)
	v_mfma_f32_32x32x16_bf16 v[72:87], v[56:59], a[128:131], v[72:87]
	buffer_load_dwordx4 v1, s[8:11], s89 offen offset:2048 lds
	ds_read_b128 v[56:59], v2 offset:4096
	s_waitcnt lgkmcnt(3)
	v_mfma_f32_32x32x16_bf16 v[88:103], v[60:63], a[128:131], v[88:103]
	ds_read_b128 v[60:63], v2 offset:5120
	s_waitcnt lgkmcnt(3)
	s_waitcnt vmcnt(7)
	v_mfma_f32_32x32x16_bf16 v[72:87], v[64:67], a[132:135], v[72:87]
	buffer_load_dwordx4 v1, s[8:11], s89 offen offset:3072 lds
	ds_read_b128 v[64:67], v2 offset:6144
	s_waitcnt lgkmcnt(3)
	v_mfma_f32_32x32x16_bf16 v[88:103], v[68:71], a[132:135], v[88:103]
	ds_read_b128 v[68:71], v2 offset:7168
	s_waitcnt lgkmcnt(3)
	s_waitcnt vmcnt(7)
	v_mfma_f32_32x32x16_bf16 v[72:87], v[56:59], a[136:139], v[72:87]
	buffer_load_dwordx4 a[152:155], v1, s[8:11], s88 offen offset:2048 sc1
	ds_read_b128 v[56:59], v2 offset:8192
	s_waitcnt lgkmcnt(3)
	v_mfma_f32_32x32x16_bf16 v[88:103], v[60:63], a[136:139], v[88:103]
	ds_read_b128 v[60:63], v2 offset:9216
	s_waitcnt lgkmcnt(3)
	s_waitcnt vmcnt(7)
	v_mfma_f32_32x32x16_bf16 v[72:87], v[64:67], a[140:143], v[72:87]
	buffer_load_dwordx4 a[156:159], v1, s[8:11], s88 offen offset:3072 sc1
	ds_read_b128 v[64:67], v2 offset:10240
	s_waitcnt lgkmcnt(3)
	v_mfma_f32_32x32x16_bf16 v[88:103], v[68:71], a[140:143], v[88:103]
	v_xor_b32 v253, s46, v39
	v_lshrrev_b32 v253, 4, v253
	v_xor_b32 v254, s90, v38
	v_or_b32 v253, v253, v254
	v_cmp_ne_u32 vcc, 0, v253
	s_cbranch_vccnz pf1poll_24
pf1ok_25:
	v_cmp_ne_u32 vcc, s46, v39
	s_nop 0
	s_and_b32 s29, vcc_lo, 0xffff
	s_cmp_eq_u32 s29, 0
	s_cselect_b32 s25, 1, 0
	s_barrier
	ds_read_b128 v[68:71], v2 offset:11264
	s_waitcnt lgkmcnt(3)
	s_waitcnt vmcnt(7)
	v_mfma_f32_32x32x16_bf16 v[72:87], v[56:59], a[144:147], v[72:87]
	s_add_u32 s94, s32, 0
	buffer_load_dwordx4 a[160:163], v1, s[8:11], s94 offen offset:0
	ds_read_b128 v[56:59], v2 offset:12288
	s_waitcnt lgkmcnt(3)
	v_mfma_f32_32x32x16_bf16 v[88:103], v[60:63], a[144:147], v[88:103]
	v_add_f32 v184, v184, v186
	v_add_f32 v185, v185, v187
	v_add_f32 v188, v188, v190
	s_add_u32 s89, s30, 0x20000
	s_add_u32 m0, s39, 0x20000
	s_nop 0
	buffer_load_dwordx4 v27, s[8:11], s89 offen offset:0 lds
	ds_read_b128 v[60:63], v2 offset:13312
	s_waitcnt lgkmcnt(3)
	s_waitcnt vmcnt(7)
	v_mfma_f32_32x32x16_bf16 v[72:87], v[64:67], a[148:151], v[72:87]
	v_add_f32 v189, v189, v191
	v_add_f32 v184, v184, v188
	v_add_f32 v185, v185, v189
	buffer_load_dwordx4 a[164:167], v1, s[8:11], s94 offen offset:1024
	ds_read_b128 v[64:67], v2 offset:14336
	s_waitcnt lgkmcnt(3)
	v_mfma_f32_32x32x16_bf16 v[88:103], v[68:71], a[148:151], v[88:103]
	v_mov_b32 v186, v184
	v_mov_b32 v187, v185
	s_nop 0
	v_permlane32_swap_b32 v184, v186
	v_permlane32_swap_b32 v185, v187
	ds_read_b128 v[68:71], v2 offset:15360
	s_waitcnt lgkmcnt(3)
	buffer_load_dwordx4 v27, s[8:11], s89 offen offset:1024 lds
	buffer_load_dwordx4 a[168:171], v1, s[8:11], s94 offen offset:2048
	buffer_load_dwordx4 v27, s[8:11], s89 offen offset:2048 lds
	s_waitcnt vmcnt(7)
	v_mfma_f32_32x32x16_bf16 v[72:87], v[56:59], a[152:155], v[72:87]
	v_add_f32 v184, v184, v186
	v_add_f32 v185, v185, v187
	v_mul_f32 v184, 0x3acccccd, v184
	buffer_load_dwordx4 v27, s[8:11], s89 offen offset:3072 lds
	ds_read_b128 v[56:59], v2 offset:16384
	s_waitcnt lgkmcnt(3)
	v_mfma_f32_32x32x16_bf16 v[88:103], v[60:63], a[152:155], v[88:103]
	v_mul_f32 v185, 0x3acccccd, v185
	v_fma_f32 v185, -v184, v184, v185
	v_max_f32 v185, 0, v185
	v_add_f32 v185, 0x3727c5ac, v185
	ds_read_b128 v[60:63], v2 offset:17408
	s_waitcnt lgkmcnt(3)
	s_waitcnt vmcnt(7)
	v_mfma_f32_32x32x16_bf16 v[72:87], v[64:67], a[156:159], v[72:87]
	v_cvt_pk_bf16_f32 v221, -v184, 0
	v_lshlrev_b32 v186, 16, v221
	v_sub_f32 v186, -v184, v186
	s_add_u32 s89, s30, 0x24000
	s_add_u32 m0, s39, 0x24000
	s_nop 0
	buffer_load_dwordx4 v27, s[8:11], s89 offen offset:0 lds
	ds_read_b128 v[64:67], v2 offset:18432
	s_waitcnt lgkmcnt(3)
	v_mfma_f32_32x32x16_bf16 v[88:103], v[68:71], a[156:159], v[88:103]
	v_cvt_pk_bf16_f32 v220, -v184, v186
	v_rsq_f32 v31, v185
	s_nop 0
	v_mul_f32 v248, 0x3fb8aa3b, v31
	ds_read_b128 v[68:71], v2 offset:19456
	s_waitcnt lgkmcnt(3)
	v_mfma_f32_32x32x8_bf16 v[104:119], v[216:217], v[220:221], 0
	v_mfma_f32_32x32x8_bf16 v[120:135], v[218:219], v[220:221], 0
	v_mfma_f32_32x32x8_bf16 v[72:87], v[212:213], v[220:221], v[72:87]
	s_nop 0
	v_mfma_f32_32x32x8_bf16 v[88:103], v[214:215], v[220:221], v[88:103]
	s_nop 5
	v_mfma_f32_32x32x16_bf16 v[104:119], v[56:59], a[0:3], v[104:119]
	buffer_load_dwordx4 v27, s[8:11], s89 offen offset:1024 lds
	ds_read_b128 v[56:59], v2 offset:20480
	s_waitcnt lgkmcnt(3)
	v_mfma_f32_32x32x16_bf16 v[104:119], v[60:63], a[4:7], v[104:119]
	buffer_load_dwordx4 a[172:175], v1, s[8:11], s94 offen offset:3072
	ds_read_b128 v[60:63], v2 offset:21504
	s_waitcnt lgkmcnt(3)
	v_mfma_f32_32x32x16_bf16 v[104:119], v[64:67], a[8:11], v[104:119]
	v_max3_f32 v249, v72, v73, v74
	v_min3_f32 v250, v72, v73, v74
	v_max3_f32 v249, v249, v75, v76
	v_min3_f32 v250, v250, v75, v76
	buffer_load_dwordx4 v27, s[8:11], s89 offen offset:2048 lds
	ds_read_b128 v[64:67], v2 offset:22528
	s_waitcnt lgkmcnt(3)
	v_mfma_f32_32x32x16_bf16 v[104:119], v[68:71], a[12:15], v[104:119]
	v_max3_f32 v249, v249, v77, v78
	v_min3_f32 v250, v250, v77, v78
	v_max3_f32 v249, v249, v79, v80
	v_min3_f32 v250, v250, v79, v80
	s_add_u32 s94, s32, 0x1000
	buffer_load_dwordx4 a[176:179], v1, s[8:11], s94 offen offset:0
	s_barrier
	ds_read_b128 v[68:71], v2 offset:23552
	s_waitcnt lgkmcnt(3)
	v_mfma_f32_32x32x16_bf16 v[104:119], v[56:59], a[16:19], v[104:119]
	v_max3_f32 v249, v249, v81, v82
	v_min3_f32 v250, v250, v81, v82
	v_max3_f32 v249, v249, v83, v84
	v_min3_f32 v250, v250, v83, v84
	ds_read_b128 v[56:59], v2 offset:24576
	s_waitcnt lgkmcnt(3)
	v_mfma_f32_32x32x16_bf16 v[104:119], v[60:63], a[20:23], v[104:119]
	v_max3_f32 v249, v249, v85, v86
	v_min3_f32 v250, v250, v85, v86
	v_max3_f32 v249, v249, v87, v88
	ds_read_b128 v[60:63], v2 offset:25600
	s_waitcnt lgkmcnt(3)
	v_mfma_f32_32x32x16_bf16 v[104:119], v[64:67], a[24:27], v[104:119]
	v_min3_f32 v250, v250, v87, v88
	v_max3_f32 v249, v249, v89, v90
	v_min3_f32 v250, v250, v89, v90
	v_max_f32 v249, v249, v91
	buffer_load_dwordx4 v27, s[8:11], s89 offen offset:3072 lds
	ds_read_b128 v[64:67], v2 offset:26624
	s_waitcnt lgkmcnt(3)
	v_mfma_f32_32x32x16_bf16 v[104:119], v[68:71], a[28:31], v[104:119]
	v_min_f32 v250, v250, v91
	v_mul_f32 v249, v248, v249
	v_mul_f32 v250, v248, v250
	v_fma_f32 v192, v72, v248, -v249
	ds_read_b128 v[68:71], v2 offset:27648
	s_waitcnt lgkmcnt(3)
	v_mfma_f32_32x32x16_bf16 v[104:119], v[56:59], a[32:35], v[104:119]
	v_fma_f32 v72, -v72, v248, v250
	v_fma_f32 v193, v73, v248, -v249
	v_fma_f32 v73, -v73, v248, v250
	v_exp_f32 v192, v192
	s_add_u32 s93, s42, 0x17e8000
	buffer_load_dword v0, v8, s[8:11], s93 offen offset:0 sc1
	ds_read_b128 v[56:59], v2 offset:28672
	s_waitcnt lgkmcnt(3)
	v_mfma_f32_32x32x16_bf16 v[104:119], v[60:63], a[36:39], v[104:119]
	v_exp_f32 v72, v72
	v_fma_f32 v194, v74, v248, -v249
	v_fma_f32 v74, -v74, v248, v250
	s_add_u32 s93, s42, 0x17e8000
	buffer_load_dword v0, v9, s[8:11], s93 offen offset:0 sc1
	ds_read_b128 v[60:63], v2 offset:29696
	s_waitcnt lgkmcnt(3)
	v_mfma_f32_32x32x16_bf16 v[104:119], v[64:67], a[40:43], v[104:119]
	v_exp_f32 v193, v193
	v_exp_f32 v73, v73
	v_fma_f32 v195, v75, v248, -v249
	v_fma_f32 v75, -v75, v248, v250
	s_add_u32 s93, s42, 0x17e8000
	buffer_load_dword v0, v10, s[8:11], s93 offen offset:0 sc1
	ds_read_b128 v[64:67], v2 offset:30720
	s_waitcnt lgkmcnt(3)
	v_mfma_f32_32x32x16_bf16 v[104:119], v[68:71], a[44:47], v[104:119]
	v_exp_f32 v194, v194
	v_exp_f32 v74, v74
	v_add_f32 v251, v192, v193
	v_add_f32 v252, v72, v73
	buffer_load_dwordx4 a[180:183], v1, s[8:11], s94 offen offset:1024
	ds_read_b128 v[68:71], v2 offset:31744
	s_waitcnt lgkmcnt(3)
	v_mfma_f32_32x32x16_bf16 v[104:119], v[56:59], a[48:51], v[104:119]
	v_fma_f32 v196, v76, v248, -v249
	v_fma_f32 v76, -v76, v248, v250
	v_exp_f32 v195, v195
	v_exp_f32 v75, v75
	buffer_load_dwordx4 a[184:187], v1, s[8:11], s94 offen offset:2048
	ds_read_b128 v[56:59], v2 offset:32768
	s_waitcnt lgkmcnt(3)
	v_mfma_f32_32x32x16_bf16 v[104:119], v[60:63], a[52:55], v[104:119]
	v_add_f32 v251, v251, v194
	v_add_f32 v252, v252, v74
	v_fma_f32 v197, v77, v248, -v249
	ds_read_b128 v[60:63], v2 offset:33792
	s_waitcnt lgkmcnt(3)
	v_mfma_f32_32x32x16_bf16 v[104:119], v[64:67], a[56:59], v[104:119]
	v_fma_f32 v77, -v77, v248, v250
	v_exp_f32 v196, v196
	v_exp_f32 v76, v76
	v_add_f32 v251, v251, v195
	buffer_load_dwordx4 a[188:191], v1, s[8:11], s94 offen offset:3072
	ds_read_b128 v[64:67], v2 offset:34816
	s_waitcnt lgkmcnt(3)
	v_mfma_f32_32x32x16_bf16 v[104:119], v[68:71], a[60:63], v[104:119]
	v_add_f32 v252, v252, v75
	v_fma_f32 v198, v78, v248, -v249
	v_fma_f32 v78, -v78, v248, v250
	v_exp_f32 v197, v197
	ds_read_b128 v[68:71], v2 offset:35840
	s_waitcnt lgkmcnt(3)
	v_mfma_f32_32x32x16_bf16 v[104:119], v[56:59], a[64:67], v[104:119]
	v_exp_f32 v77, v77
	v_add_f32 v251, v251, v196
	v_add_f32 v252, v252, v76
	v_fma_f32 v199, v79, v248, -v249
	ds_read_b128 v[56:59], v2 offset:36864
	s_waitcnt lgkmcnt(3)
	v_mfma_f32_32x32x16_bf16 v[104:119], v[60:63], a[68:71], v[104:119]
	v_fma_f32 v79, -v79, v248, v250
	v_exp_f32 v198, v198
	v_exp_f32 v78, v78
	ds_read_b128 v[60:63], v2 offset:37888
	s_waitcnt lgkmcnt(3)
	v_mfma_f32_32x32x16_bf16 v[104:119], v[64:67], a[72:75], v[104:119]
	v_add_f32 v251, v251, v197
	v_add_f32 v252, v252, v77
	v_fma_f32 v200, v80, v248, -v249
	v_fma_f32 v80, -v80, v248, v250
	s_add_u32 s94, s32, 0x2000
	buffer_load_dwordx4 a[192:195], v1, s[8:11], s94 offen offset:0
	ds_read_b128 v[64:67], v2 offset:38912
	s_waitcnt lgkmcnt(3)
	v_mfma_f32_32x32x16_bf16 v[104:119], v[68:71], a[76:79], v[104:119]
	v_exp_f32 v199, v199
	v_exp_f32 v79, v79
	v_add_f32 v251, v251, v198
	v_add_f32 v252, v252, v78
	ds_read_b128 v[68:71], v2 offset:39936
	s_waitcnt lgkmcnt(3)
	v_mfma_f32_32x32x16_bf16 v[104:119], v[56:59], a[80:83], v[104:119]
	v_fma_f32 v201, v81, v248, -v249
	v_fma_f32 v81, -v81, v248, v250
	v_exp_f32 v200, v200
	ds_read_b128 v[56:59], v2 offset:40960
	s_waitcnt lgkmcnt(3)
	v_mfma_f32_32x32x16_bf16 v[104:119], v[60:63], a[84:87], v[104:119]
	v_exp_f32 v80, v80
	v_add_f32 v251, v251, v199
	v_add_f32 v252, v252, v79
	v_fma_f32 v202, v82, v248, -v249
	buffer_load_dwordx4 a[196:199], v1, s[8:11], s94 offen offset:1024
	ds_read_b128 v[60:63], v2 offset:41984
	s_waitcnt lgkmcnt(3)
	v_mfma_f32_32x32x16_bf16 v[104:119], v[64:67], a[88:91], v[104:119]
	v_fma_f32 v82, -v82, v248, v250
	v_exp_f32 v201, v201
	v_exp_f32 v81, v81
	v_add_f32 v251, v251, v200
	ds_read_b128 v[64:67], v2 offset:43008
	s_waitcnt lgkmcnt(3)
	v_mfma_f32_32x32x16_bf16 v[104:119], v[68:71], a[92:95], v[104:119]
	v_add_f32 v252, v252, v80
	v_fma_f32 v203, v83, v248, -v249
	v_fma_f32 v83, -v83, v248, v250
	v_exp_f32 v202, v202
	buffer_load_dwordx4 a[200:203], v1, s[8:11], s94 offen offset:2048
	ds_read_b128 v[68:71], v2 offset:44032
	s_waitcnt lgkmcnt(3)
	v_mfma_f32_32x32x16_bf16 v[104:119], v[56:59], a[96:99], v[104:119]
	v_exp_f32 v82, v82
	v_add_f32 v251, v251, v201
	v_add_f32 v252, v252, v81
	ds_read_b128 v[56:59], v2 offset:45056
	s_waitcnt lgkmcnt(3)
	v_mfma_f32_32x32x16_bf16 v[104:119], v[60:63], a[100:103], v[104:119]
	v_fma_f32 v204, v84, v248, -v249
	v_fma_f32 v84, -v84, v248, v250
	v_exp_f32 v203, v203
	v_exp_f32 v83, v83
	ds_read_b128 v[60:63], v2 offset:46080
	s_waitcnt lgkmcnt(3)
	v_mfma_f32_32x32x16_bf16 v[104:119], v[64:67], a[104:107], v[104:119]
	v_add_f32 v251, v251, v202
	v_add_f32 v252, v252, v82
	v_fma_f32 v205, v85, v248, -v249
	v_fma_f32 v85, -v85, v248, v250
	buffer_load_dwordx4 a[204:207], v1, s[8:11], s94 offen offset:3072
	ds_read_b128 v[64:67], v2 offset:47104
	s_waitcnt lgkmcnt(3)
	v_mfma_f32_32x32x16_bf16 v[104:119], v[68:71], a[108:111], v[104:119]
	v_exp_f32 v204, v204
	v_exp_f32 v84, v84
	v_add_f32 v251, v251, v203
	v_add_f32 v252, v252, v83
	ds_read_b128 v[68:71], v2 offset:48128
	s_waitcnt lgkmcnt(3)
	v_mfma_f32_32x32x16_bf16 v[104:119], v[56:59], a[112:115], v[104:119]
	v_fma_f32 v206, v86, v248, -v249
	v_fma_f32 v86, -v86, v248, v250
	v_exp_f32 v205, v205
	s_add_u32 s94, s32, 0x3000
	buffer_load_dwordx4 a[208:211], v1, s[8:11], s94 offen offset:0
	ds_read_b128 v[56:59], v2 offset:49152
	s_waitcnt lgkmcnt(3)
	v_mfma_f32_32x32x16_bf16 v[104:119], v[60:63], a[116:119], v[104:119]
	v_exp_f32 v85, v85
	v_add_f32 v251, v251, v204
	v_add_f32 v252, v252, v84
	v_fma_f32 v207, v87, v248, -v249
	ds_read_b128 v[60:63], v2 offset:50176
	s_waitcnt lgkmcnt(3)
	v_mfma_f32_32x32x16_bf16 v[104:119], v[64:67], a[120:123], v[104:119]
	v_fma_f32 v87, -v87, v248, v250
	v_exp_f32 v206, v206
	v_exp_f32 v86, v86
	v_add_f32 v251, v251, v205
	ds_read_b128 v[64:67], v2 offset:51200
	s_waitcnt lgkmcnt(3)
	v_mfma_f32_32x32x16_bf16 v[104:119], v[68:71], a[124:127], v[104:119]
	v_add_f32 v252, v252, v85
	v_fma_f32 v208, v88, v248, -v249
	v_fma_f32 v88, -v88, v248, v250
	v_exp_f32 v207, v207
	ds_read_b128 v[68:71], v2 offset:52224
	s_waitcnt lgkmcnt(3)
	v_mfma_f32_32x32x16_bf16 v[104:119], v[56:59], a[128:131], v[104:119]
	v_exp_f32 v87, v87
	v_add_f32 v251, v251, v206
	v_add_f32 v252, v252, v86
	ds_read_b128 v[56:59], v2 offset:53248
	s_waitcnt lgkmcnt(3)
	v_mfma_f32_32x32x16_bf16 v[104:119], v[60:63], a[132:135], v[104:119]
	v_fma_f32 v209, v89, v248, -v249
	v_fma_f32 v89, -v89, v248, v250
	v_exp_f32 v208, v208
	v_exp_f32 v88, v88
	buffer_load_dwordx4 a[212:215], v1, s[8:11], s94 offen offset:1024
	ds_read_b128 v[60:63], v2 offset:54272
	s_waitcnt lgkmcnt(3)
	v_mfma_f32_32x32x16_bf16 v[104:119], v[64:67], a[136:139], v[104:119]
	v_add_f32 v251, v251, v207
	v_add_f32 v252, v252, v87
	v_fma_f32 v210, v90, v248, -v249
	v_fma_f32 v90, -v90, v248, v250
	ds_read_b128 v[64:67], v2 offset:55296
	s_waitcnt lgkmcnt(3)
	v_mfma_f32_32x32x16_bf16 v[104:119], v[68:71], a[140:143], v[104:119]
	v_exp_f32 v209, v209
	v_exp_f32 v89, v89
	v_add_f32 v251, v251, v208
	v_add_f32 v252, v252, v88
	buffer_load_dwordx4 a[216:219], v1, s[8:11], s94 offen offset:2048
	ds_read_b128 v[68:71], v2 offset:56320
	s_waitcnt lgkmcnt(3)
	v_mfma_f32_32x32x16_bf16 v[104:119], v[56:59], a[144:147], v[104:119]
	v_fma_f32 v211, v91, v248, -v249
	v_fma_f32 v91, -v91, v248, v250
	v_exp_f32 v210, v210
	s_waitcnt lgkmcnt(2)
	v_mfma_f32_32x32x16_bf16 v[104:119], v[60:63], a[148:151], v[104:119]
	v_exp_f32 v90, v90
	v_add_f32 v251, v251, v209
	v_add_f32 v252, v252, v89
	v_exp_f32 v211, v211
	buffer_load_dwordx4 a[220:223], v1, s[8:11], s94 offen offset:3072
	s_waitcnt lgkmcnt(1)
	v_mfma_f32_32x32x16_bf16 v[104:119], v[64:67], a[152:155], v[104:119]
	v_exp_f32 v91, v91
	v_add_f32 v251, v251, v210
	v_add_f32 v252, v252, v90
	v_add_f32 v251, v251, v211
	s_waitcnt lgkmcnt(0)
	v_mfma_f32_32x32x16_bf16 v[104:119], v[68:71], a[156:159], v[104:119]
	v_add_f32 v252, v252, v91
	v_rcp_f32 v251, v251
	v_rcp_f32 v252, v252
	s_add_u32 s94, s32, 0x4000
	buffer_load_dwordx4 a[224:227], v1, s[8:11], s94 offen offset:0
	v_pk_mul_f32 v[192:193], v[192:193], v[250:251] op_sel:[0,1] op_sel_hi:[1,1]
	v_cvt_pk_bf16_f32 v152, v192, v193
	v_pk_mul_f32 v[194:195], v[194:195], v[250:251] op_sel:[0,1] op_sel_hi:[1,1]
	v_cvt_pk_bf16_f32 v153, v194, v195
	v_pk_mul_f32 v[196:197], v[196:197], v[250:251] op_sel:[0,1] op_sel_hi:[1,1]
	v_cvt_pk_bf16_f32 v154, v196, v197
	v_pk_mul_f32 v[198:199], v[198:199], v[250:251] op_sel:[0,1] op_sel_hi:[1,1]
	v_cvt_pk_bf16_f32 v155, v198, v199
	ds_write_b128 v20, v[152:155] offset:0
	v_pk_mul_f32 v[200:201], v[200:201], v[250:251] op_sel:[0,1] op_sel_hi:[1,1]
	buffer_load_dwordx4 a[228:231], v1, s[8:11], s94 offen offset:1024
	v_cvt_pk_bf16_f32 v156, v200, v201
	v_pk_mul_f32 v[202:203], v[202:203], v[250:251] op_sel:[0,1] op_sel_hi:[1,1]
	v_cvt_pk_bf16_f32 v157, v202, v203
	v_pk_mul_f32 v[204:205], v[204:205], v[250:251] op_sel:[0,1] op_sel_hi:[1,1]
	v_cvt_pk_bf16_f32 v158, v204, v205
	v_pk_mul_f32 v[206:207], v[206:207], v[250:251] op_sel:[0,1] op_sel_hi:[1,1]
	v_cvt_pk_bf16_f32 v159, v206, v207
	ds_write_b128 v20, v[156:159] offset:16
	v_pk_mul_f32 v[208:209], v[208:209], v[250:251] op_sel:[0,1] op_sel_hi:[1,1]
	v_cvt_pk_bf16_f32 v160, v208, v209
	buffer_load_dwordx4 a[232:235], v1, s[8:11], s94 offen offset:2048
	v_pk_mul_f32 v[210:211], v[210:211], v[250:251] op_sel:[0,1] op_sel_hi:[1,1]
	v_cvt_pk_bf16_f32 v161, v210, v211
	v_pk_mul_f32 v[72:73], v[72:73], v[252:253] op_sel:[0,0] op_sel_hi:[1,0]
	v_cvt_pk_bf16_f32 v162, v72, v73
	v_pk_mul_f32 v[74:75], v[74:75], v[252:253] op_sel:[0,0] op_sel_hi:[1,0]
	v_cvt_pk_bf16_f32 v163, v74, v75
	ds_write_b128 v20, v[160:163] offset:32
	v_pk_mul_f32 v[76:77], v[76:77], v[252:253] op_sel:[0,0] op_sel_hi:[1,0]
	v_cvt_pk_bf16_f32 v164, v76, v77
	v_pk_mul_f32 v[78:79], v[78:79], v[252:253] op_sel:[0,0] op_sel_hi:[1,0]
	v_cvt_pk_bf16_f32 v165, v78, v79
	v_pk_mul_f32 v[80:81], v[80:81], v[252:253] op_sel:[0,0] op_sel_hi:[1,0]
	v_cvt_pk_bf16_f32 v166, v80, v81
	v_pk_mul_f32 v[82:83], v[82:83], v[252:253] op_sel:[0,0] op_sel_hi:[1,0]
	v_cvt_pk_bf16_f32 v167, v82, v83
	ds_write_b128 v20, v[164:167] offset:48
	v_pk_mul_f32 v[84:85], v[84:85], v[252:253] op_sel:[0,0] op_sel_hi:[1,0]
	v_cvt_pk_bf16_f32 v168, v84, v85
	v_pk_mul_f32 v[86:87], v[86:87], v[252:253] op_sel:[0,0] op_sel_hi:[1,0]
	v_cvt_pk_bf16_f32 v169, v86, v87
	buffer_load_dwordx4 a[236:239], v1, s[8:11], s94 offen offset:3072
	v_pk_mul_f32 v[88:89], v[88:89], v[252:253] op_sel:[0,0] op_sel_hi:[1,0]
	v_cvt_pk_bf16_f32 v170, v88, v89
	v_pk_mul_f32 v[90:91], v[90:91], v[252:253] op_sel:[0,0] op_sel_hi:[1,0]
	v_cvt_pk_bf16_f32 v171, v90, v91
	ds_write_b128 v20, v[168:171] offset:64
	v_pk_mul_f32 v[92:93], v[92:93], v[30:31] op_sel:[0,1] op_sel_hi:[1,1]
	v_cvt_pk_bf16_f32 v172, v92, v93
	v_pk_mul_f32 v[94:95], v[94:95], v[30:31] op_sel:[0,1] op_sel_hi:[1,1]
	v_cvt_pk_bf16_f32 v173, v94, v95
	v_pk_mul_f32 v[96:97], v[96:97], v[30:31] op_sel:[0,1] op_sel_hi:[1,1]
	v_cvt_pk_bf16_f32 v174, v96, v97
	v_pk_mul_f32 v[98:99], v[98:99], v[30:31] op_sel:[0,1] op_sel_hi:[1,1]
	v_cvt_pk_bf16_f32 v175, v98, v99
	v_pk_mul_f32 v[100:101], v[100:101], v[30:31] op_sel:[0,1] op_sel_hi:[1,1]
	v_cvt_pk_bf16_f32 v176, v100, v101
	s_add_u32 s94, s32, 0x5000
	buffer_load_dwordx4 a[240:243], v1, s[8:11], s94 offen offset:0
	v_pk_mul_f32 v[102:103], v[102:103], v[30:31] op_sel:[0,1] op_sel_hi:[1,1]
	v_cvt_pk_bf16_f32 v177, v102, v103
	v_mov_b32 v182, 0x3f80
	v_mov_b32 v183, 0
	ds_write_b128 v20, v[172:175] offset:80
	v_pk_mul_f32 v[104:105], v[104:105], v[30:31] op_sel:[0,1] op_sel_hi:[1,1]
	v_cvt_pk_bf16_f32 v178, v104, v105
	v_pk_mul_f32 v[106:107], v[106:107], v[30:31] op_sel:[0,1] op_sel_hi:[1,1]
	v_cvt_pk_bf16_f32 v179, v106, v107
	v_pk_mul_f32 v[108:109], v[108:109], v[30:31] op_sel:[0,1] op_sel_hi:[1,1]
	v_cvt_pk_bf16_f32 v180, v108, v109
	v_pk_mul_f32 v[110:111], v[110:111], v[30:31] op_sel:[0,1] op_sel_hi:[1,1]
	v_cvt_pk_bf16_f32 v181, v110, v111
	ds_write_b128 v20, v[176:179] offset:96
	ds_write_b128 v20, v[180:183] offset:112
	s_waitcnt lgkmcnt(0)
	s_waitcnt vmcnt(19)
	s_barrier
	ds_read_b64_tr_b16 v[196:197], v22 offset:0
	ds_read_b64_tr_b16 v[198:199], v22 offset:2560
	ds_read_b64_tr_b16 v[184:185], v21 offset:0
	ds_read_b64_tr_b16 v[186:187], v21 offset:2560
	ds_read_b64_tr_b16 v[188:189], v21 offset:32
	ds_read_b64_tr_b16 v[190:191], v21 offset:2592
	ds_read_b64_tr_b16 v[192:193], v21 offset:64
	ds_read_b64_tr_b16 v[194:195], v21 offset:2624
	buffer_load_dwordx4 a[244:247], v1, s[8:11], s94 offen offset:1024
	ds_read_b64_tr_b16 v[212:213], v22 offset:5120
	ds_read_b64_tr_b16 v[214:215], v22 offset:7680
	ds_read_b64_tr_b16 v[200:201], v21 offset:5120
	ds_read_b64_tr_b16 v[202:203], v21 offset:7680
	ds_read_b64_tr_b16 v[204:205], v21 offset:5152
	ds_read_b64_tr_b16 v[206:207], v21 offset:7712
	ds_read_b64_tr_b16 v[208:209], v21 offset:5184
	ds_read_b64_tr_b16 v[210:211], v21 offset:7744
	s_waitcnt lgkmcnt(12)
	v_mfma_f32_16x16x32_bf16 v[72:75], v[184:187], v[196:199], 0
	s_waitcnt lgkmcnt(10)
	v_mfma_f32_16x16x32_bf16 v[76:79], v[188:191], v[196:199], 0
	s_waitcnt lgkmcnt(8)
	v_mfma_f32_16x16x32_bf16 v[80:83], v[192:195], v[196:199], 0
	buffer_load_dwordx4 a[248:251], v1, s[8:11], s94 offen offset:2048
	ds_read_b64_tr_b16 v[228:229], v22 offset:10240
	ds_read_b64_tr_b16 v[230:231], v22 offset:12800
	ds_read_b64_tr_b16 v[216:217], v21 offset:10240
	ds_read_b64_tr_b16 v[218:219], v21 offset:12800
	ds_read_b64_tr_b16 v[220:221], v21 offset:10272
	ds_read_b64_tr_b16 v[222:223], v21 offset:12832
	ds_read_b64_tr_b16 v[224:225], v21 offset:10304
	ds_read_b64_tr_b16 v[226:227], v21 offset:12864
	s_waitcnt lgkmcnt(12)
	v_mfma_f32_16x16x32_bf16 v[72:75], v[200:203], v[212:215], v[72:75]
	s_waitcnt lgkmcnt(10)
	v_mfma_f32_16x16x32_bf16 v[76:79], v[204:207], v[212:215], v[76:79]
	s_waitcnt lgkmcnt(8)
	v_mfma_f32_16x16x32_bf16 v[80:83], v[208:211], v[212:215], v[80:83]
	buffer_load_dwordx4 a[252:255], v1, s[8:11], s94 offen offset:3072
	ds_read_b64_tr_b16 v[244:245], v22 offset:15360
	ds_read_b64_tr_b16 v[246:247], v22 offset:17920
	ds_read_b64_tr_b16 v[232:233], v21 offset:15360
	ds_read_b64_tr_b16 v[234:235], v21 offset:17920
	ds_read_b64_tr_b16 v[236:237], v21 offset:15392
	ds_read_b64_tr_b16 v[238:239], v21 offset:17952
	ds_read_b64_tr_b16 v[240:241], v21 offset:15424
	ds_read_b64_tr_b16 v[242:243], v21 offset:17984
	s_waitcnt lgkmcnt(12)
	v_mfma_f32_16x16x32_bf16 v[72:75], v[216:219], v[228:231], v[72:75]
	s_waitcnt lgkmcnt(10)
	v_mfma_f32_16x16x32_bf16 v[76:79], v[220:223], v[228:231], v[76:79]
	s_waitcnt lgkmcnt(8)
	v_mfma_f32_16x16x32_bf16 v[80:83], v[224:227], v[228:231], v[80:83]
	s_add_u32 s93, s43, 0x17e8000
	buffer_load_dword v0, v11, s[8:11], s93 offen offset:0 sc1
	s_waitcnt lgkmcnt(4)
	v_mfma_f32_16x16x32_bf16 v[72:75], v[232:235], v[244:247], v[72:75]
	s_waitcnt lgkmcnt(2)
	v_mfma_f32_16x16x32_bf16 v[76:79], v[236:239], v[244:247], v[76:79]
	s_waitcnt lgkmcnt(0)
	v_mfma_f32_16x16x32_bf16 v[80:83], v[240:243], v[244:247], v[80:83]
	ds_read_b128 v[56:59], v2 offset:57344
	ds_read_b128 v[60:63], v2 offset:58368
	ds_read_b128 v[64:67], v2 offset:59392
	s_nop 0
	v_cvt_pk_bf16_f32 v88, v72, v73
	v_cvt_pk_bf16_f32 v89, v74, v75
	v_cvt_pk_bf16_f32 v90, v76, v77
	v_cvt_pk_bf16_f32 v91, v78, v79
	v_cvt_pk_bf16_f32 v92, v80, v81
	v_cvt_pk_bf16_f32 v93, v82, v83
	v_min_u32 v88, 0xfffffffe, v88
	v_min_u32 v89, 0xfffffffe, v89
	v_min_u32 v90, 0xfffffffe, v90
	v_min_u32 v91, 0xfffffffe, v91
	v_min_u32 v92, 0xfffffffe, v92
	v_min_u32 v93, 0xfffffffe, v93
	s_add_u32 s28, s36, 0x2468000
	buffer_store_dwordx4 v[88:91], v17, s[8:11], s28 offen sc1
	buffer_store_dwordx2 v[92:93], v18, s[8:11], s28 offen sc1
	ds_read_b128 v[68:71], v2 offset:60416
	s_waitcnt lgkmcnt(3)
	v_mfma_f32_32x32x16_bf16 v[120:135], v[56:59], a[0:3], v[120:135]
	s_add_u32 s93, s43, 0x17e8000
	buffer_load_dword v0, v11, s[8:11], s93 offen offset:512 sc1
	ds_read_b128 v[56:59], v2 offset:61440
	s_waitcnt lgkmcnt(3)
	v_mfma_f32_32x32x16_bf16 v[120:135], v[60:63], a[4:7], v[120:135]
	s_add_u32 s93, s43, 0x17e8000
	buffer_load_dword v0, v11, s[8:11], s93 offen offset:1024 sc1
	ds_read_b128 v[60:63], v2 offset:62464
	s_waitcnt lgkmcnt(3)
	v_mfma_f32_32x32x16_bf16 v[120:135], v[64:67], a[8:11], v[120:135]
	s_add_u32 s93, s43, 0x17e8000
	buffer_load_dword v0, v11, s[8:11], s93 offen offset:1536 sc1
	ds_read_b128 v[64:67], v2 offset:63488
	s_waitcnt lgkmcnt(3)
	v_mfma_f32_32x32x16_bf16 v[120:135], v[68:71], a[12:15], v[120:135]
	s_add_u32 s93, s43, 0x17e8000
	buffer_load_dword v0, v11, s[8:11], s93 offen offset:2048 sc1
	ds_read_b128 v[68:71], v2 offset:64512
	s_waitcnt lgkmcnt(3)
	v_mfma_f32_32x32x16_bf16 v[120:135], v[56:59], a[16:19], v[120:135]
	s_add_u32 s93, s43, 0x17e8000
	buffer_load_dword v0, v11, s[8:11], s93 offen offset:2560 sc1
	ds_read_b128 v[56:59], v3 offset:0
	s_waitcnt lgkmcnt(3)
	v_mfma_f32_32x32x16_bf16 v[120:135], v[60:63], a[20:23], v[120:135]
	s_add_u32 s93, s40, 0x8e8000
	buffer_load_dwordx4 v[46:49], v4, s[8:11], s93 offen offset:0 sc1
	ds_read_b128 v[60:63], v3 offset:1024
	s_waitcnt lgkmcnt(3)
	v_mfma_f32_32x32x16_bf16 v[120:135], v[64:67], a[24:27], v[120:135]
	s_add_u32 s93, s40, 0x8e8000
	buffer_load_dwordx4 v[50:53], v4, s[8:11], s93 offen offset:2048 sc1
	ds_read_b128 v[64:67], v3 offset:2048
	s_waitcnt lgkmcnt(3)
	v_mfma_f32_32x32x16_bf16 v[120:135], v[68:71], a[28:31], v[120:135]
	s_add_u32 s93, s40, 0x8e8000
	buffer_load_dwordx2 v[54:55], v5, s[8:11], s93 offen sc1
	ds_read_b128 v[68:71], v3 offset:3072
	s_waitcnt lgkmcnt(3)
	v_mfma_f32_32x32x16_bf16 v[120:135], v[56:59], a[32:35], v[120:135]
	s_add_u32 s89, s31, 0
	s_add_u32 m0, s39, 0xc000
	s_nop 0
	buffer_load_dwordx4 v1, s[8:11], s89 offen offset:0 lds
	ds_read_b128 v[56:59], v3 offset:4096
	s_waitcnt lgkmcnt(3)
	v_mfma_f32_32x32x16_bf16 v[120:135], v[60:63], a[36:39], v[120:135]
	buffer_load_dwordx4 v1, s[8:11], s89 offen offset:1024 lds
	ds_read_b128 v[60:63], v3 offset:5120
	s_waitcnt lgkmcnt(3)
	v_mfma_f32_32x32x16_bf16 v[120:135], v[64:67], a[40:43], v[120:135]
	ds_read_b128 v[64:67], v3 offset:6144
	s_waitcnt lgkmcnt(3)
	v_mfma_f32_32x32x16_bf16 v[120:135], v[68:71], a[44:47], v[120:135]
	ds_read_b128 v[68:71], v3 offset:7168
	s_waitcnt lgkmcnt(3)
	v_mfma_f32_32x32x16_bf16 v[120:135], v[56:59], a[48:51], v[120:135]
	ds_read_b128 v[56:59], v3 offset:8192
	s_waitcnt lgkmcnt(3)
	v_mfma_f32_32x32x16_bf16 v[120:135], v[60:63], a[52:55], v[120:135]
	buffer_load_dwordx4 v1, s[8:11], s89 offen offset:2048 lds
	ds_read_b128 v[60:63], v3 offset:9216
	s_waitcnt lgkmcnt(3)
	v_mfma_f32_32x32x16_bf16 v[120:135], v[64:67], a[56:59], v[120:135]
	ds_read_b128 v[64:67], v3 offset:10240
	s_waitcnt lgkmcnt(3)
	v_mfma_f32_32x32x16_bf16 v[120:135], v[68:71], a[60:63], v[120:135]
	buffer_load_dwordx4 v1, s[8:11], s89 offen offset:3072 lds
	ds_read_b128 v[68:71], v3 offset:11264
	s_waitcnt lgkmcnt(3)
	v_mfma_f32_32x32x16_bf16 v[120:135], v[56:59], a[64:67], v[120:135]
	s_add_u32 s89, s31, 0x4000
	s_add_u32 m0, s39, 0x10000
	s_nop 0
	buffer_load_dwordx4 v1, s[8:11], s89 offen offset:0 lds
	ds_read_b128 v[56:59], v3 offset:12288
	s_waitcnt lgkmcnt(3)
	v_mfma_f32_32x32x16_bf16 v[120:135], v[60:63], a[68:71], v[120:135]
	ds_read_b128 v[60:63], v3 offset:13312
	s_waitcnt lgkmcnt(3)
	v_mfma_f32_32x32x16_bf16 v[120:135], v[64:67], a[72:75], v[120:135]
	ds_read_b128 v[64:67], v3 offset:14336
	s_waitcnt lgkmcnt(3)
	v_mfma_f32_32x32x16_bf16 v[120:135], v[68:71], a[76:79], v[120:135]
	ds_read_b128 v[68:71], v3 offset:15360
	s_waitcnt lgkmcnt(3)
	v_mfma_f32_32x32x16_bf16 v[120:135], v[56:59], a[80:83], v[120:135]
	ds_read_b128 v[56:59], v3 offset:16384
	s_waitcnt lgkmcnt(3)
	v_mfma_f32_32x32x16_bf16 v[120:135], v[60:63], a[84:87], v[120:135]
	ds_read_b128 v[60:63], v3 offset:17408
	s_waitcnt lgkmcnt(3)
	v_mfma_f32_32x32x16_bf16 v[120:135], v[64:67], a[88:91], v[120:135]
	buffer_load_dwordx4 v1, s[8:11], s89 offen offset:1024 lds
	ds_read_b128 v[64:67], v3 offset:18432
	s_waitcnt lgkmcnt(3)
	v_mfma_f32_32x32x16_bf16 v[120:135], v[68:71], a[92:95], v[120:135]
	buffer_load_dwordx4 v1, s[8:11], s89 offen offset:2048 lds
	ds_read_b128 v[68:71], v3 offset:19456
	s_waitcnt lgkmcnt(3)
	v_mfma_f32_32x32x16_bf16 v[120:135], v[56:59], a[96:99], v[120:135]
	buffer_load_dwordx4 v1, s[8:11], s89 offen offset:3072 lds
	ds_read_b128 v[56:59], v3 offset:20480
	s_waitcnt lgkmcnt(3)
	v_mfma_f32_32x32x16_bf16 v[120:135], v[60:63], a[100:103], v[120:135]
	ds_read_b128 v[60:63], v3 offset:21504
	s_waitcnt lgkmcnt(3)
	v_mfma_f32_32x32x16_bf16 v[120:135], v[64:67], a[104:107], v[120:135]
	ds_read_b128 v[64:67], v3 offset:22528
	s_waitcnt lgkmcnt(3)
	v_mfma_f32_32x32x16_bf16 v[120:135], v[68:71], a[108:111], v[120:135]
	ds_read_b128 v[68:71], v3 offset:23552
	s_waitcnt lgkmcnt(3)
	v_mfma_f32_32x32x16_bf16 v[120:135], v[56:59], a[112:115], v[120:135]
	ds_read_b128 v[56:59], v3 offset:24576
	s_waitcnt lgkmcnt(3)
	v_mfma_f32_32x32x16_bf16 v[120:135], v[60:63], a[116:119], v[120:135]
	ds_read_b128 v[60:63], v3 offset:25600
	s_waitcnt lgkmcnt(3)
	v_mfma_f32_32x32x16_bf16 v[120:135], v[64:67], a[120:123], v[120:135]
	ds_read_b128 v[64:67], v3 offset:26624
	s_waitcnt lgkmcnt(3)
	v_mfma_f32_32x32x16_bf16 v[120:135], v[68:71], a[124:127], v[120:135]
	ds_read_b128 v[68:71], v3 offset:27648
	s_waitcnt lgkmcnt(3)
	v_mfma_f32_32x32x16_bf16 v[120:135], v[56:59], a[128:131], v[120:135]
	ds_read_b128 v[56:59], v3 offset:28672
	s_waitcnt lgkmcnt(3)
	v_mfma_f32_32x32x16_bf16 v[120:135], v[60:63], a[132:135], v[120:135]
	ds_read_b128 v[60:63], v3 offset:29696
	s_waitcnt lgkmcnt(3)
	v_mfma_f32_32x32x16_bf16 v[120:135], v[64:67], a[136:139], v[120:135]
	ds_read_b128 v[64:67], v3 offset:30720
	s_waitcnt lgkmcnt(3)
	v_mfma_f32_32x32x16_bf16 v[120:135], v[68:71], a[140:143], v[120:135]
	ds_read_b128 v[68:71], v3 offset:31744
	s_waitcnt lgkmcnt(3)
	v_mfma_f32_32x32x16_bf16 v[120:135], v[56:59], a[144:147], v[120:135]
	s_add_u32 s88, s37, 0x2468000
	buffer_load_dwordx4 v[184:187], v19, s[8:11], s88 offen sc1
	s_waitcnt lgkmcnt(2)
	v_mfma_f32_32x32x16_bf16 v[120:135], v[60:63], a[148:151], v[120:135]
	s_waitcnt lgkmcnt(1)
	v_mfma_f32_32x32x16_bf16 v[120:135], v[64:67], a[152:155], v[120:135]
	s_add_u32 s88, s37, 0x2468d80
	buffer_load_dwordx4 v[188:191], v19, s[8:11], s88 offen sc1
	s_waitcnt lgkmcnt(0)
	v_mfma_f32_32x32x16_bf16 v[120:135], v[68:71], a[156:159], v[120:135]
	v_max3_f32 v249, v112, v113, v114
	v_min3_f32 v250, v112, v113, v114
	v_max3_f32 v249, v249, v115, v116
	v_min3_f32 v250, v250, v115, v116
	v_max3_f32 v249, v249, v117, v118
	s_add_u32 s88, s37, 0x2469b00
	buffer_load_dwordx4 v[192:195], v19, s[8:11], s88 offen sc1
	v_min3_f32 v250, v250, v117, v118
	s_nop 3
	v_max3_f32 v249, v249, v119, v120
	v_min3_f32 v250, v250, v119, v120
	v_max3_f32 v249, v249, v121, v122
	v_min3_f32 v250, v250, v121, v122
	v_max3_f32 v249, v249, v123, v124
	v_min3_f32 v250, v250, v123, v124
	v_max3_f32 v249, v249, v125, v126
	v_min3_f32 v250, v250, v125, v126
	v_max3_f32 v249, v249, v127, v128
	v_min3_f32 v250, v250, v127, v128
	v_max3_f32 v249, v249, v129, v130
	v_min3_f32 v250, v250, v129, v130
	v_max_f32 v249, v249, v131
	v_min_f32 v250, v250, v131
	s_add_u32 s88, s37, 0x246a880
	buffer_load_dwordx4 v[196:199], v19, s[8:11], s88 offen sc1
	v_mul_f32 v249, v248, v249
	v_mul_f32 v250, v248, v250
	v_pk_fma_f32 v[88:89], v[112:113], v[248:249], v[248:249] op_sel:[0,0,1] op_sel_hi:[1,0,1] neg_lo:[0,0,1] neg_hi:[0,0,1]
	v_pk_fma_f32 v[112:113], v[112:113], v[248:249], v[250:251] op_sel:[0,0,0] op_sel_hi:[1,0,0] neg_lo:[1,0,0] neg_hi:[1,0,0]
	v_pk_fma_f32 v[90:91], v[114:115], v[248:249], v[248:249] op_sel:[0,0,1] op_sel_hi:[1,0,1] neg_lo:[0,0,1] neg_hi:[0,0,1]
	v_pk_fma_f32 v[114:115], v[114:115], v[248:249], v[250:251] op_sel:[0,0,0] op_sel_hi:[1,0,0] neg_lo:[1,0,0] neg_hi:[1,0,0]
	v_exp_f32 v88, v88
	v_exp_f32 v89, v89
	v_exp_f32 v112, v112
	v_exp_f32 v113, v113
	v_pk_fma_f32 v[92:93], v[116:117], v[248:249], v[248:249] op_sel:[0,0,1] op_sel_hi:[1,0,1] neg_lo:[0,0,1] neg_hi:[0,0,1]
	v_pk_fma_f32 v[116:117], v[116:117], v[248:249], v[250:251] op_sel:[0,0,0] op_sel_hi:[1,0,0] neg_lo:[1,0,0] neg_hi:[1,0,0]
	v_exp_f32 v90, v90
	v_exp_f32 v91, v91
	v_exp_f32 v114, v114
	v_exp_f32 v115, v115
	v_pk_fma_f32 v[94:95], v[118:119], v[248:249], v[248:249] op_sel:[0,0,1] op_sel_hi:[1,0,1] neg_lo:[0,0,1] neg_hi:[0,0,1]
	v_pk_fma_f32 v[118:119], v[118:119], v[248:249], v[250:251] op_sel:[0,0,0] op_sel_hi:[1,0,0] neg_lo:[1,0,0] neg_hi:[1,0,0]
	v_exp_f32 v92, v92
	v_exp_f32 v93, v93
	s_add_u32 s88, s37, 0x246b600
	buffer_load_dwordx4 v[200:203], v19, s[8:11], s88 offen sc1
	v_exp_f32 v116, v116
	v_exp_f32 v117, v117
	v_pk_add_f32 v[252:253], v[88:89], v[90:91]
	v_pk_add_f32 v[254:255], v[112:113], v[114:115]
	v_pk_fma_f32 v[96:97], v[120:121], v[248:249], v[248:249] op_sel:[0,0,1] op_sel_hi:[1,0,1] neg_lo:[0,0,1] neg_hi:[0,0,1]
	v_pk_fma_f32 v[120:121], v[120:121], v[248:249], v[250:251] op_sel:[0,0,0] op_sel_hi:[1,0,0] neg_lo:[1,0,0] neg_hi:[1,0,0]
	v_exp_f32 v94, v94
	v_exp_f32 v95, v95
	v_exp_f32 v118, v118
	v_exp_f32 v119, v119
	v_pk_add_f32 v[252:253], v[252:253], v[92:93]
	v_pk_add_f32 v[254:255], v[254:255], v[116:117]
	v_pk_fma_f32 v[98:99], v[122:123], v[248:249], v[248:249] op_sel:[0,0,1] op_sel_hi:[1,0,1] neg_lo:[0,0,1] neg_hi:[0,0,1]
	v_pk_fma_f32 v[122:123], v[122:123], v[248:249], v[250:251] op_sel:[0,0,0] op_sel_hi:[1,0,0] neg_lo:[1,0,0] neg_hi:[1,0,0]
	v_exp_f32 v96, v96
	s_add_u32 s88, s37, 0x246c380
	buffer_load_dwordx4 v[204:207], v19, s[8:11], s88 offen sc1
	v_exp_f32 v97, v97
	v_exp_f32 v120, v120
	v_exp_f32 v121, v121
	v_pk_add_f32 v[252:253], v[252:253], v[94:95]
	v_pk_add_f32 v[254:255], v[254:255], v[118:119]
	v_pk_fma_f32 v[100:101], v[124:125], v[248:249], v[248:249] op_sel:[0,0,1] op_sel_hi:[1,0,1] neg_lo:[0,0,1] neg_hi:[0,0,1]
	v_pk_fma_f32 v[124:125], v[124:125], v[248:249], v[250:251] op_sel:[0,0,0] op_sel_hi:[1,0,0] neg_lo:[1,0,0] neg_hi:[1,0,0]
	v_exp_f32 v98, v98
	v_exp_f32 v99, v99
	v_exp_f32 v122, v122
	v_exp_f32 v123, v123
	v_pk_add_f32 v[252:253], v[252:253], v[96:97]
	v_pk_add_f32 v[254:255], v[254:255], v[120:121]
	v_pk_fma_f32 v[102:103], v[126:127], v[248:249], v[248:249] op_sel:[0,0,1] op_sel_hi:[1,0,1] neg_lo:[0,0,1] neg_hi:[0,0,1]
	v_pk_fma_f32 v[126:127], v[126:127], v[248:249], v[250:251] op_sel:[0,0,0] op_sel_hi:[1,0,0] neg_lo:[1,0,0] neg_hi:[1,0,0]
	v_exp_f32 v100, v100
	v_exp_f32 v101, v101
	v_exp_f32 v124, v124
	v_exp_f32 v125, v125
	v_pk_add_f32 v[252:253], v[252:253], v[98:99]
	s_add_u32 s88, s37, 0x246d100
	buffer_load_dwordx4 v[208:211], v19, s[8:11], s88 offen sc1
	v_pk_add_f32 v[254:255], v[254:255], v[122:123]
	v_pk_fma_f32 v[72:73], v[128:129], v[248:249], v[248:249] op_sel:[0,0,1] op_sel_hi:[1,0,1] neg_lo:[0,0,1] neg_hi:[0,0,1]
	v_pk_fma_f32 v[128:129], v[128:129], v[248:249], v[250:251] op_sel:[0,0,0] op_sel_hi:[1,0,0] neg_lo:[1,0,0] neg_hi:[1,0,0]
	v_exp_f32 v102, v102
	v_exp_f32 v103, v103
	v_exp_f32 v126, v126
	v_exp_f32 v127, v127
	v_pk_add_f32 v[252:253], v[252:253], v[100:101]
	v_pk_add_f32 v[254:255], v[254:255], v[124:125]
	v_pk_fma_f32 v[74:75], v[130:131], v[248:249], v[248:249] op_sel:[0,0,1] op_sel_hi:[1,0,1] neg_lo:[0,0,1] neg_hi:[0,0,1]
	v_pk_fma_f32 v[130:131], v[130:131], v[248:249], v[250:251] op_sel:[0,0,0] op_sel_hi:[1,0,0] neg_lo:[1,0,0] neg_hi:[1,0,0]
	v_exp_f32 v72, v72
	v_exp_f32 v73, v73
	v_exp_f32 v128, v128
	v_exp_f32 v129, v129
	s_add_u32 s88, s37, 0x246de80
	buffer_load_dwordx4 v[212:215], v19, s[8:11], s88 offen sc1
	v_pk_add_f32 v[252:253], v[252:253], v[102:103]
	v_pk_add_f32 v[254:255], v[254:255], v[126:127]
	v_exp_f32 v74, v74
	v_exp_f32 v75, v75
	v_exp_f32 v130, v130
	v_exp_f32 v131, v131
	v_pk_add_f32 v[252:253], v[252:253], v[72:73]
	v_pk_add_f32 v[254:255], v[254:255], v[128:129]
	v_pk_add_f32 v[252:253], v[252:253], v[74:75]
	v_pk_add_f32 v[254:255], v[254:255], v[130:131]
	v_add_f32 v252, v252, v253
	v_add_f32 v254, v254, v255
	v_rcp_f32 v252, v252
	v_rcp_f32 v254, v254
	v_pk_mul_f32 v[88:89], v[88:89], v[252:253] op_sel:[0,0] op_sel_hi:[1,0]
	v_pk_mul_f32 v[90:91], v[90:91], v[252:253] op_sel:[0,0] op_sel_hi:[1,0]
	v_cvt_pk_bf16_f32 v152, v88, v89
	v_cvt_pk_bf16_f32 v153, v90, v91
	v_pk_mul_f32 v[92:93], v[92:93], v[252:253] op_sel:[0,0] op_sel_hi:[1,0]
	v_pk_mul_f32 v[94:95], v[94:95], v[252:253] op_sel:[0,0] op_sel_hi:[1,0]
	v_cvt_pk_bf16_f32 v156, v92, v93
	v_cvt_pk_bf16_f32 v157, v94, v95
	v_pk_mul_f32 v[96:97], v[96:97], v[252:253] op_sel:[0,0] op_sel_hi:[1,0]
	v_pk_mul_f32 v[98:99], v[98:99], v[252:253] op_sel:[0,0] op_sel_hi:[1,0]
	v_cvt_pk_bf16_f32 v160, v96, v97
	v_cvt_pk_bf16_f32 v161, v98, v99
	v_pk_mul_f32 v[100:101], v[100:101], v[252:253] op_sel:[0,0] op_sel_hi:[1,0]
	v_pk_mul_f32 v[102:103], v[102:103], v[252:253] op_sel:[0,0] op_sel_hi:[1,0]
	v_cvt_pk_bf16_f32 v164, v100, v101
	v_cvt_pk_bf16_f32 v165, v102, v103
	v_pk_mul_f32 v[72:73], v[72:73], v[252:253] op_sel:[0,0] op_sel_hi:[1,0]
	v_pk_mul_f32 v[74:75], v[74:75], v[252:253] op_sel:[0,0] op_sel_hi:[1,0]
	v_cvt_pk_bf16_f32 v154, v72, v73
	v_cvt_pk_bf16_f32 v155, v74, v75
	v_pk_mul_f32 v[112:113], v[112:113], v[254:255] op_sel:[0,0] op_sel_hi:[1,0]
	v_pk_mul_f32 v[114:115], v[114:115], v[254:255] op_sel:[0,0] op_sel_hi:[1,0]
	v_cvt_pk_bf16_f32 v158, v112, v113
	v_cvt_pk_bf16_f32 v159, v114, v115
	v_pk_mul_f32 v[116:117], v[116:117], v[254:255] op_sel:[0,0] op_sel_hi:[1,0]
	v_pk_mul_f32 v[118:119], v[118:119], v[254:255] op_sel:[0,0] op_sel_hi:[1,0]
	v_cvt_pk_bf16_f32 v162, v116, v117
	v_cvt_pk_bf16_f32 v163, v118, v119
	v_pk_mul_f32 v[120:121], v[120:121], v[254:255] op_sel:[0,0] op_sel_hi:[1,0]
	v_pk_mul_f32 v[122:123], v[122:123], v[254:255] op_sel:[0,0] op_sel_hi:[1,0]
	v_cvt_pk_bf16_f32 v166, v120, v121
	v_cvt_pk_bf16_f32 v167, v122, v123
	v_pk_mul_f32 v[124:125], v[124:125], v[254:255] op_sel:[0,0] op_sel_hi:[1,0]
	v_pk_mul_f32 v[126:127], v[126:127], v[254:255] op_sel:[0,0] op_sel_hi:[1,0]
	v_cvt_pk_bf16_f32 v168, v124, v125
	v_cvt_pk_bf16_f32 v169, v126, v127
	v_pk_mul_f32 v[128:129], v[128:129], v[254:255] op_sel:[0,0] op_sel_hi:[1,0]
	v_pk_mul_f32 v[130:131], v[130:131], v[254:255] op_sel:[0,0] op_sel_hi:[1,0]
	v_cvt_pk_bf16_f32 v170, v128, v129
	v_cvt_pk_bf16_f32 v171, v130, v131
	s_add_u32 s88, s37, 0x246ec00
	buffer_load_dwordx4 v[216:219], v19, s[8:11], s88 offen sc1
	s_add_u32 s88, s37, 0x246f980
	buffer_load_dwordx4 v[220:223], v19, s[8:11], s88 offen sc1
	s_add_u32 s88, s37, 0x2470700
	buffer_load_dwordx4 v[224:227], v19, s[8:11], s88 offen sc1
	s_add_u32 s88, s37, 0x2471480
	buffer_load_dwordx4 v[228:231], v19, s[8:11], s88 offen sc1
	s_add_u32 s88, s37, 0x2472200
	buffer_load_dwordx4 v[232:235], v19, s[8:11], s88 offen sc1
	s_add_u32 s88, s37, 0x2472f80
	buffer_load_dwordx4 v[236:239], v19, s[8:11], s88 offen sc1
	s_add_u32 s88, s37, 0x2473d00
	buffer_load_dwordx4 v[240:243], v19, s[8:11], s88 offen sc1
	s_add_u32 s88, s37, 0x2474a80
	buffer_load_dwordx4 v[244:247], v19, s[8:11], s88 offen sc1
	s_mov_b32 s47, 0
kvre_26:
	s_waitcnt vmcnt(15)
	v_mfma_f32_32x32x16_bf16 v[136:151], v[32:35], v[184:187], 0
	v_max_u32 v253, v184, v185
	v_max3_u32 v253, v253, v186, v187
	s_waitcnt vmcnt(14)
	v_mfma_f32_32x32x16_bf16 v[136:151], v[32:35], v[188:191], v[136:151]
	v_max3_u32 v253, v253, v188, v189
	v_max3_u32 v253, v253, v190, v191
	s_waitcnt vmcnt(13)
	v_mfma_f32_32x32x16_bf16 v[136:151], v[32:35], v[192:195], v[136:151]
	v_max3_u32 v253, v253, v192, v193
	v_max3_u32 v253, v253, v194, v195
	s_waitcnt vmcnt(12)
	v_mfma_f32_32x32x16_bf16 v[136:151], v[32:35], v[196:199], v[136:151]
	v_max3_u32 v253, v253, v196, v197
	v_max3_u32 v253, v253, v198, v199
	s_waitcnt vmcnt(11)
	v_mfma_f32_32x32x16_bf16 v[136:151], v[32:35], v[200:203], v[136:151]
	v_max3_u32 v253, v253, v200, v201
	v_max3_u32 v253, v253, v202, v203
	s_waitcnt vmcnt(10)
	v_mfma_f32_32x32x16_bf16 v[136:151], v[32:35], v[204:207], v[136:151]
	v_max3_u32 v253, v253, v204, v205
	v_max3_u32 v253, v253, v206, v207
	s_waitcnt vmcnt(9)
	v_mfma_f32_32x32x16_bf16 v[136:151], v[32:35], v[208:211], v[136:151]
	v_max3_u32 v253, v253, v208, v209
	v_max3_u32 v253, v253, v210, v211
	s_waitcnt vmcnt(8)
	v_mfma_f32_32x32x16_bf16 v[136:151], v[32:35], v[212:215], v[136:151]
	v_max3_u32 v253, v253, v212, v213
	v_max3_u32 v253, v253, v214, v215
	s_waitcnt vmcnt(7)
	v_mfma_f32_32x32x16_bf16 v[136:151], v[32:35], v[216:219], v[136:151]
	s_add_u32 s94, s32, 0x6000
	buffer_load_dwordx4 a[80:83], v1, s[8:11], s94 offen offset:0
	v_max3_u32 v253, v253, v216, v217
	v_max3_u32 v253, v253, v218, v219
	s_waitcnt vmcnt(7)
	v_mfma_f32_32x32x16_bf16 v[136:151], v[32:35], v[220:223], v[136:151]
	s_add_u32 s93, s41, 0x23e8000
	buffer_load_dword v0, v6, s[8:11], s93 offen offset:0 sc1
	v_max3_u32 v253, v253, v220, v221
	v_max3_u32 v253, v253, v222, v223
	s_add_u32 s93, s38, 0x2618000
	buffer_load_dword v0, v14, s[8:11], s93 offen offset:0 sc1
	s_add_u32 s89, s31, 0x8000
	s_add_u32 m0, s39, 0x14000
	s_nop 0
	buffer_load_dwordx4 v1, s[8:11], s89 offen offset:0 lds
	s_waitcnt vmcnt(9)
	v_mfma_f32_32x32x16_bf16 v[136:151], v[32:35], v[224:227], v[136:151]
	buffer_load_dwordx4 v1, s[8:11], s89 offen offset:1024 lds
	v_max3_u32 v253, v253, v224, v225
	v_max3_u32 v253, v253, v226, v227
	s_waitcnt vmcnt(9)
	v_mfma_f32_32x32x16_bf16 v[136:151], v[32:35], v[228:231], v[136:151]
	buffer_load_dwordx4 v1, s[8:11], s89 offen offset:2048 lds
	v_max3_u32 v253, v253, v228, v229
	v_max3_u32 v253, v253, v230, v231
	s_waitcnt vmcnt(9)
	v_mfma_f32_32x32x16_bf16 v[136:151], v[32:35], v[232:235], v[136:151]
	buffer_load_dwordx4 v1, s[8:11], s89 offen offset:3072 lds
	v_max3_u32 v253, v253, v232, v233
	v_max3_u32 v253, v253, v234, v235
	s_waitcnt vmcnt(9)
	v_mfma_f32_32x32x16_bf16 v[136:151], v[32:35], v[236:239], v[136:151]
	v_max3_u32 v253, v253, v236, v237
	v_max3_u32 v253, v253, v238, v239
	s_waitcnt vmcnt(8)
	v_mfma_f32_32x32x16_bf16 v[136:151], v[32:35], v[240:243], v[136:151]
	v_max3_u32 v253, v253, v240, v241
	v_max3_u32 v253, v253, v242, v243
	s_waitcnt vmcnt(7)
	v_mfma_f32_32x32x16_bf16 v[136:151], v[32:35], v[244:247], v[136:151]
	v_max3_u32 v253, v253, v244, v245
	v_max3_u32 v253, v253, v246, v247
	v_cmp_eq_u32 vcc, -1, v253
	s_cbranch_vccnz kvretry_27
kvok_28:
	s_nop 7
	v_cvt_pk_bf16_f32 v248, v136, v137
	v_cvt_pk_bf16_f32 v249, v138, v139
	v_cvt_pk_bf16_f32 v250, v140, v141
	v_cvt_pk_bf16_f32 v251, v142, v143
	ds_write_b128 v23, v[248:251]
	s_waitcnt lgkmcnt(0)
	s_barrier
	ds_read_b128 v[204:207], v25 offset:0
	ds_read_b128 v[208:211], v25 offset:16
	ds_read_b128 v[212:215], v25 offset:32
	ds_read_b128 v[216:219], v25 offset:48
	ds_read_b128 v[220:223], v25 offset:64
	ds_read_b128 v[184:187], v24 offset:0
	ds_read_b128 v[188:191], v24 offset:16
	ds_read_b128 v[192:195], v24 offset:32
	ds_read_b128 v[196:199], v24 offset:48
	ds_read_b128 v[200:203], v24 offset:64
	s_waitcnt lgkmcnt(9)
	v_mfma_f32_32x32x16_bf16 v[88:103], v[204:207], v[152:155], 0
	s_add_u32 s89, s31, 0xc000
	s_add_u32 m0, s39, 0
	s_nop 0
	buffer_load_dwordx4 v1, s[8:11], s89 offen offset:0 lds
	s_waitcnt lgkmcnt(8)
	v_mfma_f32_32x32x16_bf16 v[88:103], v[208:211], v[156:159], v[88:103]
	buffer_load_dwordx4 v1, s[8:11], s89 offen offset:1024 lds
	s_waitcnt lgkmcnt(7)
	v_mfma_f32_32x32x16_bf16 v[88:103], v[212:215], v[160:163], v[88:103]
	buffer_load_dwordx4 v1, s[8:11], s89 offen offset:2048 lds
	s_waitcnt lgkmcnt(6)
	v_mfma_f32_32x32x16_bf16 v[88:103], v[216:219], v[164:167], v[88:103]
	buffer_load_dwordx4 v1, s[8:11], s89 offen offset:3072 lds
	s_waitcnt lgkmcnt(5)
	v_mfma_f32_32x32x16_bf16 v[88:103], v[220:223], v[168:171], v[88:103]
	s_add_u32 s89, s31, 0x10000
	s_add_u32 m0, s39, 0x4000
	s_nop 0
	buffer_load_dwordx4 v1, s[8:11], s89 offen offset:0 lds
	s_waitcnt lgkmcnt(4)
	v_mfma_f32_32x32x16_bf16 v[72:87], v[184:187], v[152:155], 0
	buffer_load_dwordx4 v1, s[8:11], s89 offen offset:1024 lds
	s_waitcnt lgkmcnt(3)
	v_mfma_f32_32x32x16_bf16 v[72:87], v[188:191], v[156:159], v[72:87]
	buffer_load_dwordx4 v1, s[8:11], s89 offen offset:2048 lds
	s_waitcnt lgkmcnt(2)
	v_mfma_f32_32x32x16_bf16 v[72:87], v[192:195], v[160:163], v[72:87]
	buffer_load_dwordx4 v1, s[8:11], s89 offen offset:3072 lds
	s_waitcnt lgkmcnt(1)
	v_mfma_f32_32x32x16_bf16 v[72:87], v[196:199], v[164:167], v[72:87]
	s_waitcnt lgkmcnt(0)
	v_mfma_f32_32x32x16_bf16 v[72:87], v[200:203], v[168:171], v[72:87]
	v_add_f32 v249, 0x358637bd, v92
	v_rcp_f32 v249, v249
	s_add_u32 s28, s42, 0x17e8000
	v_pk_mul_f32 v[88:89], v[88:89], v[248:249] op_sel:[0,1] op_sel_hi:[1,1]
	v_cvt_pk_bf16_f32 v144, v88, v89
	v_pk_mul_f32 v[90:91], v[90:91], v[248:249] op_sel:[0,1] op_sel_hi:[1,1]
	v_cvt_pk_bf16_f32 v145, v90, v91
	buffer_store_dwordx2 v[144:145], v10, s[8:11], s28 offen
	s_nop 3
	v_pk_mul_f32 v[72:73], v[72:73], v[248:249] op_sel:[0,1] op_sel_hi:[1,1]
	v_cvt_pk_bf16_f32 v136, v72, v73
	v_pk_mul_f32 v[74:75], v[74:75], v[248:249] op_sel:[0,1] op_sel_hi:[1,1]
	v_cvt_pk_bf16_f32 v137, v74, v75
	v_pk_mul_f32 v[76:77], v[76:77], v[248:249] op_sel:[0,1] op_sel_hi:[1,1]
	v_cvt_pk_bf16_f32 v138, v76, v77
	v_pk_mul_f32 v[78:79], v[78:79], v[248:249] op_sel:[0,1] op_sel_hi:[1,1]
	v_cvt_pk_bf16_f32 v139, v78, v79
	buffer_store_dwordx4 v[136:139], v8, s[8:11], s28 offen
	v_pk_mul_f32 v[80:81], v[80:81], v[248:249] op_sel:[0,1] op_sel_hi:[1,1]
	v_cvt_pk_bf16_f32 v140, v80, v81
	v_pk_mul_f32 v[82:83], v[82:83], v[248:249] op_sel:[0,1] op_sel_hi:[1,1]
	v_cvt_pk_bf16_f32 v141, v82, v83
	v_pk_mul_f32 v[84:85], v[84:85], v[248:249] op_sel:[0,1] op_sel_hi:[1,1]
	v_cvt_pk_bf16_f32 v142, v84, v85
	v_pk_mul_f32 v[86:87], v[86:87], v[248:249] op_sel:[0,1] op_sel_hi:[1,1]
	v_cvt_pk_bf16_f32 v143, v86, v87
	buffer_store_dwordx4 v[140:143], v9, s[8:11], s28 offen
	v_lshlrev_b32 v36, 16, v46
	v_and_b32 v37, 0xffff0000, v46
	v_lshlrev_b32 v38, 16, v47
	v_and_b32 v39, 0xffff0000, v47
	v_lshlrev_b32 v40, 16, v48
	v_and_b32 v41, 0xffff0000, v48
	v_lshlrev_b32 v42, 16, v49
	v_and_b32 v43, 0xffff0000, v49
	v_lshlrev_b32 v44, 16, v50
	v_and_b32 v45, 0xffff0000, v50
	v_lshlrev_b32 v46, 16, v51
	v_and_b32 v47, 0xffff0000, v51
	v_lshlrev_b32 v48, 16, v52
	v_and_b32 v49, 0xffff0000, v52
	v_lshlrev_b32 v50, 16, v53
	v_and_b32 v51, 0xffff0000, v53
	v_lshlrev_b32 v52, 16, v54
	v_and_b32 v53, 0xffff0000, v54
	v_lshlrev_b32 v54, 16, v55
	v_and_b32 v55, 0xffff0000, v55
	s_add_u32 s89, s31, 0x14000
	s_add_u32 m0, s39, 0x8000
	s_nop 0
	buffer_load_dwordx4 v1, s[8:11], s89 offen offset:0 lds
	buffer_load_dwordx4 v1, s[8:11], s89 offen offset:1024 lds
	s_add_u32 s94, s33, 0
	buffer_load_dwordx4 v[152:155], v1, s[8:11], s94 offen offset:0
	buffer_load_dwordx4 v1, s[8:11], s89 offen offset:2048 lds
	v_mov_b32 v254, 1
	s_add_u32 s29, s44, 0x2618000
	s_waitcnt vmcnt(4)
	s_cmp_eq_u32 s25, 0
	s_cbranch_scc1 slow_29
	buffer_store_dword v254, v16, s[8:11], s29 offen
back_30:
	buffer_load_dwordx4 v1, s[8:11], s89 offen offset:3072 lds
	buffer_load_dwordx4 v[156:159], v1, s[8:11], s94 offen offset:1024
	buffer_load_dwordx4 v[160:163], v1, s[8:11], s94 offen offset:2048
	buffer_load_dwordx4 v[164:167], v1, s[8:11], s94 offen offset:3072
	s_add_u32 s29, s38, 0x2618000
	buffer_load_dword v255, v14, s[8:11], s29 offen sc1
	s_add_u32 s94, s33, 0x1000
	buffer_load_dwordx4 v[168:171], v1, s[8:11], s94 offen offset:0
	s_add_u32 s94, s33, 0x3000
	buffer_load_dwordx4 v[172:175], v1, s[8:11], s94 offen offset:3072
	s_add_u32 s94, s33, 0x4000
	buffer_load_dwordx4 v[176:179], v1, s[8:11], s94 offen offset:0
	buffer_load_dwordx4 v[180:183], v1, s[8:11], s94 offen offset:1024
	s_waitcnt vmcnt(4)
	v_cmp_gt_u32 vcc, 1, v255
	s_cbranch_vccnz chkpoll_31
chkok_32:
	s_cmp_eq_u32 s25, 0
	s_cbranch_scc1 acq_33
acqb_34:
	s_add_u32 s88, s48, 0x17e8000
	buffer_load_dwordx4 a[0:3], v1, s[8:11], s88 offen offset:0 sc1
	s_add_u32 s88, s49, 0x17e8000
	buffer_load_dwordx4 a[4:7], v1, s[8:11], s88 offen offset:0 sc1
	s_add_u32 s88, s50, 0x17e8000
	buffer_load_dwordx4 a[8:11], v1, s[8:11], s88 offen offset:0 sc1
	s_add_u32 s88, s51, 0x17e8000
	buffer_load_dwordx4 a[12:15], v1, s[8:11], s88 offen offset:0 sc1
	s_add_u32 s88, s48, 0x17e8000
	buffer_load_dwordx4 a[16:19], v1, s[8:11], s88 offen offset:1024 sc1
	s_add_u32 s88, s49, 0x17e8000
	buffer_load_dwordx4 a[20:23], v1, s[8:11], s88 offen offset:1024 sc1
	s_add_u32 s88, s50, 0x17e8000
	buffer_load_dwordx4 a[24:27], v1, s[8:11], s88 offen offset:1024 sc1
	s_add_u32 s88, s51, 0x17e8000
	buffer_load_dwordx4 a[28:31], v1, s[8:11], s88 offen offset:1024 sc1
	s_waitcnt vmcnt(7)
	v_mfma_f32_16x16x32_bf16 v[72:75], a[160:163], a[0:3], 0
	s_add_u32 s88, s48, 0x17e8000
	buffer_load_dwordx4 a[32:35], v1, s[8:11], s88 offen offset:2048 sc1
	v_mfma_f32_16x16x32_bf16 v[76:79], a[164:167], a[0:3], 0
	v_mfma_f32_16x16x32_bf16 v[80:83], a[168:171], a[0:3], 0
	v_mfma_f32_16x16x32_bf16 v[84:87], a[172:175], a[0:3], 0
	v_mfma_f32_16x16x32_bf16 v[88:91], a[176:179], a[0:3], 0
	s_add_u32 s88, s49, 0x17e8000
	buffer_load_dwordx4 a[36:39], v1, s[8:11], s88 offen offset:2048 sc1
	s_waitcnt vmcnt(8)
	v_mfma_f32_16x16x32_bf16 v[92:95], a[160:163], a[4:7], 0
	v_mfma_f32_16x16x32_bf16 v[96:99], a[164:167], a[4:7], 0
	v_mfma_f32_16x16x32_bf16 v[100:103], a[168:171], a[4:7], 0
	v_mfma_f32_16x16x32_bf16 v[104:107], a[172:175], a[4:7], 0
	v_mfma_f32_16x16x32_bf16 v[108:111], a[176:179], a[4:7], 0
	s_add_u32 s88, s50, 0x17e8000
	buffer_load_dwordx4 a[40:43], v1, s[8:11], s88 offen offset:2048 sc1
	s_waitcnt vmcnt(8)
	v_mfma_f32_16x16x32_bf16 v[112:115], a[160:163], a[8:11], 0
	v_mfma_f32_16x16x32_bf16 v[116:119], a[164:167], a[8:11], 0
	v_mfma_f32_16x16x32_bf16 v[120:123], a[168:171], a[8:11], 0
	v_mfma_f32_16x16x32_bf16 v[124:127], a[172:175], a[8:11], 0
	v_mfma_f32_16x16x32_bf16 v[128:131], a[176:179], a[8:11], 0
	s_add_u32 s88, s51, 0x17e8000
	buffer_load_dwordx4 a[44:47], v1, s[8:11], s88 offen offset:2048 sc1
	s_waitcnt vmcnt(8)
	v_mfma_f32_16x16x32_bf16 v[132:135], a[160:163], a[12:15], 0
	v_mfma_f32_16x16x32_bf16 v[136:139], a[164:167], a[12:15], 0
	v_mfma_f32_16x16x32_bf16 v[140:143], a[168:171], a[12:15], 0
	s_add_u32 s88, s49, 0x17e8000
	buffer_load_dwordx4 a[52:55], v1, s[8:11], s88 offen offset:3072 sc1
	v_mfma_f32_16x16x32_bf16 v[144:147], a[172:175], a[12:15], 0
	v_mfma_f32_16x16x32_bf16 v[148:151], a[176:179], a[12:15], 0
	s_waitcnt vmcnt(8)
	v_mfma_f32_16x16x32_bf16 v[72:75], a[180:183], a[16:19], v[72:75]
	v_mfma_f32_16x16x32_bf16 v[76:79], a[184:187], a[16:19], v[76:79]
	v_mfma_f32_16x16x32_bf16 v[80:83], a[188:191], a[16:19], v[80:83]
	s_add_u32 s88, s50, 0x17e8000
	buffer_load_dwordx4 a[56:59], v1, s[8:11], s88 offen offset:3072 sc1
	v_mfma_f32_16x16x32_bf16 v[84:87], a[192:195], a[16:19], v[84:87]
	v_mfma_f32_16x16x32_bf16 v[88:91], a[196:199], a[16:19], v[88:91]
	s_waitcnt vmcnt(8)
	v_mfma_f32_16x16x32_bf16 v[92:95], a[180:183], a[20:23], v[92:95]
	s_add_u32 s88, s51, 0x17e8000
	buffer_load_dwordx4 a[60:63], v1, s[8:11], s88 offen offset:3072 sc1
	v_mfma_f32_16x16x32_bf16 v[96:99], a[184:187], a[20:23], v[96:99]
	v_mfma_f32_16x16x32_bf16 v[100:103], a[188:191], a[20:23], v[100:103]
	v_mfma_f32_16x16x32_bf16 v[104:107], a[192:195], a[20:23], v[104:107]
	v_mfma_f32_16x16x32_bf16 v[108:111], a[196:199], a[20:23], v[108:111]
	s_waitcnt vmcnt(8)
	v_mfma_f32_16x16x32_bf16 v[112:115], a[180:183], a[24:27], v[112:115]
	s_add_u32 s88, s48, 0x17e8000
	buffer_load_dwordx4 a[48:51], v1, s[8:11], s88 offen offset:3072 sc1
	v_mfma_f32_16x16x32_bf16 v[116:119], a[184:187], a[24:27], v[116:119]
	v_mfma_f32_16x16x32_bf16 v[120:123], a[188:191], a[24:27], v[120:123]
	v_mfma_f32_16x16x32_bf16 v[124:127], a[192:195], a[24:27], v[124:127]
	v_mfma_f32_16x16x32_bf16 v[128:131], a[196:199], a[24:27], v[128:131]
	s_add_u32 s88, s49, 0x17e9000
	buffer_load_dwordx4 a[68:71], v1, s[8:11], s88 offen offset:0 sc1
	s_waitcnt vmcnt(9)
	v_mfma_f32_16x16x32_bf16 v[132:135], a[180:183], a[28:31], v[132:135]
	v_mfma_f32_16x16x32_bf16 v[136:139], a[184:187], a[28:31], v[136:139]
	v_mfma_f32_16x16x32_bf16 v[140:143], a[188:191], a[28:31], v[140:143]
	v_mfma_f32_16x16x32_bf16 v[144:147], a[192:195], a[28:31], v[144:147]
	v_mfma_f32_16x16x32_bf16 v[148:151], a[196:199], a[28:31], v[148:151]
	s_add_u32 s88, s50, 0x17e9000
	buffer_load_dwordx4 a[72:75], v1, s[8:11], s88 offen offset:0 sc1
	s_waitcnt vmcnt(9)
	v_mfma_f32_16x16x32_bf16 v[72:75], a[200:203], a[32:35], v[72:75]
	v_mfma_f32_16x16x32_bf16 v[76:79], a[204:207], a[32:35], v[76:79]
	v_mfma_f32_16x16x32_bf16 v[80:83], a[208:211], a[32:35], v[80:83]
	s_add_u32 s88, s51, 0x17e9000
	buffer_load_dwordx4 a[76:79], v1, s[8:11], s88 offen offset:0 sc1
	v_mfma_f32_16x16x32_bf16 v[84:87], a[212:215], a[32:35], v[84:87]
	v_mfma_f32_16x16x32_bf16 v[88:91], a[216:219], a[32:35], v[88:91]
	s_waitcnt vmcnt(9)
	v_mfma_f32_16x16x32_bf16 v[92:95], a[200:203], a[36:39], v[92:95]
	v_mfma_f32_16x16x32_bf16 v[96:99], a[204:207], a[36:39], v[96:99]
	v_mfma_f32_16x16x32_bf16 v[100:103], a[208:211], a[36:39], v[100:103]
	s_add_u32 s88, s48, 0x17e9000
	buffer_load_dwordx4 a[64:67], v1, s[8:11], s88 offen offset:0 sc1
	v_mfma_f32_16x16x32_bf16 v[104:107], a[212:215], a[36:39], v[104:107]
	v_mfma_f32_16x16x32_bf16 v[108:111], a[216:219], a[36:39], v[108:111]
	s_waitcnt vmcnt(9)
	v_mfma_f32_16x16x32_bf16 v[112:115], a[200:203], a[40:43], v[112:115]
	v_mfma_f32_16x16x32_bf16 v[116:119], a[204:207], a[40:43], v[116:119]
	v_mfma_f32_16x16x32_bf16 v[120:123], a[208:211], a[40:43], v[120:123]
	s_add_u32 s93, s43, 0x17e8000
	buffer_load_dword v0, v11, s[8:11], s93 offen offset:0 sc1
	v_mfma_f32_16x16x32_bf16 v[124:127], a[212:215], a[40:43], v[124:127]
	v_mfma_f32_16x16x32_bf16 v[128:131], a[216:219], a[40:43], v[128:131]
	s_add_u32 s93, s43, 0x17e8000
	buffer_load_dword v0, v11, s[8:11], s93 offen offset:512 sc1
	s_waitcnt vmcnt(10)
	v_mfma_f32_16x16x32_bf16 v[132:135], a[200:203], a[44:47], v[132:135]
	s_add_u32 s93, s38, 0x2619000
	buffer_load_dword v0, v15, s[8:11], s93 offen offset:0 sc1
	v_mfma_f32_16x16x32_bf16 v[136:139], a[204:207], a[44:47], v[136:139]
	v_mfma_f32_16x16x32_bf16 v[140:143], a[208:211], a[44:47], v[140:143]
	buffer_load_dwordx4 v[184:187], v1, s[8:11], s94 offen offset:2048
	v_mfma_f32_16x16x32_bf16 v[144:147], a[212:215], a[44:47], v[144:147]
	v_mfma_f32_16x16x32_bf16 v[148:151], a[216:219], a[44:47], v[148:151]
	buffer_load_dwordx4 v[188:191], v1, s[8:11], s94 offen offset:3072
	s_waitcnt vmcnt(12)
	v_mfma_f32_16x16x32_bf16 v[92:95], a[220:223], a[52:55], v[92:95]
	s_add_u32 s94, s33, 0x7000
	buffer_load_dwordx4 v[192:195], v1, s[8:11], s94 offen offset:2048
	v_mfma_f32_16x16x32_bf16 v[96:99], a[224:227], a[52:55], v[96:99]
	v_mfma_f32_16x16x32_bf16 v[100:103], a[228:231], a[52:55], v[100:103]
	v_mfma_f32_16x16x32_bf16 v[104:107], a[232:235], a[52:55], v[104:107]
	v_mfma_f32_16x16x32_bf16 v[108:111], a[236:239], a[52:55], v[108:111]
	buffer_load_dwordx4 v[196:199], v1, s[8:11], s94 offen offset:3072
	s_waitcnt vmcnt(10)
	v_mfma_f32_16x16x32_bf16 v[92:95], a[240:243], a[68:71], v[92:95]
	s_add_u32 s94, s33, 0x8000
	buffer_load_dwordx4 v[200:203], v1, s[8:11], s94 offen offset:0
	v_mfma_f32_16x16x32_bf16 v[96:99], a[244:247], a[68:71], v[96:99]
	v_mfma_f32_16x16x32_bf16 v[100:103], a[248:251], a[68:71], v[100:103]
	v_mfma_f32_16x16x32_bf16 v[104:107], a[252:255], a[68:71], v[104:107]
	v_mfma_f32_16x16x32_bf16 v[108:111], a[80:83], a[68:71], v[108:111]
	buffer_load_dwordx4 v[204:207], v1, s[8:11], s94 offen offset:1024
	v_mfma_f32_16x16x32_bf16 v[112:115], a[220:223], a[56:59], v[112:115]
	ds_write_b64 v28, v[92:93] offset:0
	v_mfma_f32_16x16x32_bf16 v[116:119], a[224:227], a[56:59], v[116:119]
	ds_write_b64 v28, v[94:95] offset:8
	v_mfma_f32_16x16x32_bf16 v[120:123], a[228:231], a[56:59], v[120:123]
	ds_write_b64 v28, v[96:97] offset:1024
	v_mfma_f32_16x16x32_bf16 v[124:127], a[232:235], a[56:59], v[124:127]
	ds_write_b64 v28, v[98:99] offset:1032
	v_mfma_f32_16x16x32_bf16 v[128:131], a[236:239], a[56:59], v[128:131]
	ds_write_b64 v28, v[100:101] offset:2048
	buffer_load_dwordx4 v[208:211], v1, s[8:11], s94 offen offset:2048
	s_waitcnt vmcnt(12)
	v_mfma_f32_16x16x32_bf16 v[112:115], a[240:243], a[72:75], v[112:115]
	ds_write_b64 v28, v[102:103] offset:2056
	v_mfma_f32_16x16x32_bf16 v[116:119], a[244:247], a[72:75], v[116:119]
	ds_write_b64 v28, v[104:105] offset:3072
	v_mfma_f32_16x16x32_bf16 v[120:123], a[248:251], a[72:75], v[120:123]
	ds_write_b64 v28, v[106:107] offset:3080
	s_add_u32 s94, s33, 0xb000
	buffer_load_dwordx4 v[212:215], v1, s[8:11], s94 offen offset:1024
	v_mfma_f32_16x16x32_bf16 v[124:127], a[252:255], a[72:75], v[124:127]
	ds_write_b64 v28, v[108:109] offset:4096
	v_mfma_f32_16x16x32_bf16 v[128:131], a[80:83], a[72:75], v[128:131]
	ds_write_b64 v28, v[110:111] offset:4104
	v_mfma_f32_16x16x32_bf16 v[132:135], a[220:223], a[60:63], v[132:135]
	ds_write_b64 v29, v[112:113] offset:0
	v_mfma_f32_16x16x32_bf16 v[136:139], a[224:227], a[60:63], v[136:139]
	ds_write_b64 v29, v[114:115] offset:8
	v_mfma_f32_16x16x32_bf16 v[140:143], a[228:231], a[60:63], v[140:143]
	ds_write_b64 v29, v[116:117] offset:1024
	v_mfma_f32_16x16x32_bf16 v[144:147], a[232:235], a[60:63], v[144:147]
	ds_write_b64 v29, v[118:119] offset:1032
	v_mfma_f32_16x16x32_bf16 v[148:151], a[236:239], a[60:63], v[148:151]
	ds_write_b64 v29, v[120:121] offset:2048
	s_waitcnt vmcnt(12)
	v_mfma_f32_16x16x32_bf16 v[132:135], a[240:243], a[76:79], v[132:135]
	ds_write_b64 v29, v[122:123] offset:2056
	v_mfma_f32_16x16x32_bf16 v[136:139], a[244:247], a[76:79], v[136:139]
	ds_write_b64 v29, v[124:125] offset:3072
	v_mfma_f32_16x16x32_bf16 v[140:143], a[248:251], a[76:79], v[140:143]
	ds_write_b64 v29, v[126:127] offset:3080
	v_mfma_f32_16x16x32_bf16 v[144:147], a[252:255], a[76:79], v[144:147]
	ds_write_b64 v29, v[128:129] offset:4096
	v_mfma_f32_16x16x32_bf16 v[148:151], a[80:83], a[76:79], v[148:151]
	ds_write_b64 v29, v[130:131] offset:4104
	v_mfma_f32_16x16x32_bf16 v[72:75], a[220:223], a[48:51], v[72:75]
	ds_write_b64 v30, v[132:133] offset:0
	v_mfma_f32_16x16x32_bf16 v[76:79], a[224:227], a[48:51], v[76:79]
	ds_write_b64 v30, v[134:135] offset:8
	v_mfma_f32_16x16x32_bf16 v[80:83], a[228:231], a[48:51], v[80:83]
	ds_write_b64 v30, v[136:137] offset:1024
	v_mfma_f32_16x16x32_bf16 v[84:87], a[232:235], a[48:51], v[84:87]
	ds_write_b64 v30, v[138:139] offset:1032
	v_mfma_f32_16x16x32_bf16 v[88:91], a[236:239], a[48:51], v[88:91]
	ds_write_b64 v30, v[140:141] offset:2048
	s_waitcnt vmcnt(11)
	v_mfma_f32_16x16x32_bf16 v[72:75], a[240:243], a[64:67], v[72:75]
	ds_write_b64 v30, v[142:143] offset:2056
	v_mfma_f32_16x16x32_bf16 v[76:79], a[244:247], a[64:67], v[76:79]
	ds_write_b64 v30, v[144:145] offset:3072
	v_mfma_f32_16x16x32_bf16 v[80:83], a[248:251], a[64:67], v[80:83]
	ds_write_b64 v30, v[146:147] offset:3080
	v_mfma_f32_16x16x32_bf16 v[84:87], a[252:255], a[64:67], v[84:87]
	ds_write_b64 v30, v[148:149] offset:4096
	v_mfma_f32_16x16x32_bf16 v[88:91], a[80:83], a[64:67], v[88:91]
	ds_write_b64 v30, v[150:151] offset:4104
	s_waitcnt lgkmcnt(0)
	s_barrier
	ds_read_b128 v[92:95], v26 offset:0
	ds_read_b128 v[112:115], v26 offset:5120
	ds_read_b128 v[132:135], v26 offset:10240
	ds_read_b128 v[96:99], v26 offset:1024
	ds_read_b128 v[116:119], v26 offset:6144
	ds_read_b128 v[136:139], v26 offset:11264
	ds_read_b128 v[100:103], v26 offset:2048
	ds_read_b128 v[120:123], v26 offset:7168
	ds_read_b128 v[140:143], v26 offset:12288
	ds_read_b128 v[104:107], v26 offset:3072
	ds_read_b128 v[124:127], v26 offset:8192
	ds_read_b128 v[144:147], v26 offset:13312
	ds_read_b128 v[108:111], v26 offset:4096
	ds_read_b128 v[128:131], v26 offset:9216
	ds_read_b128 v[148:151], v26 offset:14336
	v_pk_add_f32 v[36:37], v[36:37], v[72:73]
	v_pk_add_f32 v[38:39], v[38:39], v[74:75]
	v_pk_add_f32 v[40:41], v[40:41], v[76:77]
	v_pk_add_f32 v[42:43], v[42:43], v[78:79]
	v_pk_add_f32 v[44:45], v[44:45], v[80:81]
	v_pk_add_f32 v[46:47], v[46:47], v[82:83]
	v_pk_add_f32 v[48:49], v[48:49], v[84:85]
	v_pk_add_f32 v[50:51], v[50:51], v[86:87]
	v_pk_add_f32 v[52:53], v[52:53], v[88:89]
	v_pk_add_f32 v[54:55], v[54:55], v[90:91]
	s_add_u32 s28, s40, 0x8e8000
	s_add_u32 s93, s61, 0x263a000
	v_and_b32 v253, 0x200, v1
	v_lshrrev_b32 v252, 1, v1
	v_lshl_or_b32 v253, v253, 21, v252
	buffer_load_dwordx2 a[244:245], v253, s[8:11], s93 offen offset:0
	buffer_load_dwordx2 a[246:247], v253, s[8:11], s93 offen offset:256
	buffer_load_dwordx2 a[248:249], v253, s[8:11], s93 offen offset:512
	buffer_load_dwordx2 a[250:251], v253, s[8:11], s93 offen offset:768
	buffer_load_dwordx2 a[252:253], v253, s[8:11], s93 offen offset:1024
	buffer_load_dwordx2 a[254:255], v253, s[8:11], s93 offen offset:1280
	buffer_load_dwordx4 v[216:219], v1, s[8:11], s94 offen offset:2048
	s_waitcnt lgkmcnt(12)
	v_pk_add_f32 v[92:93], v[92:93], v[112:113]
	v_pk_add_f32 v[36:37], v[36:37], v[132:133]
	v_pk_add_f32 v[94:95], v[94:95], v[114:115]
	v_pk_add_f32 v[38:39], v[38:39], v[134:135]
	v_pk_add_f32 v[36:37], v[36:37], v[92:93]
	v_pk_add_f32 v[38:39], v[38:39], v[94:95]
	v_cvt_pk_bf16_f32 v72, v36, v37
	v_cvt_pk_bf16_f32 v73, v38, v39
	v_pk_add_f32 v[82:83], v[36:37], v[38:39]
	v_pk_mul_f32 v[84:85], v[36:37], v[36:37]
	v_pk_fma_f32 v[84:85], v[38:39], v[38:39], v[84:85]
	buffer_load_dwordx4 v[220:223], v1, s[8:11], s94 offen offset:3072
	s_add_u32 s94, s33, 0xc000
	buffer_load_dwordx4 v[224:227], v1, s[8:11], s94 offen offset:0
	s_waitcnt lgkmcnt(9)
	v_pk_add_f32 v[96:97], v[96:97], v[116:117]
	v_pk_add_f32 v[40:41], v[40:41], v[136:137]
	v_pk_add_f32 v[98:99], v[98:99], v[118:119]
	v_pk_add_f32 v[42:43], v[42:43], v[138:139]
	v_pk_add_f32 v[40:41], v[40:41], v[96:97]
	v_pk_add_f32 v[42:43], v[42:43], v[98:99]
	v_cvt_pk_bf16_f32 v74, v40, v41
	v_cvt_pk_bf16_f32 v75, v42, v43
	buffer_store_dwordx4 v[72:75], v4, s[8:11], s28 offen
	v_pk_add_f32 v[82:83], v[82:83], v[40:41]
	v_pk_fma_f32 v[84:85], v[40:41], v[40:41], v[84:85]
	v_pk_add_f32 v[82:83], v[82:83], v[42:43]
	v_pk_fma_f32 v[84:85], v[42:43], v[42:43], v[84:85]
	s_waitcnt lgkmcnt(6)
	v_pk_add_f32 v[100:101], v[100:101], v[120:121]
	v_pk_add_f32 v[44:45], v[44:45], v[140:141]
	v_pk_add_f32 v[102:103], v[102:103], v[122:123]
	v_pk_add_f32 v[46:47], v[46:47], v[142:143]
	v_pk_add_f32 v[44:45], v[44:45], v[100:101]
	v_pk_add_f32 v[46:47], v[46:47], v[102:103]
	v_cvt_pk_bf16_f32 v76, v44, v45
	v_cvt_pk_bf16_f32 v77, v46, v47
	v_pk_add_f32 v[82:83], v[82:83], v[44:45]
	v_pk_fma_f32 v[84:85], v[44:45], v[44:45], v[84:85]
	v_pk_add_f32 v[82:83], v[82:83], v[46:47]
	v_pk_fma_f32 v[84:85], v[46:47], v[46:47], v[84:85]
	buffer_load_dwordx4 v[228:231], v1, s[8:11], s94 offen offset:1024
	s_waitcnt lgkmcnt(3)
	v_pk_add_f32 v[104:105], v[104:105], v[124:125]
	v_pk_add_f32 v[48:49], v[48:49], v[144:145]
	v_pk_add_f32 v[106:107], v[106:107], v[126:127]
	v_pk_add_f32 v[50:51], v[50:51], v[146:147]
	v_pk_add_f32 v[48:49], v[48:49], v[104:105]
	v_pk_add_f32 v[50:51], v[50:51], v[106:107]
	v_cvt_pk_bf16_f32 v78, v48, v49
	v_cvt_pk_bf16_f32 v79, v50, v51
	buffer_store_dwordx4 v[76:79], v4, s[8:11], s28 offen offset:2048
	v_pk_add_f32 v[82:83], v[82:83], v[48:49]
	v_pk_fma_f32 v[84:85], v[48:49], v[48:49], v[84:85]
	v_pk_add_f32 v[82:83], v[82:83], v[50:51]
	v_pk_fma_f32 v[84:85], v[50:51], v[50:51], v[84:85]
	s_waitcnt lgkmcnt(0)
	v_pk_add_f32 v[108:109], v[108:109], v[128:129]
	v_pk_add_f32 v[52:53], v[52:53], v[148:149]
	v_pk_add_f32 v[110:111], v[110:111], v[130:131]
	v_pk_add_f32 v[54:55], v[54:55], v[150:151]
	v_pk_add_f32 v[52:53], v[52:53], v[108:109]
	v_pk_add_f32 v[54:55], v[54:55], v[110:111]
	v_cvt_pk_bf16_f32 v80, v52, v53
	v_cvt_pk_bf16_f32 v81, v54, v55
	buffer_store_dwordx2 v[80:81], v5, s[8:11], s28 offen
	v_pk_add_f32 v[82:83], v[82:83], v[52:53]
	v_pk_fma_f32 v[84:85], v[52:53], v[52:53], v[84:85]
	v_pk_add_f32 v[82:83], v[82:83], v[54:55]
	v_pk_fma_f32 v[84:85], v[54:55], v[54:55], v[84:85]
	v_add_f32 v82, v82, v83
	v_add_f32 v84, v84, v85
	s_add_u32 s28, s41, 0x23e8000
	s_nop 0
	v_permlane32_swap_b32 v82, v84
	v_add_f32 v82, v82, v84
	v_mov_b32 v83, v82
	s_nop 1
	v_permlane16_swap_b32 v82, v83
	v_add_f32 v82, v82, v83
	buffer_store_dword v82, v6, s[8:11], s28 offen
	s_barrier
	s_add_u32 s89, s31, 0x18000
	s_add_u32 m0, s39, 0x18000
	s_nop 0
	buffer_load_dwordx4 v1, s[8:11], s89 offen offset:0 lds
	buffer_load_dwordx4 v1, s[8:11], s89 offen offset:1024 lds
	s_add_u32 s94, s33, 0x1000
	buffer_load_dwordx4 v[232:235], v1, s[8:11], s94 offen offset:1024
	buffer_load_dwordx4 v1, s[8:11], s89 offen offset:2048 lds
	v_mov_b32 v254, 1
	s_add_u32 s29, s45, 0x2619000
	s_waitcnt vmcnt(4)
	s_cmp_eq_u32 s25, 0
	s_cbranch_scc1 slow_35
	buffer_store_dword v254, v16, s[8:11], s29 offen
back_36:
	buffer_load_dwordx4 v[236:239], v1, s[8:11], s94 offen offset:2048
	buffer_load_dwordx4 v1, s[8:11], s89 offen offset:3072 lds
	buffer_load_dwordx4 v[240:243], v1, s[8:11], s94 offen offset:3072
	s_add_u32 s89, s31, 0x1c000
	s_add_u32 m0, s39, 0x1c000
	s_nop 0
	buffer_load_dwordx4 v1, s[8:11], s89 offen offset:0 lds
	s_add_u32 s29, s38, 0x2619000
	buffer_load_dword v255, v15, s[8:11], s29 offen sc1
	s_add_u32 s94, s33, 0x2000
	buffer_load_dwordx4 v[244:247], v1, s[8:11], s94 offen offset:0
	buffer_load_dwordx4 v1, s[8:11], s89 offen offset:1024 lds
	buffer_load_dwordx4 a[160:163], v1, s[8:11], s94 offen offset:1024
	buffer_load_dwordx4 v1, s[8:11], s89 offen offset:2048 lds
	s_waitcnt vmcnt(4)
	v_cmp_gt_u32 vcc, 1, v255
	s_cbranch_vccnz chkpoll_37
chkok_38:
	s_cmp_eq_u32 s25, 0
	s_cbranch_scc1 acq_39
acqb_40:
	s_add_u32 s88, s34, 0x8e8000
	buffer_load_dwordx4 a[0:3], v1, s[8:11], s88 offen offset:0 sc1
	buffer_load_dwordx4 a[4:7], v1, s[8:11], s88 offen offset:1024 sc1
	buffer_load_dwordx4 a[8:11], v1, s[8:11], s88 offen offset:2048 sc1
	buffer_load_dwordx4 a[12:15], v1, s[8:11], s88 offen offset:3072 sc1
	s_barrier
	ds_read_b128 v[56:59], v1 offset:49152
	ds_read_b128 v[60:63], v1 offset:50176
	ds_read_b128 v[64:67], v1 offset:51200
	ds_read_b128 v[68:71], v1 offset:52224
	s_waitcnt lgkmcnt(3)
	s_add_u32 s88, s34, 0x8e9000
	buffer_load_dwordx4 a[16:19], v1, s[8:11], s88 offen offset:0 sc1
	buffer_load_dwordx4 a[20:23], v1, s[8:11], s88 offen offset:1024 sc1
	buffer_load_dwordx4 a[24:27], v1, s[8:11], s88 offen offset:2048 sc1
	buffer_load_dwordx4 a[28:31], v1, s[8:11], s88 offen offset:3072 sc1
	s_waitcnt vmcnt(7)
	v_mfma_f32_32x32x16_bf16 v[72:87], v[56:59], a[0:3], 0
	s_add_u32 s88, s34, 0x8ea000
	buffer_load_dwordx4 a[32:35], v1, s[8:11], s88 offen offset:0 sc1
	ds_read_b128 v[56:59], v1 offset:53248
	s_waitcnt lgkmcnt(3)
	v_mfma_f32_32x32x16_bf16 v[88:103], v[60:63], a[0:3], 0
	buffer_load_dwordx4 a[36:39], v1, s[8:11], s88 offen offset:1024 sc1
	ds_read_b128 v[60:63], v1 offset:54272
	s_waitcnt lgkmcnt(3)
	s_waitcnt vmcnt(8)
	v_mfma_f32_32x32x16_bf16 v[72:87], v[64:67], a[4:7], v[72:87]
	buffer_load_dwordx4 a[40:43], v1, s[8:11], s88 offen offset:2048 sc1
	ds_read_b128 v[64:67], v1 offset:55296
	s_waitcnt lgkmcnt(3)
	v_mfma_f32_32x32x16_bf16 v[88:103], v[68:71], a[4:7], v[88:103]
	ds_read_b128 v[68:71], v1 offset:56320
	s_waitcnt lgkmcnt(3)
	s_waitcnt vmcnt(8)
	v_mfma_f32_32x32x16_bf16 v[72:87], v[56:59], a[8:11], v[72:87]
	ds_read_b128 v[56:59], v1 offset:57344
	s_waitcnt lgkmcnt(3)
	v_mfma_f32_32x32x16_bf16 v[88:103], v[60:63], a[8:11], v[88:103]
	buffer_load_dwordx4 a[44:47], v1, s[8:11], s88 offen offset:3072 sc1
	ds_read_b128 v[60:63], v1 offset:58368
	s_waitcnt lgkmcnt(3)
	s_waitcnt vmcnt(8)
	v_mfma_f32_32x32x16_bf16 v[72:87], v[64:67], a[12:15], v[72:87]
	ds_read_b128 v[64:67], v1 offset:59392
	s_waitcnt lgkmcnt(3)
	v_mfma_f32_32x32x16_bf16 v[88:103], v[68:71], a[12:15], v[88:103]
	s_add_u32 s88, s34, 0x8eb000
	buffer_load_dwordx4 a[48:51], v1, s[8:11], s88 offen offset:0 sc1
	ds_read_b128 v[68:71], v1 offset:60416
	s_waitcnt lgkmcnt(3)
	s_waitcnt vmcnt(8)
	v_mfma_f32_32x32x16_bf16 v[72:87], v[56:59], a[16:19], v[72:87]
	ds_read_b128 v[56:59], v1 offset:61440
	s_waitcnt lgkmcnt(3)
	v_mfma_f32_32x32x16_bf16 v[88:103], v[60:63], a[16:19], v[88:103]
	buffer_load_dwordx4 a[52:55], v1, s[8:11], s88 offen offset:1024 sc1
	ds_read_b128 v[60:63], v1 offset:62464
	s_waitcnt lgkmcnt(3)
	s_waitcnt vmcnt(8)
	v_mfma_f32_32x32x16_bf16 v[72:87], v[64:67], a[20:23], v[72:87]
	ds_read_b128 v[64:67], v1 offset:63488
	s_waitcnt lgkmcnt(3)
	v_mfma_f32_32x32x16_bf16 v[88:103], v[68:71], a[20:23], v[88:103]
	buffer_load_dwordx4 a[56:59], v1, s[8:11], s88 offen offset:2048 sc1
	ds_read_b128 v[68:71], v1 offset:64512
	s_waitcnt lgkmcnt(3)
	s_waitcnt vmcnt(8)
	v_mfma_f32_32x32x16_bf16 v[72:87], v[56:59], a[24:27], v[72:87]
	ds_read_b128 v[56:59], v2 offset:0
	s_waitcnt lgkmcnt(3)
	v_mfma_f32_32x32x16_bf16 v[88:103], v[60:63], a[24:27], v[88:103]
	buffer_load_dwordx4 a[60:63], v1, s[8:11], s88 offen offset:3072 sc1
	ds_read_b128 v[60:63], v2 offset:1024
	s_waitcnt lgkmcnt(3)
	s_waitcnt vmcnt(8)
	v_mfma_f32_32x32x16_bf16 v[72:87], v[64:67], a[28:31], v[72:87]
	ds_read_b128 v[64:67], v2 offset:2048
	s_waitcnt lgkmcnt(3)
	v_mfma_f32_32x32x16_bf16 v[88:103], v[68:71], a[28:31], v[88:103]
	s_add_u32 s88, s34, 0x8ec000
	buffer_load_dwordx4 a[64:67], v1, s[8:11], s88 offen offset:0 sc1
	ds_read_b128 v[68:71], v2 offset:3072
	s_waitcnt lgkmcnt(3)
	s_waitcnt vmcnt(8)
	v_mfma_f32_32x32x16_bf16 v[72:87], v[56:59], a[32:35], v[72:87]
	ds_read_b128 v[56:59], v2 offset:4096
	s_waitcnt lgkmcnt(3)
	v_mfma_f32_32x32x16_bf16 v[88:103], v[60:63], a[32:35], v[88:103]
	buffer_load_dwordx4 a[68:71], v1, s[8:11], s88 offen offset:1024 sc1
	ds_read_b128 v[60:63], v2 offset:5120
	s_waitcnt lgkmcnt(3)
	s_waitcnt vmcnt(8)
	v_mfma_f32_32x32x16_bf16 v[72:87], v[64:67], a[36:39], v[72:87]
	ds_read_b128 v[64:67], v2 offset:6144
	s_waitcnt lgkmcnt(3)
	v_mfma_f32_32x32x16_bf16 v[88:103], v[68:71], a[36:39], v[88:103]
	buffer_load_dwordx4 a[72:75], v1, s[8:11], s88 offen offset:2048 sc1
	ds_read_b128 v[68:71], v2 offset:7168
	s_waitcnt lgkmcnt(3)
	s_waitcnt vmcnt(8)
	v_mfma_f32_32x32x16_bf16 v[72:87], v[56:59], a[40:43], v[72:87]
	ds_read_b128 v[56:59], v2 offset:8192
	s_waitcnt lgkmcnt(3)
	v_mfma_f32_32x32x16_bf16 v[88:103], v[60:63], a[40:43], v[88:103]
	ds_read_b128 v[60:63], v2 offset:9216
	s_waitcnt lgkmcnt(3)
	s_waitcnt vmcnt(7)
	v_mfma_f32_32x32x16_bf16 v[72:87], v[64:67], a[44:47], v[72:87]
	buffer_load_dwordx4 a[76:79], v1, s[8:11], s88 offen offset:3072 sc1
	ds_read_b128 v[64:67], v2 offset:10240
	s_waitcnt lgkmcnt(3)
	v_mfma_f32_32x32x16_bf16 v[88:103], v[68:71], a[44:47], v[88:103]
	ds_read_b128 v[68:71], v2 offset:11264
	s_waitcnt lgkmcnt(3)
	s_waitcnt vmcnt(7)
	v_mfma_f32_32x32x16_bf16 v[72:87], v[56:59], a[48:51], v[72:87]
	s_add_u32 s88, s34, 0x8ed000
	buffer_load_dwordx4 a[80:83], v1, s[8:11], s88 offen offset:0 sc1
	ds_read_b128 v[56:59], v2 offset:12288
	s_waitcnt lgkmcnt(3)
	v_mfma_f32_32x32x16_bf16 v[88:103], v[60:63], a[48:51], v[88:103]
	ds_read_b128 v[60:63], v2 offset:13312
	s_waitcnt lgkmcnt(3)
	s_waitcnt vmcnt(7)
	v_mfma_f32_32x32x16_bf16 v[72:87], v[64:67], a[52:55], v[72:87]
	buffer_load_dwordx4 a[84:87], v1, s[8:11], s88 offen offset:1024 sc1
	ds_read_b128 v[64:67], v2 offset:14336
	s_waitcnt lgkmcnt(3)
	v_mfma_f32_32x32x16_bf16 v[88:103], v[68:71], a[52:55], v[88:103]
	ds_read_b128 v[68:71], v2 offset:15360
	s_waitcnt lgkmcnt(3)
	s_waitcnt vmcnt(7)
	v_mfma_f32_32x32x16_bf16 v[72:87], v[56:59], a[56:59], v[72:87]
	buffer_load_dwordx4 a[88:91], v1, s[8:11], s88 offen offset:2048 sc1
	ds_read_b128 v[56:59], v2 offset:16384
	s_waitcnt lgkmcnt(3)
	v_mfma_f32_32x32x16_bf16 v[88:103], v[60:63], a[56:59], v[88:103]
	ds_read_b128 v[60:63], v2 offset:17408
	s_waitcnt lgkmcnt(3)
	s_waitcnt vmcnt(7)
	v_mfma_f32_32x32x16_bf16 v[72:87], v[64:67], a[60:63], v[72:87]
	buffer_load_dwordx4 a[92:95], v1, s[8:11], s88 offen offset:3072 sc1
	ds_read_b128 v[64:67], v2 offset:18432
	s_waitcnt lgkmcnt(3)
	v_mfma_f32_32x32x16_bf16 v[88:103], v[68:71], a[60:63], v[88:103]
	ds_read_b128 v[68:71], v2 offset:19456
	s_waitcnt lgkmcnt(3)
	s_waitcnt vmcnt(7)
	v_mfma_f32_32x32x16_bf16 v[72:87], v[56:59], a[64:67], v[72:87]
	s_add_u32 s88, s34, 0x8ee000
	buffer_load_dwordx4 a[96:99], v1, s[8:11], s88 offen offset:0 sc1
	ds_read_b128 v[56:59], v2 offset:20480
	s_waitcnt lgkmcnt(3)
	v_mfma_f32_32x32x16_bf16 v[88:103], v[60:63], a[64:67], v[88:103]
	ds_read_b128 v[60:63], v2 offset:21504
	s_waitcnt lgkmcnt(3)
	s_waitcnt vmcnt(7)
	v_mfma_f32_32x32x16_bf16 v[72:87], v[64:67], a[68:71], v[72:87]
	buffer_load_dwordx4 a[100:103], v1, s[8:11], s88 offen offset:1024 sc1
	ds_read_b128 v[64:67], v2 offset:22528
	s_waitcnt lgkmcnt(3)
	v_mfma_f32_32x32x16_bf16 v[88:103], v[68:71], a[68:71], v[88:103]
	ds_read_b128 v[68:71], v2 offset:23552
	s_waitcnt lgkmcnt(3)
	s_waitcnt vmcnt(7)
	v_mfma_f32_32x32x16_bf16 v[72:87], v[56:59], a[72:75], v[72:87]
	buffer_load_dwordx4 a[104:107], v1, s[8:11], s88 offen offset:2048 sc1
	ds_read_b128 v[56:59], v2 offset:24576
	s_waitcnt lgkmcnt(3)
	v_mfma_f32_32x32x16_bf16 v[88:103], v[60:63], a[72:75], v[88:103]
	ds_read_b128 v[60:63], v2 offset:25600
	s_waitcnt lgkmcnt(3)
	s_waitcnt vmcnt(7)
	v_mfma_f32_32x32x16_bf16 v[72:87], v[64:67], a[76:79], v[72:87]
	buffer_load_dwordx4 a[108:111], v1, s[8:11], s88 offen offset:3072 sc1
	ds_read_b128 v[64:67], v2 offset:26624
	s_waitcnt lgkmcnt(3)
	v_mfma_f32_32x32x16_bf16 v[88:103], v[68:71], a[76:79], v[88:103]
	ds_read_b128 v[68:71], v2 offset:27648
	s_waitcnt lgkmcnt(3)
	s_waitcnt vmcnt(7)
	v_mfma_f32_32x32x16_bf16 v[72:87], v[56:59], a[80:83], v[72:87]
	s_add_u32 s88, s34, 0x8ef000
	buffer_load_dwordx4 a[112:115], v1, s[8:11], s88 offen offset:0 sc1
	ds_read_b128 v[56:59], v2 offset:28672
	s_waitcnt lgkmcnt(3)
	v_mfma_f32_32x32x16_bf16 v[88:103], v[60:63], a[80:83], v[88:103]
	ds_read_b128 v[60:63], v2 offset:29696
	s_waitcnt lgkmcnt(3)
	s_waitcnt vmcnt(7)
	v_mfma_f32_32x32x16_bf16 v[72:87], v[64:67], a[84:87], v[72:87]
	buffer_load_dwordx4 a[116:119], v1, s[8:11], s88 offen offset:1024 sc1
	ds_read_b128 v[64:67], v2 offset:30720
	s_waitcnt lgkmcnt(3)
	v_mfma_f32_32x32x16_bf16 v[88:103], v[68:71], a[84:87], v[88:103]
	ds_read_b128 v[68:71], v2 offset:31744
	s_waitcnt lgkmcnt(3)
	s_waitcnt vmcnt(7)
	v_mfma_f32_32x32x16_bf16 v[72:87], v[56:59], a[88:91], v[72:87]
	buffer_load_dwordx4 a[120:123], v1, s[8:11], s88 offen offset:2048 sc1
	ds_read_b128 v[56:59], v1 offset:0
	s_waitcnt lgkmcnt(3)
	v_mfma_f32_32x32x16_bf16 v[88:103], v[60:63], a[88:91], v[88:103]
	ds_read_b128 v[60:63], v1 offset:1024
	s_waitcnt lgkmcnt(3)
	s_waitcnt vmcnt(7)
	v_mfma_f32_32x32x16_bf16 v[72:87], v[64:67], a[92:95], v[72:87]
	s_add_u32 s93, s35, 0x23e8000
	buffer_load_dwordx2 v[136:137], v7, s[8:11], s93 offen offset:0 sc1
	buffer_load_dwordx2 v[138:139], v7, s[8:11], s93 offen offset:128 sc1
	buffer_load_dwordx2 v[140:141], v7, s[8:11], s93 offen offset:256 sc1
	buffer_load_dwordx2 v[142:143], v7, s[8:11], s93 offen offset:384 sc1
	ds_read_b128 v[64:67], v1 offset:2048
	s_waitcnt lgkmcnt(3)
	v_mfma_f32_32x32x16_bf16 v[88:103], v[68:71], a[92:95], v[88:103]
	buffer_load_dwordx4 a[124:127], v1, s[8:11], s88 offen offset:3072 sc1
	ds_read_b128 v[68:71], v1 offset:3072
	s_waitcnt lgkmcnt(3)
	s_waitcnt vmcnt(11)
	v_mfma_f32_32x32x16_bf16 v[72:87], v[56:59], a[96:99], v[72:87]
	s_add_u32 s88, s34, 0x8f0000
	buffer_load_dwordx4 a[128:131], v1, s[8:11], s88 offen offset:0 sc1
	ds_read_b128 v[56:59], v1 offset:4096
	s_waitcnt lgkmcnt(3)
	v_mfma_f32_32x32x16_bf16 v[88:103], v[60:63], a[96:99], v[88:103]
	ds_read_b128 v[60:63], v1 offset:5120
	s_waitcnt lgkmcnt(3)
	s_waitcnt vmcnt(11)
	v_mfma_f32_32x32x16_bf16 v[72:87], v[64:67], a[100:103], v[72:87]
	buffer_load_dwordx4 a[132:135], v1, s[8:11], s88 offen offset:1024 sc1
	ds_read_b128 v[64:67], v1 offset:6144
	s_waitcnt lgkmcnt(3)
	v_mfma_f32_32x32x16_bf16 v[88:103], v[68:71], a[100:103], v[88:103]
	ds_read_b128 v[68:71], v1 offset:7168
	s_waitcnt lgkmcnt(3)
	s_waitcnt vmcnt(11)
	v_mfma_f32_32x32x16_bf16 v[72:87], v[56:59], a[104:107], v[72:87]
	buffer_load_dwordx4 a[136:139], v1, s[8:11], s88 offen offset:2048 sc1
	ds_read_b128 v[56:59], v1 offset:8192
	s_waitcnt lgkmcnt(3)
	v_mfma_f32_32x32x16_bf16 v[88:103], v[60:63], a[104:107], v[88:103]
	ds_read_b128 v[60:63], v1 offset:9216
	s_waitcnt lgkmcnt(3)
	s_waitcnt vmcnt(11)
	v_mfma_f32_32x32x16_bf16 v[72:87], v[64:67], a[108:111], v[72:87]
	buffer_load_dwordx4 a[140:143], v1, s[8:11], s88 offen offset:3072 sc1
	ds_read_b128 v[64:67], v1 offset:10240
	s_waitcnt lgkmcnt(3)
	v_mfma_f32_32x32x16_bf16 v[88:103], v[68:71], a[108:111], v[88:103]
	ds_read_b128 v[68:71], v1 offset:11264
	s_waitcnt lgkmcnt(3)
	s_waitcnt vmcnt(11)
	v_mfma_f32_32x32x16_bf16 v[72:87], v[56:59], a[112:115], v[72:87]
	s_add_u32 s88, s34, 0x8f1000
	buffer_load_dwordx4 a[144:147], v1, s[8:11], s88 offen offset:0 sc1
	ds_read_b128 v[56:59], v1 offset:12288
	s_waitcnt lgkmcnt(3)
	v_mfma_f32_32x32x16_bf16 v[88:103], v[60:63], a[112:115], v[88:103]
	ds_read_b128 v[60:63], v1 offset:13312
	s_waitcnt lgkmcnt(3)
	s_waitcnt vmcnt(11)
	v_mfma_f32_32x32x16_bf16 v[72:87], v[64:67], a[116:119], v[72:87]
	buffer_load_dwordx4 v1, s[8:11], s89 offen offset:3072 lds
	ds_read_b128 v[64:67], v1 offset:14336
	s_waitcnt lgkmcnt(3)
	v_mfma_f32_32x32x16_bf16 v[88:103], v[68:71], a[116:119], v[88:103]
	ds_read_b128 v[68:71], v1 offset:15360
	s_waitcnt lgkmcnt(3)
	s_waitcnt vmcnt(11)
	v_mfma_f32_32x32x16_bf16 v[72:87], v[56:59], a[120:123], v[72:87]
	buffer_load_dwordx4 a[148:151], v1, s[8:11], s88 offen offset:1024 sc1
	ds_read_b128 v[56:59], v1 offset:16384
	s_waitcnt lgkmcnt(3)
	v_mfma_f32_32x32x16_bf16 v[88:103], v[60:63], a[120:123], v[88:103]
	ds_read_b128 v[60:63], v1 offset:17408
	s_waitcnt lgkmcnt(3)
	s_waitcnt vmcnt(7)
	v_mfma_f32_32x32x16_bf16 v[72:87], v[64:67], a[124:127], v[72:87]
	buffer_load_dwordx4 a[152:155], v1, s[8:11], s88 offen offset:2048 sc1
	ds_read_b128 v[64:67], v1 offset:18432
	s_waitcnt lgkmcnt(3)
	v_mfma_f32_32x32x16_bf16 v[88:103], v[68:71], a[124:127], v[88:103]
	buffer_load_dwordx4 a[156:159], v1, s[8:11], s88 offen offset:3072 sc1
	ds_read_b128 v[68:71], v1 offset:19456
	s_waitcnt lgkmcnt(3)
	s_waitcnt vmcnt(8)
	v_mfma_f32_32x32x16_bf16 v[72:87], v[56:59], a[128:131], v[72:87]
	s_add_u32 s89, s31, 0x20000
	s_add_u32 m0, s39, 0x20000
	s_nop 0
	buffer_load_dwordx4 v1, s[8:11], s89 offen offset:0 lds
	ds_read_b128 v[56:59], v1 offset:20480
	s_waitcnt lgkmcnt(3)
	v_mfma_f32_32x32x16_bf16 v[88:103], v[60:63], a[128:131], v[88:103]
	s_add_u32 s94, s33, 0x5000
	buffer_load_dwordx4 a[164:167], v1, s[8:11], s94 offen offset:0
	ds_read_b128 v[60:63], v1 offset:21504
	s_waitcnt lgkmcnt(3)
	s_waitcnt vmcnt(9)
	v_mfma_f32_32x32x16_bf16 v[72:87], v[64:67], a[132:135], v[72:87]
	buffer_load_dwordx4 v1, s[8:11], s89 offen offset:1024 lds
	ds_read_b128 v[64:67], v1 offset:22528
	s_waitcnt lgkmcnt(3)
	v_mfma_f32_32x32x16_bf16 v[88:103], v[68:71], a[132:135], v[88:103]
	ds_read_b128 v[68:71], v1 offset:23552
	s_waitcnt lgkmcnt(3)
	s_waitcnt vmcnt(9)
	v_mfma_f32_32x32x16_bf16 v[72:87], v[56:59], a[136:139], v[72:87]
	buffer_load_dwordx4 a[168:171], v1, s[8:11], s94 offen offset:1024
	ds_read_b128 v[56:59], v1 offset:24576
	s_waitcnt lgkmcnt(3)
	v_mfma_f32_32x32x16_bf16 v[88:103], v[60:63], a[136:139], v[88:103]
	ds_read_b128 v[60:63], v1 offset:25600
	s_waitcnt lgkmcnt(3)
	s_waitcnt vmcnt(9)
	v_mfma_f32_32x32x16_bf16 v[72:87], v[64:67], a[140:143], v[72:87]
	ds_read_b128 v[64:67], v1 offset:26624
	s_waitcnt lgkmcnt(3)
	v_mfma_f32_32x32x16_bf16 v[88:103], v[68:71], a[140:143], v[88:103]
	ds_read_b128 v[68:71], v1 offset:27648
	s_waitcnt lgkmcnt(3)
	s_waitcnt vmcnt(8)
	v_mfma_f32_32x32x16_bf16 v[72:87], v[56:59], a[144:147], v[72:87]
	ds_read_b128 v[56:59], v1 offset:28672
	s_waitcnt lgkmcnt(3)
	v_mfma_f32_32x32x16_bf16 v[88:103], v[60:63], a[144:147], v[88:103]
	v_add_f32 v136, v136, v138
	v_add_f32 v137, v137, v139
	v_add_f32 v140, v140, v142
	ds_read_b128 v[60:63], v1 offset:29696
	s_waitcnt lgkmcnt(3)
	buffer_load_dwordx4 v1, s[8:11], s89 offen offset:2048 lds
	s_waitcnt vmcnt(7)
	v_mfma_f32_32x32x16_bf16 v[72:87], v[64:67], a[148:151], v[72:87]
	v_add_f32 v141, v141, v143
	v_add_f32 v136, v136, v140
	v_add_f32 v137, v137, v141
	buffer_load_dwordx4 v1, s[8:11], s89 offen offset:3072 lds
	ds_read_b128 v[64:67], v1 offset:30720
	s_waitcnt lgkmcnt(3)
	v_mfma_f32_32x32x16_bf16 v[88:103], v[68:71], a[148:151], v[88:103]
	v_mov_b32 v138, v136
	v_mov_b32 v139, v137
	s_nop 0
	v_permlane32_swap_b32 v136, v138
	buffer_load_dwordx4 a[172:175], v1, s[8:11], s94 offen offset:2048
	ds_read_b128 v[68:71], v1 offset:31744
	s_waitcnt lgkmcnt(3)
	s_waitcnt vmcnt(8)
	v_mfma_f32_32x32x16_bf16 v[72:87], v[56:59], a[152:155], v[72:87]
	v_permlane32_swap_b32 v137, v139
	v_add_f32 v136, v136, v138
	v_add_f32 v137, v137, v139
	v_mul_f32 v136, 0x3acccccd, v136
	s_add_u32 s89, s31, 0x24000
	s_add_u32 m0, s39, 0x24000
	s_nop 0
	buffer_load_dwordx4 v1, s[8:11], s89 offen offset:0 lds
	ds_read_b128 v[56:59], v1 offset:32768
	s_waitcnt lgkmcnt(3)
	v_mfma_f32_32x32x16_bf16 v[88:103], v[60:63], a[152:155], v[88:103]
	v_mul_f32 v137, 0x3acccccd, v137
	v_fma_f32 v137, -v136, v136, v137
	v_max_f32 v137, 0, v137
	ds_read_b128 v[60:63], v1 offset:33792
	s_waitcnt lgkmcnt(3)
	s_waitcnt vmcnt(8)
	v_mfma_f32_32x32x16_bf16 v[72:87], v[64:67], a[156:159], v[72:87]
	v_add_f32 v137, 0x3727c5ac, v137
	v_cvt_pk_bf16_f32 v141, -v136, 0
	v_lshlrev_b32 v138, 16, v141
	ds_read_b128 v[64:67], v1 offset:34816
	s_waitcnt lgkmcnt(3)
	v_mfma_f32_32x32x16_bf16 v[88:103], v[68:71], a[156:159], v[88:103]
	v_sub_f32 v138, -v136, v138
	v_cvt_pk_bf16_f32 v140, -v136, v138
	v_rcp_f32 v31, v137
	ds_read_b128 v[68:71], v1 offset:35840
	s_waitcnt lgkmcnt(3)
	v_mfma_f32_32x32x8_bf16 v[104:119], a[248:249], v[140:141], 0
	v_mfma_f32_32x32x8_bf16 v[120:135], a[250:251], v[140:141], 0
	v_mfma_f32_32x32x8_bf16 v[72:87], a[244:245], v[140:141], v[72:87]
	s_nop 1
	v_mfma_f32_32x32x8_bf16 v[88:103], a[246:247], v[140:141], v[88:103]
	s_nop 4
	v_mfma_f32_32x32x16_bf16 v[104:119], v[56:59], a[0:3], v[104:119]
	buffer_load_dwordx4 a[176:179], v1, s[8:11], s94 offen offset:3072
	ds_read_b128 v[56:59], v1 offset:36864
	s_waitcnt lgkmcnt(3)
	v_mfma_f32_32x32x16_bf16 v[120:135], v[60:63], a[0:3], v[120:135]
	buffer_load_dwordx4 v1, s[8:11], s89 offen offset:1024 lds
	ds_read_b128 v[60:63], v1 offset:37888
	s_waitcnt lgkmcnt(3)
	v_mfma_f32_32x32x16_bf16 v[104:119], v[64:67], a[4:7], v[104:119]
	ds_read_b128 v[64:67], v1 offset:38912
	s_waitcnt lgkmcnt(3)
	v_mfma_f32_32x32x16_bf16 v[120:135], v[68:71], a[4:7], v[120:135]
	v_max_f32 v72, 0, v72
	v_max_f32 v73, 0, v73
	s_add_u32 s94, s33, 0x6000
	buffer_load_dwordx4 a[180:183], v1, s[8:11], s94 offen offset:0
	s_barrier
	ds_read_b128 v[68:71], v1 offset:39936
	s_waitcnt lgkmcnt(3)
	v_mfma_f32_32x32x16_bf16 v[104:119], v[56:59], a[8:11], v[104:119]
	v_mul_f32 v88, v31, v88
	v_mul_f32 v89, v31, v89
	buffer_load_dwordx4 v1, s[8:11], s89 offen offset:2048 lds
	ds_read_b128 v[56:59], v1 offset:40960
	s_waitcnt lgkmcnt(3)
	v_mfma_f32_32x32x16_bf16 v[120:135], v[60:63], a[8:11], v[120:135]
	v_mul_f32 v72, v72, v88
	v_mul_f32 v73, v73, v89
	ds_read_b128 v[60:63], v1 offset:41984
	s_waitcnt lgkmcnt(3)
	v_mfma_f32_32x32x16_bf16 v[104:119], v[64:67], a[12:15], v[104:119]
	v_cvt_pk_bf16_f32 v144, v72, v73
	v_max_f32 v74, 0, v74
	ds_read_b128 v[64:67], v1 offset:43008
	s_waitcnt lgkmcnt(3)
	v_mfma_f32_32x32x16_bf16 v[120:135], v[68:71], a[12:15], v[120:135]
	v_max_f32 v75, 0, v75
	v_mul_f32 v90, v31, v90
	ds_read_b128 v[68:71], v1 offset:44032
	s_waitcnt lgkmcnt(3)
	v_mfma_f32_32x32x16_bf16 v[104:119], v[56:59], a[16:19], v[104:119]
	v_mul_f32 v91, v31, v91
	v_mul_f32 v74, v74, v90
	ds_read_b128 v[56:59], v1 offset:45056
	s_waitcnt lgkmcnt(3)
	v_mfma_f32_32x32x16_bf16 v[120:135], v[60:63], a[16:19], v[120:135]
	v_mul_f32 v75, v75, v91
	v_cvt_pk_bf16_f32 v145, v74, v75
	ds_read_b128 v[60:63], v1 offset:46080
	s_waitcnt lgkmcnt(3)
	v_mfma_f32_32x32x16_bf16 v[104:119], v[64:67], a[20:23], v[104:119]
	v_max_f32 v76, 0, v76
	v_max_f32 v77, 0, v77
	s_add_u32 s94, s33, 0x8000
	buffer_load_dwordx4 a[184:187], v1, s[8:11], s94 offen offset:3072
	ds_read_b128 v[64:67], v1 offset:47104
	s_waitcnt lgkmcnt(3)
	v_mfma_f32_32x32x16_bf16 v[120:135], v[68:71], a[20:23], v[120:135]
	v_mul_f32 v92, v31, v92
	v_mul_f32 v93, v31, v93
	ds_read_b128 v[68:71], v1 offset:48128
	s_waitcnt lgkmcnt(3)
	v_mfma_f32_32x32x16_bf16 v[104:119], v[56:59], a[24:27], v[104:119]
	v_mul_f32 v76, v76, v92
	v_mul_f32 v77, v77, v93
	ds_read_b128 v[56:59], v2 offset:32768
	s_waitcnt lgkmcnt(3)
	v_mfma_f32_32x32x16_bf16 v[120:135], v[60:63], a[24:27], v[120:135]
	v_cvt_pk_bf16_f32 v146, v76, v77
	v_max_f32 v78, 0, v78
	ds_read_b128 v[60:63], v2 offset:33792
	s_waitcnt lgkmcnt(3)
	v_mfma_f32_32x32x16_bf16 v[104:119], v[64:67], a[28:31], v[104:119]
	v_max_f32 v79, 0, v79
	v_mul_f32 v94, v31, v94
	ds_read_b128 v[64:67], v2 offset:34816
	s_waitcnt lgkmcnt(3)
	v_mfma_f32_32x32x16_bf16 v[120:135], v[68:71], a[28:31], v[120:135]
	v_mul_f32 v95, v31, v95
	v_mul_f32 v78, v78, v94
	buffer_load_dwordx4 v1, s[8:11], s89 offen offset:3072 lds
	ds_read_b128 v[68:71], v2 offset:35840
	s_waitcnt lgkmcnt(3)
	v_mfma_f32_32x32x16_bf16 v[104:119], v[56:59], a[32:35], v[104:119]
	v_mul_f32 v79, v79, v95
	v_cvt_pk_bf16_f32 v147, v78, v79
	ds_read_b128 v[56:59], v2 offset:36864
	s_waitcnt lgkmcnt(3)
	v_mfma_f32_32x32x16_bf16 v[120:135], v[60:63], a[32:35], v[120:135]
	s_add_u32 s28, s43, 0x17e8000
	buffer_store_dwordx4 v[144:147], v11, s[8:11], s28 offen offset:0
	v_max_f32 v80, 0, v80
	ds_read_b128 v[60:63], v2 offset:37888
	s_waitcnt lgkmcnt(3)
	v_mfma_f32_32x32x16_bf16 v[104:119], v[64:67], a[36:39], v[104:119]
	v_max_f32 v81, 0, v81
	v_mul_f32 v96, v31, v96
	ds_read_b128 v[64:67], v2 offset:38912
	s_waitcnt lgkmcnt(3)
	v_mfma_f32_32x32x16_bf16 v[120:135], v[68:71], a[36:39], v[120:135]
	v_mul_f32 v97, v31, v97
	v_mul_f32 v80, v80, v96
	ds_read_b128 v[68:71], v2 offset:39936
	s_waitcnt lgkmcnt(3)
	v_mfma_f32_32x32x16_bf16 v[104:119], v[56:59], a[40:43], v[104:119]
	v_mul_f32 v81, v81, v97
	v_cvt_pk_bf16_f32 v148, v80, v81
	s_add_u32 s89, s31, 0x28000
	s_add_u32 m0, s39, 0xc000
	s_nop 0
	buffer_load_dwordx4 v1, s[8:11], s89 offen offset:0 lds
	ds_read_b128 v[56:59], v2 offset:40960
	s_waitcnt lgkmcnt(3)
	v_mfma_f32_32x32x16_bf16 v[120:135], v[60:63], a[40:43], v[120:135]
	v_max_f32 v82, 0, v82
	v_max_f32 v83, 0, v83
	ds_read_b128 v[60:63], v2 offset:41984
	s_waitcnt lgkmcnt(3)
	v_mfma_f32_32x32x16_bf16 v[104:119], v[64:67], a[44:47], v[104:119]
	v_mul_f32 v98, v31, v98
	v_mul_f32 v99, v31, v99
	ds_read_b128 v[64:67], v2 offset:43008
	s_waitcnt lgkmcnt(3)
	v_mfma_f32_32x32x16_bf16 v[120:135], v[68:71], a[44:47], v[120:135]
	v_mul_f32 v82, v82, v98
	v_mul_f32 v83, v83, v99
	ds_read_b128 v[68:71], v2 offset:44032
	s_waitcnt lgkmcnt(3)
	v_mfma_f32_32x32x16_bf16 v[104:119], v[56:59], a[48:51], v[104:119]
	v_cvt_pk_bf16_f32 v149, v82, v83
	v_max_f32 v84, 0, v84
	buffer_load_dwordx4 v1, s[8:11], s89 offen offset:1024 lds
	ds_read_b128 v[56:59], v2 offset:45056
	s_waitcnt lgkmcnt(3)
	v_mfma_f32_32x32x16_bf16 v[120:135], v[60:63], a[48:51], v[120:135]
	v_max_f32 v85, 0, v85
	v_mul_f32 v100, v31, v100
	ds_read_b128 v[60:63], v2 offset:46080
	s_waitcnt lgkmcnt(3)
	v_mfma_f32_32x32x16_bf16 v[104:119], v[64:67], a[52:55], v[104:119]
	v_mul_f32 v101, v31, v101
	v_mul_f32 v84, v84, v100
	buffer_load_dwordx4 v1, s[8:11], s89 offen offset:2048 lds
	ds_read_b128 v[64:67], v2 offset:47104
	s_waitcnt lgkmcnt(3)
	v_mfma_f32_32x32x16_bf16 v[120:135], v[68:71], a[52:55], v[120:135]
	v_mul_f32 v85, v85, v101
	v_cvt_pk_bf16_f32 v150, v84, v85
	ds_read_b128 v[68:71], v2 offset:48128
	s_waitcnt lgkmcnt(3)
	v_mfma_f32_32x32x16_bf16 v[104:119], v[56:59], a[56:59], v[104:119]
	v_max_f32 v86, 0, v86
	v_max_f32 v87, 0, v87
	ds_read_b128 v[56:59], v2 offset:49152
	s_waitcnt lgkmcnt(3)
	v_mfma_f32_32x32x16_bf16 v[120:135], v[60:63], a[56:59], v[120:135]
	v_mul_f32 v102, v31, v102
	v_mul_f32 v103, v31, v103
	ds_read_b128 v[60:63], v2 offset:50176
	s_waitcnt lgkmcnt(3)
	v_mfma_f32_32x32x16_bf16 v[104:119], v[64:67], a[60:63], v[104:119]
	v_mul_f32 v86, v86, v102
	v_mul_f32 v87, v87, v103
	buffer_load_dwordx4 v1, s[8:11], s89 offen offset:3072 lds
	ds_read_b128 v[64:67], v2 offset:51200
	s_waitcnt lgkmcnt(3)
	v_mfma_f32_32x32x16_bf16 v[120:135], v[68:71], a[60:63], v[120:135]
	v_cvt_pk_bf16_f32 v151, v86, v87
	s_add_u32 s28, s43, 0x17e8000
	buffer_store_dwordx4 v[148:151], v11, s[8:11], s28 offen offset:512
	ds_read_b128 v[68:71], v2 offset:52224
	s_waitcnt lgkmcnt(3)
	v_mfma_f32_32x32x16_bf16 v[104:119], v[56:59], a[64:67], v[104:119]
	ds_read_b128 v[56:59], v2 offset:53248
	s_waitcnt lgkmcnt(3)
	v_mfma_f32_32x32x16_bf16 v[120:135], v[60:63], a[64:67], v[120:135]
	ds_read_b128 v[60:63], v2 offset:54272
	s_waitcnt lgkmcnt(3)
	v_mfma_f32_32x32x16_bf16 v[104:119], v[64:67], a[68:71], v[104:119]
	ds_read_b128 v[64:67], v2 offset:55296
	s_waitcnt lgkmcnt(3)
	v_mfma_f32_32x32x16_bf16 v[120:135], v[68:71], a[68:71], v[120:135]
	ds_read_b128 v[68:71], v2 offset:56320
	s_waitcnt lgkmcnt(3)
	v_mfma_f32_32x32x16_bf16 v[104:119], v[56:59], a[72:75], v[104:119]
	s_add_u32 s89, s31, 0x2c000
	s_add_u32 m0, s39, 0x10000
	s_nop 0
	buffer_load_dwordx4 v1, s[8:11], s89 offen offset:0 lds
	ds_read_b128 v[56:59], v2 offset:57344
	s_waitcnt lgkmcnt(3)
	v_mfma_f32_32x32x16_bf16 v[120:135], v[60:63], a[72:75], v[120:135]
	ds_read_b128 v[60:63], v2 offset:58368
	s_waitcnt lgkmcnt(3)
	v_mfma_f32_32x32x16_bf16 v[104:119], v[64:67], a[76:79], v[104:119]
	buffer_load_dwordx4 v1, s[8:11], s89 offen offset:1024 lds
	ds_read_b128 v[64:67], v2 offset:59392
	s_waitcnt lgkmcnt(3)
	v_mfma_f32_32x32x16_bf16 v[120:135], v[68:71], a[76:79], v[120:135]
	buffer_load_dwordx4 v1, s[8:11], s89 offen offset:2048 lds
	ds_read_b128 v[68:71], v2 offset:60416
	s_waitcnt lgkmcnt(3)
	v_mfma_f32_32x32x16_bf16 v[104:119], v[56:59], a[80:83], v[104:119]
	ds_read_b128 v[56:59], v2 offset:61440
	s_waitcnt lgkmcnt(3)
	v_mfma_f32_32x32x16_bf16 v[120:135], v[60:63], a[80:83], v[120:135]
	ds_read_b128 v[60:63], v2 offset:62464
	s_waitcnt lgkmcnt(3)
	v_mfma_f32_32x32x16_bf16 v[104:119], v[64:67], a[84:87], v[104:119]
	ds_read_b128 v[64:67], v2 offset:63488
	s_waitcnt lgkmcnt(3)
	v_mfma_f32_32x32x16_bf16 v[120:135], v[68:71], a[84:87], v[120:135]
	s_add_u32 s94, s33, 0x9000
	buffer_load_dwordx4 a[188:191], v1, s[8:11], s94 offen offset:0
	ds_read_b128 v[68:71], v2 offset:64512
	s_waitcnt lgkmcnt(3)
	v_mfma_f32_32x32x16_bf16 v[104:119], v[56:59], a[88:91], v[104:119]
	s_waitcnt vmcnt(10)
	s_barrier
	ds_read_b128 v[56:59], v3 offset:0
	s_waitcnt lgkmcnt(3)
	v_mfma_f32_32x32x16_bf16 v[120:135], v[60:63], a[88:91], v[120:135]
	ds_read_b128 v[60:63], v3 offset:1024
	s_waitcnt lgkmcnt(3)
	v_mfma_f32_32x32x16_bf16 v[104:119], v[64:67], a[92:95], v[104:119]
	buffer_load_dwordx4 v1, s[8:11], s89 offen offset:3072 lds
	ds_read_b128 v[64:67], v3 offset:2048
	s_waitcnt lgkmcnt(3)
	v_mfma_f32_32x32x16_bf16 v[120:135], v[68:71], a[92:95], v[120:135]
	ds_read_b128 v[68:71], v3 offset:3072
	s_waitcnt lgkmcnt(3)
	v_mfma_f32_32x32x16_bf16 v[104:119], v[56:59], a[96:99], v[104:119]
	ds_read_b128 v[56:59], v3 offset:4096
	s_waitcnt lgkmcnt(3)
	v_mfma_f32_32x32x16_bf16 v[120:135], v[60:63], a[96:99], v[120:135]
	ds_read_b128 v[60:63], v3 offset:5120
	s_waitcnt lgkmcnt(3)
	v_mfma_f32_32x32x16_bf16 v[104:119], v[64:67], a[100:103], v[104:119]
	buffer_load_dwordx4 a[192:195], v1, s[8:11], s94 offen offset:1024
	ds_read_b128 v[64:67], v3 offset:6144
	s_waitcnt lgkmcnt(3)
	v_mfma_f32_32x32x16_bf16 v[120:135], v[68:71], a[100:103], v[120:135]
	ds_read_b128 v[68:71], v3 offset:7168
	s_waitcnt lgkmcnt(3)
	v_mfma_f32_32x32x16_bf16 v[104:119], v[56:59], a[104:107], v[104:119]
	ds_read_b128 v[56:59], v3 offset:8192
	s_waitcnt lgkmcnt(3)
	v_mfma_f32_32x32x16_bf16 v[120:135], v[60:63], a[104:107], v[120:135]
	ds_read_b128 v[60:63], v3 offset:9216
	s_waitcnt lgkmcnt(3)
	v_mfma_f32_32x32x16_bf16 v[104:119], v[64:67], a[108:111], v[104:119]
	ds_read_b128 v[64:67], v3 offset:10240
	s_waitcnt lgkmcnt(3)
	v_mfma_f32_32x32x16_bf16 v[120:135], v[68:71], a[108:111], v[120:135]
	s_add_u32 s89, s31, 0x30000
	s_add_u32 m0, s39, 0x14000
	s_nop 0
	buffer_load_dwordx4 v1, s[8:11], s89 offen offset:0 lds
	ds_read_b128 v[68:71], v3 offset:11264
	s_waitcnt lgkmcnt(3)
	v_mfma_f32_32x32x16_bf16 v[104:119], v[56:59], a[112:115], v[104:119]
	buffer_load_dwordx4 v1, s[8:11], s89 offen offset:1024 lds
	ds_read_b128 v[56:59], v3 offset:12288
	s_waitcnt lgkmcnt(3)
	v_mfma_f32_32x32x16_bf16 v[120:135], v[60:63], a[112:115], v[120:135]
	ds_read_b128 v[60:63], v3 offset:13312
	s_waitcnt lgkmcnt(3)
	v_mfma_f32_32x32x16_bf16 v[104:119], v[64:67], a[116:119], v[104:119]
	ds_read_b128 v[64:67], v3 offset:14336
	s_waitcnt lgkmcnt(3)
	v_mfma_f32_32x32x16_bf16 v[120:135], v[68:71], a[116:119], v[120:135]
	buffer_load_dwordx4 a[196:199], v1, s[8:11], s94 offen offset:2048
	ds_read_b128 v[68:71], v3 offset:15360
	s_waitcnt lgkmcnt(3)
	v_mfma_f32_32x32x16_bf16 v[104:119], v[56:59], a[120:123], v[104:119]
	ds_read_b128 v[56:59], v3 offset:16384
	s_waitcnt lgkmcnt(3)
	v_mfma_f32_32x32x16_bf16 v[120:135], v[60:63], a[120:123], v[120:135]
	ds_read_b128 v[60:63], v3 offset:17408
	s_waitcnt lgkmcnt(3)
	v_mfma_f32_32x32x16_bf16 v[104:119], v[64:67], a[124:127], v[104:119]
	ds_read_b128 v[64:67], v3 offset:18432
	s_waitcnt lgkmcnt(3)
	v_mfma_f32_32x32x16_bf16 v[120:135], v[68:71], a[124:127], v[120:135]
	buffer_load_dwordx4 v1, s[8:11], s89 offen offset:2048 lds
	ds_read_b128 v[68:71], v3 offset:19456
	s_waitcnt lgkmcnt(3)
	v_mfma_f32_32x32x16_bf16 v[104:119], v[56:59], a[128:131], v[104:119]
	ds_read_b128 v[56:59], v3 offset:20480
	s_waitcnt lgkmcnt(3)
	v_mfma_f32_32x32x16_bf16 v[120:135], v[60:63], a[128:131], v[120:135]
	ds_read_b128 v[60:63], v3 offset:21504
	s_waitcnt lgkmcnt(3)
	v_mfma_f32_32x32x16_bf16 v[104:119], v[64:67], a[132:135], v[104:119]
	ds_read_b128 v[64:67], v3 offset:22528
	s_waitcnt lgkmcnt(3)
	v_mfma_f32_32x32x16_bf16 v[120:135], v[68:71], a[132:135], v[120:135]
	buffer_load_dwordx4 a[200:203], v1, s[8:11], s94 offen offset:3072
	ds_read_b128 v[68:71], v3 offset:23552
	s_waitcnt lgkmcnt(3)
	v_mfma_f32_32x32x16_bf16 v[104:119], v[56:59], a[136:139], v[104:119]
	ds_read_b128 v[56:59], v3 offset:24576
	s_waitcnt lgkmcnt(3)
	v_mfma_f32_32x32x16_bf16 v[120:135], v[60:63], a[136:139], v[120:135]
	ds_read_b128 v[60:63], v3 offset:25600
	s_waitcnt lgkmcnt(3)
	v_mfma_f32_32x32x16_bf16 v[104:119], v[64:67], a[140:143], v[104:119]
	ds_read_b128 v[64:67], v3 offset:26624
	s_waitcnt lgkmcnt(3)
	v_mfma_f32_32x32x16_bf16 v[120:135], v[68:71], a[140:143], v[120:135]
	buffer_load_dwordx4 v1, s[8:11], s89 offen offset:3072 lds
	ds_read_b128 v[68:71], v3 offset:27648
	s_waitcnt lgkmcnt(3)
	v_mfma_f32_32x32x16_bf16 v[104:119], v[56:59], a[144:147], v[104:119]
	ds_read_b128 v[56:59], v3 offset:28672
	s_waitcnt lgkmcnt(3)
	v_mfma_f32_32x32x16_bf16 v[120:135], v[60:63], a[144:147], v[120:135]
	s_add_u32 s89, s31, 0x34000
	s_add_u32 m0, s39, 0
	s_nop 0
	buffer_load_dwordx4 v1, s[8:11], s89 offen offset:0 lds
	ds_read_b128 v[60:63], v3 offset:29696
	s_waitcnt lgkmcnt(3)
	v_mfma_f32_32x32x16_bf16 v[104:119], v[64:67], a[148:151], v[104:119]
	ds_read_b128 v[64:67], v3 offset:30720
	s_waitcnt lgkmcnt(3)
	v_mfma_f32_32x32x16_bf16 v[120:135], v[68:71], a[148:151], v[120:135]
	ds_read_b128 v[68:71], v3 offset:31744
	s_waitcnt lgkmcnt(3)
	v_mfma_f32_32x32x8_bf16 v[72:87], a[252:253], v[140:141], 0
	v_mfma_f32_32x32x8_bf16 v[88:103], a[254:255], v[140:141], 0
	v_mfma_f32_32x32x16_bf16 v[104:119], v[56:59], a[152:155], v[104:119]
	buffer_load_dwordx4 v1, s[8:11], s89 offen offset:1024 lds
	s_waitcnt vmcnt(9)
	s_barrier
	ds_read_b128 v[56:59], v1 offset:49152
	s_waitcnt lgkmcnt(3)
	v_mfma_f32_32x32x16_bf16 v[120:135], v[60:63], a[152:155], v[120:135]
	s_add_u32 s94, s33, 0xc000
	buffer_load_dwordx4 a[204:207], v1, s[8:11], s94 offen offset:2048
	ds_read_b128 v[60:63], v1 offset:50176
	s_waitcnt lgkmcnt(3)
	v_mfma_f32_32x32x16_bf16 v[104:119], v[64:67], a[156:159], v[104:119]
	ds_read_b128 v[64:67], v1 offset:51200
	s_waitcnt lgkmcnt(3)
	v_mfma_f32_32x32x16_bf16 v[120:135], v[68:71], a[156:159], v[120:135]
	ds_read_b128 v[68:71], v1 offset:52224
	s_waitcnt lgkmcnt(3)
	v_mfma_f32_32x32x16_bf16 v[72:87], v[56:59], a[0:3], v[72:87]
	buffer_load_dwordx4 v1, s[8:11], s89 offen offset:2048 lds
	ds_read_b128 v[56:59], v1 offset:53248
	s_waitcnt lgkmcnt(3)
	v_mfma_f32_32x32x16_bf16 v[88:103], v[60:63], a[0:3], v[88:103]
	ds_read_b128 v[60:63], v1 offset:54272
	s_waitcnt lgkmcnt(3)
	v_mfma_f32_32x32x16_bf16 v[72:87], v[64:67], a[4:7], v[72:87]
	v_max_f32 v104, 0, v104
	v_max_f32 v105, 0, v105
	v_mul_f32 v120, v31, v120
	v_mul_f32 v121, v31, v121
	ds_read_b128 v[64:67], v1 offset:55296
	s_waitcnt lgkmcnt(3)
	v_mfma_f32_32x32x16_bf16 v[88:103], v[68:71], a[4:7], v[88:103]
	v_mul_f32 v104, v104, v120
	v_mul_f32 v105, v105, v121
	v_cvt_pk_bf16_f32 v144, v104, v105
	v_max_f32 v106, 0, v106
	ds_read_b128 v[68:71], v1 offset:56320
	s_waitcnt lgkmcnt(3)
	v_mfma_f32_32x32x16_bf16 v[72:87], v[56:59], a[8:11], v[72:87]
	v_max_f32 v107, 0, v107
	v_mul_f32 v122, v31, v122
	v_mul_f32 v123, v31, v123
	buffer_load_dwordx4 a[208:211], v1, s[8:11], s94 offen offset:3072
	ds_read_b128 v[56:59], v1 offset:57344
	s_waitcnt lgkmcnt(3)
	v_mfma_f32_32x32x16_bf16 v[88:103], v[60:63], a[8:11], v[88:103]
	v_mul_f32 v106, v106, v122
	v_mul_f32 v107, v107, v123
	v_cvt_pk_bf16_f32 v145, v106, v107
	v_max_f32 v108, 0, v108
	ds_read_b128 v[60:63], v1 offset:58368
	s_waitcnt lgkmcnt(3)
	v_mfma_f32_32x32x16_bf16 v[72:87], v[64:67], a[12:15], v[72:87]
	v_max_f32 v109, 0, v109
	v_mul_f32 v124, v31, v124
	v_mul_f32 v125, v31, v125
	v_mul_f32 v108, v108, v124
	buffer_load_dwordx4 v1, s[8:11], s89 offen offset:3072 lds
	ds_read_b128 v[64:67], v1 offset:59392
	s_waitcnt lgkmcnt(3)
	v_mfma_f32_32x32x16_bf16 v[88:103], v[68:71], a[12:15], v[88:103]
	v_mul_f32 v109, v109, v125
	v_cvt_pk_bf16_f32 v146, v108, v109
	v_max_f32 v110, 0, v110
	ds_read_b128 v[68:71], v1 offset:60416
	s_waitcnt lgkmcnt(3)
	v_mfma_f32_32x32x16_bf16 v[72:87], v[56:59], a[16:19], v[72:87]
	v_max_f32 v111, 0, v111
	v_mul_f32 v126, v31, v126
	v_mul_f32 v127, v31, v127
	v_mul_f32 v110, v110, v126
	ds_read_b128 v[56:59], v1 offset:61440
	s_waitcnt lgkmcnt(3)
	v_mfma_f32_32x32x16_bf16 v[88:103], v[60:63], a[16:19], v[88:103]
	v_mul_f32 v111, v111, v127
	v_cvt_pk_bf16_f32 v147, v110, v111
	s_add_u32 s28, s43, 0x17e8000
	buffer_store_dwordx4 v[144:147], v11, s[8:11], s28 offen offset:1024
	ds_read_b128 v[60:63], v1 offset:62464
	s_waitcnt lgkmcnt(3)
	v_mfma_f32_32x32x16_bf16 v[72:87], v[64:67], a[20:23], v[72:87]
	v_max_f32 v112, 0, v112
	v_max_f32 v113, 0, v113
	v_mul_f32 v128, v31, v128
	v_mul_f32 v129, v31, v129
	ds_read_b128 v[64:67], v1 offset:63488
	s_waitcnt lgkmcnt(3)
	v_mfma_f32_32x32x16_bf16 v[88:103], v[68:71], a[20:23], v[88:103]
	v_mul_f32 v112, v112, v128
	v_mul_f32 v113, v113, v129
	v_cvt_pk_bf16_f32 v148, v112, v113
	v_max_f32 v114, 0, v114
	ds_read_b128 v[68:71], v1 offset:64512
	s_waitcnt lgkmcnt(3)
	v_mfma_f32_32x32x16_bf16 v[72:87], v[56:59], a[24:27], v[72:87]
	v_max_f32 v115, 0, v115
	v_mul_f32 v130, v31, v130
	v_mul_f32 v131, v31, v131
	s_add_u32 s89, s31, 0x38000
	s_add_u32 m0, s39, 0x4000
	s_nop 0
	buffer_load_dwordx4 v1, s[8:11], s89 offen offset:0 lds
	ds_read_b128 v[56:59], v2 offset:0
	s_waitcnt lgkmcnt(3)
	v_mfma_f32_32x32x16_bf16 v[88:103], v[60:63], a[24:27], v[88:103]
	v_mul_f32 v114, v114, v130
	v_mul_f32 v115, v115, v131
	v_cvt_pk_bf16_f32 v149, v114, v115
	v_max_f32 v116, 0, v116
	ds_read_b128 v[60:63], v2 offset:1024
	s_waitcnt lgkmcnt(3)
	v_mfma_f32_32x32x16_bf16 v[72:87], v[64:67], a[28:31], v[72:87]
	v_max_f32 v117, 0, v117
	v_mul_f32 v132, v31, v132
	v_mul_f32 v133, v31, v133
	v_mul_f32 v116, v116, v132
	ds_read_b128 v[64:67], v2 offset:2048
	s_waitcnt lgkmcnt(3)
	v_mfma_f32_32x32x16_bf16 v[88:103], v[68:71], a[28:31], v[88:103]
	v_mul_f32 v117, v117, v133
	v_cvt_pk_bf16_f32 v150, v116, v117
	v_max_f32 v118, 0, v118
	ds_read_b128 v[68:71], v2 offset:3072
	s_waitcnt lgkmcnt(3)
	v_mfma_f32_32x32x16_bf16 v[72:87], v[56:59], a[32:35], v[72:87]
	v_max_f32 v119, 0, v119
	v_mul_f32 v134, v31, v134
	v_mul_f32 v135, v31, v135
	v_mul_f32 v118, v118, v134
	buffer_load_dwordx4 v1, s[8:11], s89 offen offset:1024 lds
	ds_read_b128 v[56:59], v2 offset:4096
	s_waitcnt lgkmcnt(3)
	v_mfma_f32_32x32x16_bf16 v[88:103], v[60:63], a[32:35], v[88:103]
	v_mul_f32 v119, v119, v135
	v_cvt_pk_bf16_f32 v151, v118, v119
	s_add_u32 s28, s43, 0x17e8000
	buffer_store_dwordx4 v[148:151], v11, s[8:11], s28 offen offset:1536
	ds_read_b128 v[60:63], v2 offset:5120
	s_waitcnt lgkmcnt(3)
	v_mfma_f32_32x32x16_bf16 v[72:87], v[64:67], a[36:39], v[72:87]
	ds_read_b128 v[64:67], v2 offset:6144
	s_waitcnt lgkmcnt(3)
	v_mfma_f32_32x32x16_bf16 v[88:103], v[68:71], a[36:39], v[88:103]
	ds_read_b128 v[68:71], v2 offset:7168
	s_waitcnt lgkmcnt(3)
	v_mfma_f32_32x32x16_bf16 v[72:87], v[56:59], a[40:43], v[72:87]
	ds_read_b128 v[56:59], v2 offset:8192
	s_waitcnt lgkmcnt(3)
	v_mfma_f32_32x32x16_bf16 v[88:103], v[60:63], a[40:43], v[88:103]
	ds_read_b128 v[60:63], v2 offset:9216
	s_waitcnt lgkmcnt(3)
	v_mfma_f32_32x32x16_bf16 v[72:87], v[64:67], a[44:47], v[72:87]
	buffer_load_dwordx4 v1, s[8:11], s89 offen offset:2048 lds
	ds_read_b128 v[64:67], v2 offset:10240
	s_waitcnt lgkmcnt(3)
	v_mfma_f32_32x32x16_bf16 v[88:103], v[68:71], a[44:47], v[88:103]
	ds_read_b128 v[68:71], v2 offset:11264
	s_waitcnt lgkmcnt(3)
	v_mfma_f32_32x32x16_bf16 v[72:87], v[56:59], a[48:51], v[72:87]
	buffer_load_dwordx4 v1, s[8:11], s89 offen offset:3072 lds
	ds_read_b128 v[56:59], v2 offset:12288
	s_waitcnt lgkmcnt(3)
	v_mfma_f32_32x32x16_bf16 v[88:103], v[60:63], a[48:51], v[88:103]
	ds_read_b128 v[60:63], v2 offset:13312
	s_waitcnt lgkmcnt(3)
	v_mfma_f32_32x32x16_bf16 v[72:87], v[64:67], a[52:55], v[72:87]
	ds_read_b128 v[64:67], v2 offset:14336
	s_waitcnt lgkmcnt(3)
	v_mfma_f32_32x32x16_bf16 v[88:103], v[68:71], a[52:55], v[88:103]
	ds_read_b128 v[68:71], v2 offset:15360
	s_waitcnt lgkmcnt(3)
	v_mfma_f32_32x32x16_bf16 v[72:87], v[56:59], a[56:59], v[72:87]
	s_add_u32 s93, s38, 0x261a000
	buffer_load_dword v0, v14, s[8:11], s93 offen offset:0 sc1
	s_add_u32 s94, s33, 0xd000
	buffer_load_dwordx4 a[212:215], v1, s[8:11], s94 offen offset:0
	s_waitcnt vmcnt(8)
	s_barrier
	ds_read_b128 v[56:59], v2 offset:16384
	s_waitcnt lgkmcnt(3)
	v_mfma_f32_32x32x16_bf16 v[88:103], v[60:63], a[56:59], v[88:103]
	buffer_load_dwordx4 a[216:219], v1, s[8:11], s94 offen offset:1024
	ds_read_b128 v[60:63], v2 offset:17408
	s_waitcnt lgkmcnt(3)
	v_mfma_f32_32x32x16_bf16 v[72:87], v[64:67], a[60:63], v[72:87]
	buffer_load_dwordx4 a[220:223], v1, s[8:11], s94 offen offset:2048
	ds_read_b128 v[64:67], v2 offset:18432
	s_waitcnt lgkmcnt(3)
	v_mfma_f32_32x32x16_bf16 v[88:103], v[68:71], a[60:63], v[88:103]
	ds_read_b128 v[68:71], v2 offset:19456
	s_waitcnt lgkmcnt(3)
	v_mfma_f32_32x32x16_bf16 v[72:87], v[56:59], a[64:67], v[72:87]
	s_add_u32 s94, s33, 0x2000
	buffer_load_dwordx4 a[224:227], v1, s[8:11], s94 offen offset:2048
	ds_read_b128 v[56:59], v2 offset:20480
	s_waitcnt lgkmcnt(3)
	v_mfma_f32_32x32x16_bf16 v[88:103], v[60:63], a[64:67], v[88:103]
	ds_read_b128 v[60:63], v2 offset:21504
	s_waitcnt lgkmcnt(3)
	v_mfma_f32_32x32x16_bf16 v[72:87], v[64:67], a[68:71], v[72:87]
	ds_read_b128 v[64:67], v2 offset:22528
	s_waitcnt lgkmcnt(3)
	v_mfma_f32_32x32x16_bf16 v[88:103], v[68:71], a[68:71], v[88:103]
	ds_read_b128 v[68:71], v2 offset:23552
	s_waitcnt lgkmcnt(3)
	v_mfma_f32_32x32x16_bf16 v[72:87], v[56:59], a[72:75], v[72:87]
	buffer_load_dwordx4 a[228:231], v1, s[8:11], s94 offen offset:3072
	ds_read_b128 v[56:59], v2 offset:24576
	s_waitcnt lgkmcnt(3)
	v_mfma_f32_32x32x16_bf16 v[88:103], v[60:63], a[72:75], v[88:103]
	s_add_u32 s94, s33, 0x3000
	buffer_load_dwordx4 a[232:235], v1, s[8:11], s94 offen offset:0
	ds_read_b128 v[60:63], v2 offset:25600
	s_waitcnt lgkmcnt(3)
	v_mfma_f32_32x32x16_bf16 v[72:87], v[64:67], a[76:79], v[72:87]
	ds_read_b128 v[64:67], v2 offset:26624
	s_waitcnt lgkmcnt(3)
	v_mfma_f32_32x32x16_bf16 v[88:103], v[68:71], a[76:79], v[88:103]
	ds_read_b128 v[68:71], v2 offset:27648
	s_waitcnt lgkmcnt(3)
	v_mfma_f32_32x32x16_bf16 v[72:87], v[56:59], a[80:83], v[72:87]
	ds_read_b128 v[56:59], v2 offset:28672
	s_waitcnt lgkmcnt(3)
	v_mfma_f32_32x32x16_bf16 v[88:103], v[60:63], a[80:83], v[88:103]
	ds_read_b128 v[60:63], v2 offset:29696
	s_waitcnt lgkmcnt(3)
	v_mfma_f32_32x32x16_bf16 v[72:87], v[64:67], a[84:87], v[72:87]
	buffer_load_dwordx4 a[236:239], v1, s[8:11], s94 offen offset:1024
	ds_read_b128 v[64:67], v2 offset:30720
	s_waitcnt lgkmcnt(3)
	v_mfma_f32_32x32x16_bf16 v[88:103], v[68:71], a[84:87], v[88:103]
	ds_read_b128 v[68:71], v2 offset:31744
	s_waitcnt lgkmcnt(3)
	v_mfma_f32_32x32x16_bf16 v[72:87], v[56:59], a[88:91], v[72:87]
	v_mov_b32 v254, 2
	s_add_u32 s29, s44, 0x261a000
	s_waitcnt vmcnt(10)
	s_cmp_eq_u32 s25, 0
	s_cbranch_scc1 slow_41
	buffer_store_dword v254, v16, s[8:11], s29 offen
back_42:
	ds_read_b128 v[56:59], v1 offset:0
	s_waitcnt lgkmcnt(3)
	v_mfma_f32_32x32x16_bf16 v[88:103], v[60:63], a[88:91], v[88:103]
	ds_read_b128 v[60:63], v1 offset:1024
	s_waitcnt lgkmcnt(3)
	v_mfma_f32_32x32x16_bf16 v[72:87], v[64:67], a[92:95], v[72:87]
	buffer_load_dwordx4 a[240:243], v1, s[8:11], s94 offen offset:2048
	ds_read_b128 v[64:67], v1 offset:2048
	s_waitcnt lgkmcnt(3)
	v_mfma_f32_32x32x16_bf16 v[88:103], v[68:71], a[92:95], v[88:103]
	ds_read_b128 v[68:71], v1 offset:3072
	s_waitcnt lgkmcnt(3)
	v_mfma_f32_32x32x16_bf16 v[72:87], v[56:59], a[96:99], v[72:87]
	ds_read_b128 v[56:59], v1 offset:4096
	s_waitcnt lgkmcnt(3)
	v_mfma_f32_32x32x16_bf16 v[88:103], v[60:63], a[96:99], v[88:103]
	ds_read_b128 v[60:63], v1 offset:5120
	s_waitcnt lgkmcnt(3)
	v_mfma_f32_32x32x16_bf16 v[72:87], v[64:67], a[100:103], v[72:87]
	ds_read_b128 v[64:67], v1 offset:6144
	s_waitcnt lgkmcnt(3)
	v_mfma_f32_32x32x16_bf16 v[88:103], v[68:71], a[100:103], v[88:103]
	s_add_u32 s94, s33, 0x6000
	buffer_load_dwordx4 a[244:247], v1, s[8:11], s94 offen offset:1024
	ds_read_b128 v[68:71], v1 offset:7168
	s_waitcnt lgkmcnt(3)
	v_mfma_f32_32x32x16_bf16 v[72:87], v[56:59], a[104:107], v[72:87]
	ds_read_b128 v[56:59], v1 offset:8192
	s_waitcnt lgkmcnt(3)
	v_mfma_f32_32x32x16_bf16 v[88:103], v[60:63], a[104:107], v[88:103]
	buffer_load_dwordx4 a[248:251], v1, s[8:11], s94 offen offset:2048
	ds_read_b128 v[60:63], v1 offset:9216
	s_waitcnt lgkmcnt(3)
	v_mfma_f32_32x32x16_bf16 v[72:87], v[64:67], a[108:111], v[72:87]
	ds_read_b128 v[64:67], v1 offset:10240
	s_waitcnt lgkmcnt(3)
	v_mfma_f32_32x32x16_bf16 v[88:103], v[68:71], a[108:111], v[88:103]
	buffer_load_dwordx4 a[252:255], v1, s[8:11], s94 offen offset:3072
	ds_read_b128 v[68:71], v1 offset:11264
	s_waitcnt lgkmcnt(3)
	v_mfma_f32_32x32x16_bf16 v[72:87], v[56:59], a[112:115], v[72:87]
	ds_read_b128 v[56:59], v1 offset:12288
	s_waitcnt lgkmcnt(3)
	v_mfma_f32_32x32x16_bf16 v[88:103], v[60:63], a[112:115], v[88:103]
	s_add_u32 s94, s33, 0x7000
	buffer_load_dwordx4 a[0:3], v1, s[8:11], s94 offen offset:0
	ds_read_b128 v[60:63], v1 offset:13312
	s_waitcnt lgkmcnt(3)
	v_mfma_f32_32x32x16_bf16 v[72:87], v[64:67], a[116:119], v[72:87]
	ds_read_b128 v[64:67], v1 offset:14336
	s_waitcnt lgkmcnt(3)
	v_mfma_f32_32x32x16_bf16 v[88:103], v[68:71], a[116:119], v[88:103]
	buffer_load_dwordx4 a[4:7], v1, s[8:11], s94 offen offset:1024
	ds_read_b128 v[68:71], v1 offset:15360
	s_waitcnt lgkmcnt(3)
	v_mfma_f32_32x32x16_bf16 v[72:87], v[56:59], a[120:123], v[72:87]
	s_waitcnt vmcnt(15)
	s_barrier
	ds_read_b128 v[56:59], v1 offset:16384
	s_waitcnt lgkmcnt(3)
	v_mfma_f32_32x32x16_bf16 v[88:103], v[60:63], a[120:123], v[88:103]
	s_add_u32 s94, s33, 0xa000
	buffer_load_dwordx4 a[8:11], v1, s[8:11], s94 offen offset:0
	ds_read_b128 v[60:63], v1 offset:17408
	s_waitcnt lgkmcnt(3)
	v_mfma_f32_32x32x16_bf16 v[72:87], v[64:67], a[124:127], v[72:87]
	ds_read_b128 v[64:67], v1 offset:18432
	s_waitcnt lgkmcnt(3)
	v_mfma_f32_32x32x16_bf16 v[88:103], v[68:71], a[124:127], v[88:103]
	ds_read_b128 v[68:71], v1 offset:19456
	s_waitcnt lgkmcnt(3)
	v_mfma_f32_32x32x16_bf16 v[72:87], v[56:59], a[128:131], v[72:87]
	buffer_load_dwordx4 a[12:15], v1, s[8:11], s94 offen offset:1024
	ds_read_b128 v[56:59], v1 offset:20480
	s_waitcnt lgkmcnt(3)
	v_mfma_f32_32x32x16_bf16 v[88:103], v[60:63], a[128:131], v[88:103]
	ds_read_b128 v[60:63], v1 offset:21504
	s_waitcnt lgkmcnt(3)
	v_mfma_f32_32x32x16_bf16 v[72:87], v[64:67], a[132:135], v[72:87]
	s_add_u32 s29, s38, 0x261a000
	buffer_load_dword v255, v14, s[8:11], s29 offen sc1
	ds_read_b128 v[64:67], v1 offset:22528
	s_waitcnt lgkmcnt(3)
	v_mfma_f32_32x32x16_bf16 v[88:103], v[68:71], a[132:135], v[88:103]
	ds_read_b128 v[68:71], v1 offset:23552
	s_waitcnt lgkmcnt(3)
	v_mfma_f32_32x32x16_bf16 v[72:87], v[56:59], a[136:139], v[72:87]
	buffer_load_dwordx4 a[16:19], v1, s[8:11], s94 offen offset:2048
	ds_read_b128 v[56:59], v1 offset:24576
	s_waitcnt lgkmcnt(3)
	v_mfma_f32_32x32x16_bf16 v[88:103], v[60:63], a[136:139], v[88:103]
	ds_read_b128 v[60:63], v1 offset:25600
	s_waitcnt lgkmcnt(3)
	v_mfma_f32_32x32x16_bf16 v[72:87], v[64:67], a[140:143], v[72:87]
	ds_read_b128 v[64:67], v1 offset:26624
	s_waitcnt lgkmcnt(3)
	v_mfma_f32_32x32x16_bf16 v[88:103], v[68:71], a[140:143], v[88:103]
	ds_read_b128 v[68:71], v1 offset:27648
	s_waitcnt lgkmcnt(3)
	v_mfma_f32_32x32x16_bf16 v[72:87], v[56:59], a[144:147], v[72:87]
	ds_read_b128 v[56:59], v1 offset:28672
	s_waitcnt lgkmcnt(3)
	v_mfma_f32_32x32x16_bf16 v[88:103], v[60:63], a[144:147], v[88:103]
	buffer_load_dwordx4 a[20:23], v1, s[8:11], s94 offen offset:3072
	ds_read_b128 v[60:63], v1 offset:29696
	s_waitcnt lgkmcnt(3)
	v_mfma_f32_32x32x16_bf16 v[72:87], v[64:67], a[148:151], v[72:87]
	ds_read_b128 v[64:67], v1 offset:30720
	s_waitcnt lgkmcnt(3)
	v_mfma_f32_32x32x16_bf16 v[88:103], v[68:71], a[148:151], v[88:103]
	s_add_u32 s94, s33, 0xb000
	buffer_load_dwordx4 a[24:27], v1, s[8:11], s94 offen offset:0
	ds_read_b128 v[68:71], v1 offset:31744
	s_waitcnt lgkmcnt(3)
	v_mfma_f32_32x32x16_bf16 v[72:87], v[56:59], a[152:155], v[72:87]
	s_waitcnt lgkmcnt(2)
	v_mfma_f32_32x32x16_bf16 v[88:103], v[60:63], a[152:155], v[88:103]
	s_add_u32 s94, s33, 0xd000
	buffer_load_dwordx4 a[28:31], v1, s[8:11], s94 offen offset:3072
	s_waitcnt lgkmcnt(1)
	v_mfma_f32_32x32x16_bf16 v[72:87], v[64:67], a[156:159], v[72:87]
	s_waitcnt lgkmcnt(0)
	v_mfma_f32_32x32x16_bf16 v[88:103], v[68:71], a[156:159], v[88:103]
	s_add_u32 s94, s33, 0xe000
	buffer_load_dwordx4 a[32:35], v1, s[8:11], s94 offen offset:0
	s_waitcnt vmcnt(5)
	v_cmp_gt_u32 vcc, 2, v255
	s_cbranch_vccnz chkpoll_43
chkok_44:
	s_cmp_eq_u32 s25, 0
	s_cbranch_scc1 acq_45
acqb_46:
	s_nop 2
	v_max_f32 v72, 0, v72
	v_max_f32 v73, 0, v73
	v_pk_mul_f32 v[88:89], v[88:89], v[30:31] op_sel:[0,1] op_sel_hi:[1,1]
	v_pk_mul_f32 v[72:73], v[72:73], v[88:89]
	s_add_u32 s88, s52, 0x17e8000
	buffer_load_dwordx4 a[48:51], v1, s[8:11], s88 offen offset:0 sc1
	v_cvt_pk_bf16_f32 v144, v72, v73
	v_max_f32 v74, 0, v74
	v_max_f32 v75, 0, v75
	v_pk_mul_f32 v[90:91], v[90:91], v[30:31] op_sel:[0,1] op_sel_hi:[1,1]
	s_add_u32 s88, s53, 0x17e8000
	buffer_load_dwordx4 a[52:55], v1, s[8:11], s88 offen offset:0 sc1
	v_pk_mul_f32 v[74:75], v[74:75], v[90:91]
	v_cvt_pk_bf16_f32 v145, v74, v75
	v_max_f32 v76, 0, v76
	v_max_f32 v77, 0, v77
	s_add_u32 s88, s54, 0x17e8000
	buffer_load_dwordx4 a[56:59], v1, s[8:11], s88 offen offset:0 sc1
	v_pk_mul_f32 v[92:93], v[92:93], v[30:31] op_sel:[0,1] op_sel_hi:[1,1]
	v_pk_mul_f32 v[76:77], v[76:77], v[92:93]
	v_cvt_pk_bf16_f32 v146, v76, v77
	v_max_f32 v78, 0, v78
	v_max_f32 v79, 0, v79
	v_pk_mul_f32 v[94:95], v[94:95], v[30:31] op_sel:[0,1] op_sel_hi:[1,1]
	v_pk_mul_f32 v[78:79], v[78:79], v[94:95]
	v_cvt_pk_bf16_f32 v147, v78, v79
	s_add_u32 s88, s55, 0x17e8000
	buffer_load_dwordx4 a[60:63], v1, s[8:11], s88 offen offset:0 sc1
	s_add_u32 s28, s43, 0x17e8000
	buffer_store_dwordx4 v[144:147], v11, s[8:11], s28 offen offset:2048
	v_max_f32 v80, 0, v80
	v_max_f32 v81, 0, v81
	v_pk_mul_f32 v[96:97], v[96:97], v[30:31] op_sel:[0,1] op_sel_hi:[1,1]
	v_pk_mul_f32 v[80:81], v[80:81], v[96:97]
	v_cvt_pk_bf16_f32 v148, v80, v81
	v_max_f32 v82, 0, v82
	v_max_f32 v83, 0, v83
	v_pk_mul_f32 v[98:99], v[98:99], v[30:31] op_sel:[0,1] op_sel_hi:[1,1]
	v_pk_mul_f32 v[82:83], v[82:83], v[98:99]
	v_cvt_pk_bf16_f32 v149, v82, v83
	v_max_f32 v84, 0, v84
	v_max_f32 v85, 0, v85
	v_pk_mul_f32 v[100:101], v[100:101], v[30:31] op_sel:[0,1] op_sel_hi:[1,1]
	v_pk_mul_f32 v[84:85], v[84:85], v[100:101]
	v_cvt_pk_bf16_f32 v150, v84, v85
	s_add_u32 s88, s52, 0x17e8000
	buffer_load_dwordx4 a[64:67], v1, s[8:11], s88 offen offset:3072 sc1
	v_max_f32 v86, 0, v86
	v_max_f32 v87, 0, v87
	v_pk_mul_f32 v[102:103], v[102:103], v[30:31] op_sel:[0,1] op_sel_hi:[1,1]
	v_pk_mul_f32 v[86:87], v[86:87], v[102:103]
	v_cvt_pk_bf16_f32 v151, v86, v87
	s_add_u32 s28, s43, 0x17e8000
	buffer_store_dwordx4 v[148:151], v11, s[8:11], s28 offen offset:2560
	s_barrier
	s_add_u32 s88, s53, 0x17e8000
	buffer_load_dwordx4 a[68:71], v1, s[8:11], s88 offen offset:3072 sc1
	s_waitcnt vmcnt(7)
	v_mfma_f32_16x16x32_bf16 v[72:75], v[152:155], a[48:51], 0
	s_add_u32 s88, s54, 0x17e8000
	buffer_load_dwordx4 a[72:75], v1, s[8:11], s88 offen offset:3072 sc1
	v_mfma_f32_16x16x32_bf16 v[76:79], v[156:159], a[48:51], 0
	v_mfma_f32_16x16x32_bf16 v[80:83], v[160:163], a[48:51], 0
	s_add_u32 s88, s55, 0x17e8000
	buffer_load_dwordx4 a[76:79], v1, s[8:11], s88 offen offset:3072 sc1
	v_mfma_f32_16x16x32_bf16 v[84:87], v[164:167], a[48:51], 0
	v_mfma_f32_16x16x32_bf16 v[88:91], v[168:171], a[48:51], 0
	s_add_u32 s88, s52, 0x17e9000
	buffer_load_dwordx4 a[80:83], v1, s[8:11], s88 offen offset:2048 sc1
	s_waitcnt vmcnt(9)
	v_mfma_f32_16x16x32_bf16 v[92:95], v[152:155], a[52:55], 0
	s_add_u32 s88, s53, 0x17e9000
	buffer_load_dwordx4 a[84:87], v1, s[8:11], s88 offen offset:2048 sc1
	v_mfma_f32_16x16x32_bf16 v[96:99], v[156:159], a[52:55], 0
	v_mfma_f32_16x16x32_bf16 v[100:103], v[160:163], a[52:55], 0
	v_mfma_f32_16x16x32_bf16 v[104:107], v[164:167], a[52:55], 0
	v_mfma_f32_16x16x32_bf16 v[108:111], v[168:171], a[52:55], 0
	s_waitcnt vmcnt(9)
	v_mfma_f32_16x16x32_bf16 v[112:115], v[152:155], a[56:59], 0
	s_add_u32 s88, s54, 0x17e9000
	buffer_load_dwordx4 a[88:91], v1, s[8:11], s88 offen offset:2048 sc1
	v_mfma_f32_16x16x32_bf16 v[116:119], v[156:159], a[56:59], 0
	v_mfma_f32_16x16x32_bf16 v[120:123], v[160:163], a[56:59], 0
	s_add_u32 s88, s55, 0x17e9000
	buffer_load_dwordx4 a[92:95], v1, s[8:11], s88 offen offset:2048 sc1
	v_mfma_f32_16x16x32_bf16 v[124:127], v[164:167], a[56:59], 0
	v_mfma_f32_16x16x32_bf16 v[128:131], v[168:171], a[56:59], 0
	s_waitcnt vmcnt(10)
	v_mfma_f32_16x16x32_bf16 v[132:135], v[152:155], a[60:63], 0
	v_mfma_f32_16x16x32_bf16 v[136:139], v[156:159], a[60:63], 0
	v_mfma_f32_16x16x32_bf16 v[140:143], v[160:163], a[60:63], 0
	v_mfma_f32_16x16x32_bf16 v[144:147], v[164:167], a[60:63], 0
	v_mfma_f32_16x16x32_bf16 v[148:151], v[168:171], a[60:63], 0
	s_add_u32 s88, s52, 0x17ea000
	buffer_load_dwordx4 a[96:99], v1, s[8:11], s88 offen offset:1024 sc1
	s_waitcnt vmcnt(9)
	v_mfma_f32_16x16x32_bf16 v[72:75], v[172:175], a[64:67], v[72:75]
	v_mfma_f32_16x16x32_bf16 v[76:79], v[176:179], a[64:67], v[76:79]
	v_mfma_f32_16x16x32_bf16 v[80:83], v[180:183], a[64:67], v[80:83]
	s_add_u32 s88, s53, 0x17ea000
	buffer_load_dwordx4 a[100:103], v1, s[8:11], s88 offen offset:1024 sc1
	v_mfma_f32_16x16x32_bf16 v[84:87], v[184:187], a[64:67], v[84:87]
	v_mfma_f32_16x16x32_bf16 v[88:91], v[188:191], a[64:67], v[88:91]
	s_waitcnt vmcnt(8)
	v_mfma_f32_16x16x32_bf16 v[92:95], v[172:175], a[68:71], v[92:95]
	s_add_u32 s88, s54, 0x17ea000
	buffer_load_dwordx4 a[104:107], v1, s[8:11], s88 offen offset:1024 sc1
	v_mfma_f32_16x16x32_bf16 v[96:99], v[176:179], a[68:71], v[96:99]
	v_mfma_f32_16x16x32_bf16 v[100:103], v[180:183], a[68:71], v[100:103]
	v_mfma_f32_16x16x32_bf16 v[104:107], v[184:187], a[68:71], v[104:107]
	v_mfma_f32_16x16x32_bf16 v[108:111], v[188:191], a[68:71], v[108:111]
	s_add_u32 s88, s55, 0x17ea000
	buffer_load_dwordx4 a[108:111], v1, s[8:11], s88 offen offset:1024 sc1
	s_waitcnt vmcnt(9)
	v_mfma_f32_16x16x32_bf16 v[112:115], v[172:175], a[72:75], v[112:115]
	v_mfma_f32_16x16x32_bf16 v[116:119], v[176:179], a[72:75], v[116:119]
	v_mfma_f32_16x16x32_bf16 v[120:123], v[180:183], a[72:75], v[120:123]
	v_mfma_f32_16x16x32_bf16 v[124:127], v[184:187], a[72:75], v[124:127]
	v_mfma_f32_16x16x32_bf16 v[128:131], v[188:191], a[72:75], v[128:131]
	s_add_u32 s88, s52, 0x17e8000
	buffer_load_dwordx4 a[112:115], v1, s[8:11], s88 offen offset:1024 sc1
	s_waitcnt vmcnt(9)
	v_mfma_f32_16x16x32_bf16 v[132:135], v[172:175], a[76:79], v[132:135]
	v_mfma_f32_16x16x32_bf16 v[136:139], v[176:179], a[76:79], v[136:139]
	v_mfma_f32_16x16x32_bf16 v[140:143], v[180:183], a[76:79], v[140:143]
	v_mfma_f32_16x16x32_bf16 v[144:147], v[184:187], a[76:79], v[144:147]
	v_mfma_f32_16x16x32_bf16 v[148:151], v[188:191], a[76:79], v[148:151]
	s_add_u32 s88, s53, 0x17e8000
	buffer_load_dwordx4 a[116:119], v1, s[8:11], s88 offen offset:1024 sc1
	s_waitcnt vmcnt(9)
	v_mfma_f32_16x16x32_bf16 v[72:75], v[192:195], a[80:83], v[72:75]
	v_mfma_f32_16x16x32_bf16 v[76:79], v[196:199], a[80:83], v[76:79]
	v_mfma_f32_16x16x32_bf16 v[80:83], v[200:203], a[80:83], v[80:83]
	s_add_u32 s88, s54, 0x17e8000
	buffer_load_dwordx4 a[120:123], v1, s[8:11], s88 offen offset:1024 sc1
	v_mfma_f32_16x16x32_bf16 v[84:87], v[204:207], a[80:83], v[84:87]
	v_mfma_f32_16x16x32_bf16 v[88:91], v[208:211], a[80:83], v[88:91]
	s_waitcnt vmcnt(9)
	v_mfma_f32_16x16x32_bf16 v[92:95], v[192:195], a[84:87], v[92:95]
	v_mfma_f32_16x16x32_bf16 v[96:99], v[196:199], a[84:87], v[96:99]
	v_mfma_f32_16x16x32_bf16 v[100:103], v[200:203], a[84:87], v[100:103]
	v_mov_b32 v254, 3
	s_add_u32 s29, s44, 0x261a000
	s_cmp_eq_u32 s25, 0
	s_cbranch_scc1 slow_47
	buffer_store_dword v254, v16, s[8:11], s29 offen
back_48:
	s_add_u32 s88, s55, 0x17e8000
	buffer_load_dwordx4 a[124:127], v1, s[8:11], s88 offen offset:1024 sc1
	v_mfma_f32_16x16x32_bf16 v[104:107], v[204:207], a[84:87], v[104:107]
	v_mfma_f32_16x16x32_bf16 v[108:111], v[208:211], a[84:87], v[108:111]
	s_add_u32 s88, s52, 0x17e9000
	buffer_load_dwordx4 a[128:131], v1, s[8:11], s88 offen offset:0 sc1
	s_waitcnt vmcnt(11)
	v_mfma_f32_16x16x32_bf16 v[112:115], v[192:195], a[88:91], v[112:115]
	v_mfma_f32_16x16x32_bf16 v[116:119], v[196:199], a[88:91], v[116:119]
	v_mfma_f32_16x16x32_bf16 v[120:123], v[200:203], a[88:91], v[120:123]
	v_mfma_f32_16x16x32_bf16 v[124:127], v[204:207], a[88:91], v[124:127]
	v_mfma_f32_16x16x32_bf16 v[128:131], v[208:211], a[88:91], v[128:131]
	s_add_u32 s88, s53, 0x17e9000
	buffer_load_dwordx4 a[132:135], v1, s[8:11], s88 offen offset:0 sc1
	s_waitcnt vmcnt(11)
	v_mfma_f32_16x16x32_bf16 v[132:135], v[192:195], a[92:95], v[132:135]
	v_mfma_f32_16x16x32_bf16 v[136:139], v[196:199], a[92:95], v[136:139]
	v_mfma_f32_16x16x32_bf16 v[140:143], v[200:203], a[92:95], v[140:143]
	v_mfma_f32_16x16x32_bf16 v[144:147], v[204:207], a[92:95], v[144:147]
	v_mfma_f32_16x16x32_bf16 v[148:151], v[208:211], a[92:95], v[148:151]
	s_add_u32 s88, s54, 0x17e9000
	buffer_load_dwordx4 a[136:139], v1, s[8:11], s88 offen offset:0 sc1
	s_waitcnt vmcnt(11)
	v_mfma_f32_16x16x32_bf16 v[72:75], v[212:215], a[96:99], v[72:75]
	v_mfma_f32_16x16x32_bf16 v[76:79], v[216:219], a[96:99], v[76:79]
	v_mfma_f32_16x16x32_bf16 v[80:83], v[220:223], a[96:99], v[80:83]
	s_add_u32 s88, s55, 0x17e9000
	buffer_load_dwordx4 a[140:143], v1, s[8:11], s88 offen offset:0 sc1
	v_mfma_f32_16x16x32_bf16 v[84:87], v[224:227], a[96:99], v[84:87]
	v_mfma_f32_16x16x32_bf16 v[88:91], v[228:231], a[96:99], v[88:91]
	s_waitcnt vmcnt(11)
	v_mfma_f32_16x16x32_bf16 v[92:95], v[212:215], a[100:103], v[92:95]
	v_mfma_f32_16x16x32_bf16 v[96:99], v[216:219], a[100:103], v[96:99]
	v_mfma_f32_16x16x32_bf16 v[100:103], v[220:223], a[100:103], v[100:103]
	s_add_u32 s88, s52, 0x17e9000
	buffer_load_dwordx4 a[144:147], v1, s[8:11], s88 offen offset:3072 sc1
	v_mfma_f32_16x16x32_bf16 v[104:107], v[224:227], a[100:103], v[104:107]
	v_mfma_f32_16x16x32_bf16 v[108:111], v[228:231], a[100:103], v[108:111]
	s_waitcnt vmcnt(11)
	v_mfma_f32_16x16x32_bf16 v[112:115], v[212:215], a[104:107], v[112:115]
	s_add_u32 s88, s53, 0x17e9000
	buffer_load_dwordx4 a[148:151], v1, s[8:11], s88 offen offset:3072 sc1
	v_mfma_f32_16x16x32_bf16 v[116:119], v[216:219], a[104:107], v[116:119]
	v_mfma_f32_16x16x32_bf16 v[120:123], v[220:223], a[104:107], v[120:123]
	v_mfma_f32_16x16x32_bf16 v[124:127], v[224:227], a[104:107], v[124:127]
	v_mfma_f32_16x16x32_bf16 v[128:131], v[228:231], a[104:107], v[128:131]
	s_waitcnt vmcnt(11)
	v_mfma_f32_16x16x32_bf16 v[132:135], v[212:215], a[108:111], v[132:135]
	s_add_u32 s88, s54, 0x17e9000
	buffer_load_dwordx4 a[152:155], v1, s[8:11], s88 offen offset:3072 sc1
	v_mfma_f32_16x16x32_bf16 v[136:139], v[216:219], a[108:111], v[136:139]
	v_mfma_f32_16x16x32_bf16 v[140:143], v[220:223], a[108:111], v[140:143]
	s_add_u32 s29, s38, 0x261a000
	buffer_load_dword v255, v14, s[8:11], s29 offen sc1
	v_mfma_f32_16x16x32_bf16 v[144:147], v[224:227], a[108:111], v[144:147]
	v_mfma_f32_16x16x32_bf16 v[148:151], v[228:231], a[108:111], v[148:151]
	s_waitcnt vmcnt(12)
	v_mfma_f32_16x16x32_bf16 v[72:75], v[232:235], a[112:115], v[72:75]
	s_add_u32 s88, s55, 0x17e9000
	buffer_load_dwordx4 a[156:159], v1, s[8:11], s88 offen offset:3072 sc1
	v_mfma_f32_16x16x32_bf16 v[76:79], v[236:239], a[112:115], v[76:79]
	v_mfma_f32_16x16x32_bf16 v[80:83], v[240:243], a[112:115], v[80:83]
	v_mfma_f32_16x16x32_bf16 v[84:87], v[244:247], a[112:115], v[84:87]
	v_mfma_f32_16x16x32_bf16 v[88:91], a[160:163], a[112:115], v[88:91]
	s_add_u32 s88, s52, 0x17ea000
	buffer_load_dwordx4 a[48:51], v1, s[8:11], s88 offen offset:2048 sc1
	s_waitcnt vmcnt(13)
	v_mfma_f32_16x16x32_bf16 v[92:95], v[232:235], a[116:119], v[92:95]
	v_mfma_f32_16x16x32_bf16 v[96:99], v[236:239], a[116:119], v[96:99]
	v_mfma_f32_16x16x32_bf16 v[100:103], v[240:243], a[116:119], v[100:103]
	v_mfma_f32_16x16x32_bf16 v[104:107], v[244:247], a[116:119], v[104:107]
	v_mfma_f32_16x16x32_bf16 v[108:111], a[160:163], a[116:119], v[108:111]
	s_add_u32 s88, s53, 0x17ea000
	buffer_load_dwordx4 a[52:55], v1, s[8:11], s88 offen offset:2048 sc1
	s_waitcnt vmcnt(13)
	v_mfma_f32_16x16x32_bf16 v[112:115], v[232:235], a[120:123], v[112:115]
	v_mfma_f32_16x16x32_bf16 v[116:119], v[236:239], a[120:123], v[116:119]
	v_mfma_f32_16x16x32_bf16 v[120:123], v[240:243], a[120:123], v[120:123]
	v_mfma_f32_16x16x32_bf16 v[124:127], v[244:247], a[120:123], v[124:127]
	v_mfma_f32_16x16x32_bf16 v[128:131], a[160:163], a[120:123], v[128:131]
	s_add_u32 s88, s54, 0x17ea000
	buffer_load_dwordx4 a[56:59], v1, s[8:11], s88 offen offset:2048 sc1
	s_waitcnt vmcnt(12)
	v_mfma_f32_16x16x32_bf16 v[132:135], v[232:235], a[124:127], v[132:135]
	v_mfma_f32_16x16x32_bf16 v[136:139], v[236:239], a[124:127], v[136:139]
	v_mfma_f32_16x16x32_bf16 v[140:143], v[240:243], a[124:127], v[140:143]
	s_add_u32 s88, s55, 0x17ea000
	buffer_load_dwordx4 a[60:63], v1, s[8:11], s88 offen offset:2048 sc1
	v_mfma_f32_16x16x32_bf16 v[144:147], v[244:247], a[124:127], v[144:147]
	v_mfma_f32_16x16x32_bf16 v[148:151], a[160:163], a[124:127], v[148:151]
	s_waitcnt vmcnt(5)
	v_cmp_gt_u32 vcc, 3, v255
	s_cbranch_vccnz chkpoll_49
chkok_50:
	s_cmp_eq_u32 s25, 0
	s_cbranch_scc1 acq_51
acqb_52:
	s_add_u32 s88, s52, 0x17e8000
	buffer_load_dwordx4 a[64:67], v1, s[8:11], s88 offen offset:2048 sc1
	v_mfma_f32_16x16x32_bf16 v[72:75], a[164:167], a[128:131], v[72:75]
	s_add_u32 s88, s53, 0x17e8000
	buffer_load_dwordx4 a[68:71], v1, s[8:11], s88 offen offset:2048 sc1
	v_mfma_f32_16x16x32_bf16 v[76:79], a[168:171], a[128:131], v[76:79]
	v_mfma_f32_16x16x32_bf16 v[80:83], a[172:175], a[128:131], v[80:83]
	s_add_u32 s88, s54, 0x17e8000
	buffer_load_dwordx4 a[72:75], v1, s[8:11], s88 offen offset:2048 sc1
	v_mfma_f32_16x16x32_bf16 v[84:87], a[176:179], a[128:131], v[84:87]
	v_mfma_f32_16x16x32_bf16 v[88:91], a[180:183], a[128:131], v[88:91]
	s_add_u32 s88, s55, 0x17e8000
	buffer_load_dwordx4 a[76:79], v1, s[8:11], s88 offen offset:2048 sc1
	v_mfma_f32_16x16x32_bf16 v[92:95], a[164:167], a[132:135], v[92:95]
	s_add_u32 s88, s52, 0x17e9000
	buffer_load_dwordx4 a[80:83], v1, s[8:11], s88 offen offset:1024 sc1
	v_mfma_f32_16x16x32_bf16 v[96:99], a[168:171], a[132:135], v[96:99]
	v_mfma_f32_16x16x32_bf16 v[100:103], a[172:175], a[132:135], v[100:103]
	v_mfma_f32_16x16x32_bf16 v[104:107], a[176:179], a[132:135], v[104:107]
	v_mfma_f32_16x16x32_bf16 v[108:111], a[180:183], a[132:135], v[108:111]
	s_add_u32 s88, s53, 0x17e9000
	buffer_load_dwordx4 a[84:87], v1, s[8:11], s88 offen offset:1024 sc1
	v_mfma_f32_16x16x32_bf16 v[112:115], a[164:167], a[136:139], v[112:115]
	v_mfma_f32_16x16x32_bf16 v[116:119], a[168:171], a[136:139], v[116:119]
	v_mfma_f32_16x16x32_bf16 v[120:123], a[172:175], a[136:139], v[120:123]
	v_mfma_f32_16x16x32_bf16 v[124:127], a[176:179], a[136:139], v[124:127]
	v_mfma_f32_16x16x32_bf16 v[128:131], a[180:183], a[136:139], v[128:131]
	s_add_u32 s88, s54, 0x17e9000
	buffer_load_dwordx4 a[88:91], v1, s[8:11], s88 offen offset:1024 sc1
	v_mfma_f32_16x16x32_bf16 v[132:135], a[164:167], a[140:143], v[132:135]
	v_mfma_f32_16x16x32_bf16 v[136:139], a[168:171], a[140:143], v[136:139]
	v_mfma_f32_16x16x32_bf16 v[140:143], a[172:175], a[140:143], v[140:143]
	s_add_u32 s88, s55, 0x17e9000
	buffer_load_dwordx4 a[92:95], v1, s[8:11], s88 offen offset:1024 sc1
	v_mfma_f32_16x16x32_bf16 v[144:147], a[176:179], a[140:143], v[144:147]
	v_mfma_f32_16x16x32_bf16 v[148:151], a[180:183], a[140:143], v[148:151]
	v_mfma_f32_16x16x32_bf16 v[72:75], a[184:187], a[144:147], v[72:75]
	v_mfma_f32_16x16x32_bf16 v[76:79], a[188:191], a[144:147], v[76:79]
	v_mfma_f32_16x16x32_bf16 v[80:83], a[192:195], a[144:147], v[80:83]
	s_add_u32 s88, s53, 0x17ea000
	buffer_load_dwordx4 a[100:103], v1, s[8:11], s88 offen offset:0 sc1
	v_mfma_f32_16x16x32_bf16 v[84:87], a[196:199], a[144:147], v[84:87]
	v_mfma_f32_16x16x32_bf16 v[88:91], a[200:203], a[144:147], v[88:91]
	v_mfma_f32_16x16x32_bf16 v[92:95], a[184:187], a[148:151], v[92:95]
	v_mfma_f32_16x16x32_bf16 v[96:99], a[188:191], a[148:151], v[96:99]
	v_mfma_f32_16x16x32_bf16 v[100:103], a[192:195], a[148:151], v[100:103]
	s_add_u32 s88, s54, 0x17ea000
	buffer_load_dwordx4 a[104:107], v1, s[8:11], s88 offen offset:0 sc1
	v_mfma_f32_16x16x32_bf16 v[104:107], a[196:199], a[148:151], v[104:107]
	v_mfma_f32_16x16x32_bf16 v[108:111], a[200:203], a[148:151], v[108:111]
	v_mfma_f32_16x16x32_bf16 v[112:115], a[184:187], a[152:155], v[112:115]
	s_add_u32 s88, s55, 0x17ea000
	buffer_load_dwordx4 a[108:111], v1, s[8:11], s88 offen offset:0 sc1
	v_mfma_f32_16x16x32_bf16 v[116:119], a[188:191], a[152:155], v[116:119]
	v_mfma_f32_16x16x32_bf16 v[120:123], a[192:195], a[152:155], v[120:123]
	v_mfma_f32_16x16x32_bf16 v[124:127], a[196:199], a[152:155], v[124:127]
	v_mfma_f32_16x16x32_bf16 v[128:131], a[200:203], a[152:155], v[128:131]
	s_add_u32 s88, s52, 0x17ea000
	buffer_load_dwordx4 a[96:99], v1, s[8:11], s88 offen offset:0 sc1
	s_waitcnt vmcnt(16)
	v_mfma_f32_16x16x32_bf16 v[132:135], a[184:187], a[156:159], v[132:135]
	v_mfma_f32_16x16x32_bf16 v[136:139], a[188:191], a[156:159], v[136:139]
	v_mfma_f32_16x16x32_bf16 v[140:143], a[192:195], a[156:159], v[140:143]
	v_mfma_f32_16x16x32_bf16 v[144:147], a[196:199], a[156:159], v[144:147]
	v_mfma_f32_16x16x32_bf16 v[148:151], a[200:203], a[156:159], v[148:151]
	buffer_load_dwordx4 a[36:39], v1, s[8:11], s94 offen offset:1024
	s_waitcnt vmcnt(16)
	v_mfma_f32_16x16x32_bf16 v[72:75], a[204:207], a[48:51], v[72:75]
	v_mfma_f32_16x16x32_bf16 v[76:79], a[208:211], a[48:51], v[76:79]
	v_mfma_f32_16x16x32_bf16 v[80:83], a[212:215], a[48:51], v[80:83]
	v_mfma_f32_16x16x32_bf16 v[84:87], a[216:219], a[48:51], v[84:87]
	v_mfma_f32_16x16x32_bf16 v[88:91], a[220:223], a[48:51], v[88:91]
	buffer_load_dwordx4 a[40:43], v1, s[8:11], s94 offen offset:2048
	s_waitcnt vmcnt(16)
	v_mfma_f32_16x16x32_bf16 v[92:95], a[204:207], a[52:55], v[92:95]
	v_mfma_f32_16x16x32_bf16 v[96:99], a[208:211], a[52:55], v[96:99]
	v_mfma_f32_16x16x32_bf16 v[100:103], a[212:215], a[52:55], v[100:103]
	buffer_load_dwordx4 a[44:47], v1, s[8:11], s94 offen offset:3072
	v_mfma_f32_16x16x32_bf16 v[104:107], a[216:219], a[52:55], v[104:107]
	v_mfma_f32_16x16x32_bf16 v[108:111], a[220:223], a[52:55], v[108:111]
	s_waitcnt vmcnt(16)
	v_mfma_f32_16x16x32_bf16 v[112:115], a[204:207], a[56:59], v[112:115]
	v_mfma_f32_16x16x32_bf16 v[116:119], a[208:211], a[56:59], v[116:119]
	v_mfma_f32_16x16x32_bf16 v[120:123], a[212:215], a[56:59], v[120:123]
	s_add_u32 s88, s53, 0x17ea000
	buffer_load_dwordx4 a[116:119], v1, s[8:11], s88 offen offset:3072 sc1
	v_mfma_f32_16x16x32_bf16 v[124:127], a[216:219], a[56:59], v[124:127]
	v_mfma_f32_16x16x32_bf16 v[128:131], a[220:223], a[56:59], v[128:131]
	s_waitcnt vmcnt(16)
	v_mfma_f32_16x16x32_bf16 v[132:135], a[204:207], a[60:63], v[132:135]
	s_add_u32 s88, s54, 0x17ea000
	buffer_load_dwordx4 a[120:123], v1, s[8:11], s88 offen offset:3072 sc1
	v_mfma_f32_16x16x32_bf16 v[136:139], a[208:211], a[60:63], v[136:139]
	v_mfma_f32_16x16x32_bf16 v[140:143], a[212:215], a[60:63], v[140:143]
	v_mfma_f32_16x16x32_bf16 v[144:147], a[216:219], a[60:63], v[144:147]
	v_mfma_f32_16x16x32_bf16 v[148:151], a[220:223], a[60:63], v[148:151]
	s_waitcnt vmcnt(16)
	v_mfma_f32_16x16x32_bf16 v[72:75], a[224:227], a[64:67], v[72:75]
	s_add_u32 s88, s55, 0x17ea000
	buffer_load_dwordx4 a[124:127], v1, s[8:11], s88 offen offset:3072 sc1
	v_mfma_f32_16x16x32_bf16 v[76:79], a[228:231], a[64:67], v[76:79]
	v_mfma_f32_16x16x32_bf16 v[80:83], a[232:235], a[64:67], v[80:83]
	v_mfma_f32_16x16x32_bf16 v[84:87], a[236:239], a[64:67], v[84:87]
	v_mfma_f32_16x16x32_bf16 v[88:91], a[240:243], a[64:67], v[88:91]
	s_add_u32 s88, s52, 0x17ea000
	buffer_load_dwordx4 a[112:115], v1, s[8:11], s88 offen offset:3072 sc1
	s_waitcnt vmcnt(17)
	v_mfma_f32_16x16x32_bf16 v[92:95], a[224:227], a[68:71], v[92:95]
	v_mfma_f32_16x16x32_bf16 v[96:99], a[228:231], a[68:71], v[96:99]
	v_mfma_f32_16x16x32_bf16 v[100:103], a[232:235], a[68:71], v[100:103]
	v_mfma_f32_16x16x32_bf16 v[104:107], a[236:239], a[68:71], v[104:107]
	v_mfma_f32_16x16x32_bf16 v[108:111], a[240:243], a[68:71], v[108:111]
	s_add_u32 s93, s40, 0x8e8000
	buffer_load_dword v0, v4, s[8:11], s93 offen offset:0 sc1
	s_waitcnt vmcnt(17)
	v_mfma_f32_16x16x32_bf16 v[112:115], a[224:227], a[72:75], v[112:115]
	s_add_u32 s93, s40, 0x8e8000
	buffer_load_dword v0, v4, s[8:11], s93 offen offset:2048 sc1
	v_mfma_f32_16x16x32_bf16 v[116:119], a[228:231], a[72:75], v[116:119]
	v_mfma_f32_16x16x32_bf16 v[120:123], a[232:235], a[72:75], v[120:123]
	s_add_u32 s93, s40, 0x8e8000
	buffer_load_dword v0, v5, s[8:11], s93 offen offset:0 sc1
	v_mfma_f32_16x16x32_bf16 v[124:127], a[236:239], a[72:75], v[124:127]
	v_mfma_f32_16x16x32_bf16 v[128:131], a[240:243], a[72:75], v[128:131]
	s_add_u32 s93, s41, 0x23e8000
	buffer_load_dword v0, v6, s[8:11], s93 offen offset:0 sc1
	s_waitcnt vmcnt(19)
	v_mfma_f32_16x16x32_bf16 v[132:135], a[224:227], a[76:79], v[132:135]
	s_add_u32 s93, s38, 0x261f000
	buffer_load_dword v0, v15, s[8:11], s93 offen offset:0 sc1
	v_mfma_f32_16x16x32_bf16 v[136:139], a[228:231], a[76:79], v[136:139]
	v_mfma_f32_16x16x32_bf16 v[140:143], a[232:235], a[76:79], v[140:143]
	s_add_u32 s89, s30, 0
	s_add_u32 m0, s39, 0
	s_nop 0
	buffer_load_dwordx4 v1, s[8:11], s89 offen offset:0 lds
	v_mfma_f32_16x16x32_bf16 v[144:147], a[236:239], a[76:79], v[144:147]
	v_mfma_f32_16x16x32_bf16 v[148:151], a[240:243], a[76:79], v[148:151]
	s_waitcnt vmcnt(20)
	v_mfma_f32_16x16x32_bf16 v[72:75], a[244:247], a[80:83], v[72:75]
	v_mfma_f32_16x16x32_bf16 v[76:79], a[248:251], a[80:83], v[76:79]
	v_mfma_f32_16x16x32_bf16 v[80:83], a[252:255], a[80:83], v[80:83]
	v_mfma_f32_16x16x32_bf16 v[84:87], a[0:3], a[80:83], v[84:87]
	v_mfma_f32_16x16x32_bf16 v[88:91], a[4:7], a[80:83], v[88:91]
	s_waitcnt vmcnt(19)
	v_mfma_f32_16x16x32_bf16 v[92:95], a[244:247], a[84:87], v[92:95]
	v_mfma_f32_16x16x32_bf16 v[96:99], a[248:251], a[84:87], v[96:99]
	v_mfma_f32_16x16x32_bf16 v[100:103], a[252:255], a[84:87], v[100:103]
	v_mfma_f32_16x16x32_bf16 v[104:107], a[0:3], a[84:87], v[104:107]
	v_mfma_f32_16x16x32_bf16 v[108:111], a[4:7], a[84:87], v[108:111]
	s_waitcnt vmcnt(18)
	v_mfma_f32_16x16x32_bf16 v[112:115], a[244:247], a[88:91], v[112:115]
	v_mfma_f32_16x16x32_bf16 v[116:119], a[248:251], a[88:91], v[116:119]
	v_mfma_f32_16x16x32_bf16 v[120:123], a[252:255], a[88:91], v[120:123]
	v_mfma_f32_16x16x32_bf16 v[124:127], a[0:3], a[88:91], v[124:127]
	v_mfma_f32_16x16x32_bf16 v[128:131], a[4:7], a[88:91], v[128:131]
	s_waitcnt vmcnt(17)
	v_mfma_f32_16x16x32_bf16 v[132:135], a[244:247], a[92:95], v[132:135]
	v_mfma_f32_16x16x32_bf16 v[136:139], a[248:251], a[92:95], v[136:139]
	v_mfma_f32_16x16x32_bf16 v[140:143], a[252:255], a[92:95], v[140:143]
	buffer_load_dwordx4 v1, s[8:11], s89 offen offset:1024 lds
	v_mfma_f32_16x16x32_bf16 v[144:147], a[0:3], a[92:95], v[144:147]
	v_mfma_f32_16x16x32_bf16 v[148:151], a[4:7], a[92:95], v[148:151]
	s_waitcnt vmcnt(17)
	v_mfma_f32_16x16x32_bf16 v[92:95], a[8:11], a[100:103], v[92:95]
	v_mfma_f32_16x16x32_bf16 v[96:99], a[12:15], a[100:103], v[96:99]
	v_mfma_f32_16x16x32_bf16 v[100:103], a[16:19], a[100:103], v[100:103]
	buffer_load_dwordx4 v1, s[8:11], s89 offen offset:2048 lds
	v_mfma_f32_16x16x32_bf16 v[104:107], a[20:23], a[100:103], v[104:107]
	v_mfma_f32_16x16x32_bf16 v[108:111], a[24:27], a[100:103], v[108:111]
	buffer_load_dwordx4 v1, s[8:11], s89 offen offset:3072 lds
	s_waitcnt vmcnt(12)
	v_mfma_f32_16x16x32_bf16 v[92:95], a[28:31], a[116:119], v[92:95]
	s_add_u32 s89, s30, 0x4000
	s_add_u32 m0, s39, 0x4000
	s_nop 0
	buffer_load_dwordx4 v1, s[8:11], s89 offen offset:0 lds
	v_mfma_f32_16x16x32_bf16 v[96:99], a[32:35], a[116:119], v[96:99]
	v_mfma_f32_16x16x32_bf16 v[100:103], a[36:39], a[116:119], v[100:103]
	buffer_load_dwordx4 v1, s[8:11], s89 offen offset:1024 lds
	v_mfma_f32_16x16x32_bf16 v[104:107], a[40:43], a[116:119], v[104:107]
	v_mfma_f32_16x16x32_bf16 v[108:111], a[44:47], a[116:119], v[108:111]
	buffer_load_dwordx4 v1, s[8:11], s89 offen offset:2048 lds
	v_mfma_f32_16x16x32_bf16 v[112:115], a[8:11], a[104:107], v[112:115]
	ds_write_b64 v28, v[92:93] offset:0
	buffer_load_dwordx4 v1, s[8:11], s89 offen offset:3072 lds
	v_mfma_f32_16x16x32_bf16 v[116:119], a[12:15], a[104:107], v[116:119]
	ds_write_b64 v28, v[94:95] offset:8
	v_mfma_f32_16x16x32_bf16 v[120:123], a[16:19], a[104:107], v[120:123]
	ds_write_b64 v28, v[96:97] offset:1024
	v_mfma_f32_16x16x32_bf16 v[124:127], a[20:23], a[104:107], v[124:127]
	ds_write_b64 v28, v[98:99] offset:1032
	v_mfma_f32_16x16x32_bf16 v[128:131], a[24:27], a[104:107], v[128:131]
	ds_write_b64 v28, v[100:101] offset:2048
	s_waitcnt vmcnt(15)
	v_mfma_f32_16x16x32_bf16 v[112:115], a[28:31], a[120:123], v[112:115]
	ds_write_b64 v28, v[102:103] offset:2056
	v_mfma_f32_16x16x32_bf16 v[116:119], a[32:35], a[120:123], v[116:119]
	ds_write_b64 v28, v[104:105] offset:3072
	v_mfma_f32_16x16x32_bf16 v[120:123], a[36:39], a[120:123], v[120:123]
	ds_write_b64 v28, v[106:107] offset:3080
	v_mfma_f32_16x16x32_bf16 v[124:127], a[40:43], a[120:123], v[124:127]
	ds_write_b64 v28, v[108:109] offset:4096
	v_mfma_f32_16x16x32_bf16 v[128:131], a[44:47], a[120:123], v[128:131]
	ds_write_b64 v28, v[110:111] offset:4104
	v_mfma_f32_16x16x32_bf16 v[132:135], a[8:11], a[108:111], v[132:135]
	ds_write_b64 v29, v[112:113] offset:0
	v_mfma_f32_16x16x32_bf16 v[136:139], a[12:15], a[108:111], v[136:139]
	ds_write_b64 v29, v[114:115] offset:8
	v_mfma_f32_16x16x32_bf16 v[140:143], a[16:19], a[108:111], v[140:143]
	ds_write_b64 v29, v[116:117] offset:1024
	v_mfma_f32_16x16x32_bf16 v[144:147], a[20:23], a[108:111], v[144:147]
	ds_write_b64 v29, v[118:119] offset:1032
	v_mfma_f32_16x16x32_bf16 v[148:151], a[24:27], a[108:111], v[148:151]
	ds_write_b64 v29, v[120:121] offset:2048
	s_waitcnt vmcnt(14)
	v_mfma_f32_16x16x32_bf16 v[132:135], a[28:31], a[124:127], v[132:135]
	ds_write_b64 v29, v[122:123] offset:2056
	v_mfma_f32_16x16x32_bf16 v[136:139], a[32:35], a[124:127], v[136:139]
	ds_write_b64 v29, v[124:125] offset:3072
	v_mfma_f32_16x16x32_bf16 v[140:143], a[36:39], a[124:127], v[140:143]
	ds_write_b64 v29, v[126:127] offset:3080
	v_mfma_f32_16x16x32_bf16 v[144:147], a[40:43], a[124:127], v[144:147]
	ds_write_b64 v29, v[128:129] offset:4096
	v_mfma_f32_16x16x32_bf16 v[148:151], a[44:47], a[124:127], v[148:151]
	ds_write_b64 v29, v[130:131] offset:4104
	v_mfma_f32_16x16x32_bf16 v[72:75], a[8:11], a[96:99], v[72:75]
	ds_write_b64 v30, v[132:133] offset:0
	v_mfma_f32_16x16x32_bf16 v[76:79], a[12:15], a[96:99], v[76:79]
	ds_write_b64 v30, v[134:135] offset:8
	v_mfma_f32_16x16x32_bf16 v[80:83], a[16:19], a[96:99], v[80:83]
	ds_write_b64 v30, v[136:137] offset:1024
	v_mfma_f32_16x16x32_bf16 v[84:87], a[20:23], a[96:99], v[84:87]
	ds_write_b64 v30, v[138:139] offset:1032
	v_mfma_f32_16x16x32_bf16 v[88:91], a[24:27], a[96:99], v[88:91]
	ds_write_b64 v30, v[140:141] offset:2048
	s_waitcnt vmcnt(13)
	v_mfma_f32_16x16x32_bf16 v[72:75], a[28:31], a[112:115], v[72:75]
	ds_write_b64 v30, v[142:143] offset:2056
	s_add_u32 s89, s30, 0x8000
	s_add_u32 m0, s39, 0x8000
	s_nop 0
	buffer_load_dwordx4 v1, s[8:11], s89 offen offset:0 lds
	v_mfma_f32_16x16x32_bf16 v[76:79], a[32:35], a[112:115], v[76:79]
	ds_write_b64 v30, v[144:145] offset:3072
	v_mfma_f32_16x16x32_bf16 v[80:83], a[36:39], a[112:115], v[80:83]
	ds_write_b64 v30, v[146:147] offset:3080
	v_mfma_f32_16x16x32_bf16 v[84:87], a[40:43], a[112:115], v[84:87]
	ds_write_b64 v30, v[148:149] offset:4096
	v_mfma_f32_16x16x32_bf16 v[88:91], a[44:47], a[112:115], v[88:91]
	ds_write_b64 v30, v[150:151] offset:4104
	s_waitcnt lgkmcnt(0)
	s_barrier
	ds_read_b128 v[92:95], v26 offset:0
	ds_read_b128 v[112:115], v26 offset:5120
	ds_read_b128 v[132:135], v26 offset:10240
	ds_read_b128 v[96:99], v26 offset:1024
	ds_read_b128 v[116:119], v26 offset:6144
	ds_read_b128 v[136:139], v26 offset:11264
	ds_read_b128 v[100:103], v26 offset:2048
	ds_read_b128 v[120:123], v26 offset:7168
	ds_read_b128 v[140:143], v26 offset:12288
	ds_read_b128 v[104:107], v26 offset:3072
	ds_read_b128 v[124:127], v26 offset:8192
	ds_read_b128 v[144:147], v26 offset:13312
	ds_read_b128 v[108:111], v26 offset:4096
	ds_read_b128 v[128:131], v26 offset:9216
	ds_read_b128 v[148:151], v26 offset:14336
	v_pk_add_f32 v[36:37], v[36:37], v[72:73]
	v_pk_add_f32 v[38:39], v[38:39], v[74:75]
	v_pk_add_f32 v[40:41], v[40:41], v[76:77]
	v_pk_add_f32 v[42:43], v[42:43], v[78:79]
	v_pk_add_f32 v[44:45], v[44:45], v[80:81]
	v_pk_add_f32 v[46:47], v[46:47], v[82:83]
	v_pk_add_f32 v[48:49], v[48:49], v[84:85]
	v_pk_add_f32 v[50:51], v[50:51], v[86:87]
	v_pk_add_f32 v[52:53], v[52:53], v[88:89]
	v_pk_add_f32 v[54:55], v[54:55], v[90:91]
	s_add_u32 s28, s40, 0x8e8000
	buffer_load_dwordx4 v1, s[8:11], s89 offen offset:1024 lds
	buffer_load_dwordx4 v1, s[8:11], s89 offen offset:2048 lds
	s_waitcnt lgkmcnt(12)
	v_pk_add_f32 v[92:93], v[92:93], v[112:113]
	v_pk_add_f32 v[36:37], v[36:37], v[132:133]
	v_pk_add_f32 v[94:95], v[94:95], v[114:115]
	v_pk_add_f32 v[38:39], v[38:39], v[134:135]
	v_pk_add_f32 v[36:37], v[36:37], v[92:93]
	v_pk_add_f32 v[38:39], v[38:39], v[94:95]
	v_cvt_pk_bf16_f32 v72, v36, v37
	v_cvt_pk_bf16_f32 v73, v38, v39
	v_pk_add_f32 v[82:83], v[36:37], v[38:39]
	v_pk_mul_f32 v[84:85], v[36:37], v[36:37]
	v_pk_fma_f32 v[84:85], v[38:39], v[38:39], v[84:85]
	buffer_load_dwordx4 v1, s[8:11], s89 offen offset:3072 lds
	s_waitcnt lgkmcnt(9)
	v_pk_add_f32 v[96:97], v[96:97], v[116:117]
	v_pk_add_f32 v[40:41], v[40:41], v[136:137]
	v_pk_add_f32 v[98:99], v[98:99], v[118:119]
	v_pk_add_f32 v[42:43], v[42:43], v[138:139]
	v_pk_add_f32 v[40:41], v[40:41], v[96:97]
	v_pk_add_f32 v[42:43], v[42:43], v[98:99]
	v_cvt_pk_bf16_f32 v74, v40, v41
	v_cvt_pk_bf16_f32 v75, v42, v43
	buffer_store_dwordx4 v[72:75], v4, s[8:11], s28 offen
	v_pk_add_f32 v[82:83], v[82:83], v[40:41]
	v_pk_fma_f32 v[84:85], v[40:41], v[40:41], v[84:85]
	v_pk_add_f32 v[82:83], v[82:83], v[42:43]
	v_pk_fma_f32 v[84:85], v[42:43], v[42:43], v[84:85]
	s_waitcnt lgkmcnt(6)
	v_pk_add_f32 v[100:101], v[100:101], v[120:121]
	v_pk_add_f32 v[44:45], v[44:45], v[140:141]
	v_pk_add_f32 v[102:103], v[102:103], v[122:123]
	v_pk_add_f32 v[46:47], v[46:47], v[142:143]
	v_pk_add_f32 v[44:45], v[44:45], v[100:101]
	v_pk_add_f32 v[46:47], v[46:47], v[102:103]
	v_cvt_pk_bf16_f32 v76, v44, v45
	v_cvt_pk_bf16_f32 v77, v46, v47
	v_pk_add_f32 v[82:83], v[82:83], v[44:45]
	v_pk_fma_f32 v[84:85], v[44:45], v[44:45], v[84:85]
	v_pk_add_f32 v[82:83], v[82:83], v[46:47]
	v_pk_fma_f32 v[84:85], v[46:47], v[46:47], v[84:85]
	s_waitcnt lgkmcnt(3)
	v_pk_add_f32 v[104:105], v[104:105], v[124:125]
	v_pk_add_f32 v[48:49], v[48:49], v[144:145]
	v_pk_add_f32 v[106:107], v[106:107], v[126:127]
	v_pk_add_f32 v[50:51], v[50:51], v[146:147]
	v_pk_add_f32 v[48:49], v[48:49], v[104:105]
	v_pk_add_f32 v[50:51], v[50:51], v[106:107]
	v_cvt_pk_bf16_f32 v78, v48, v49
	v_cvt_pk_bf16_f32 v79, v50, v51
	buffer_store_dwordx4 v[76:79], v4, s[8:11], s28 offen offset:2048
	v_pk_add_f32 v[82:83], v[82:83], v[48:49]
	v_pk_fma_f32 v[84:85], v[48:49], v[48:49], v[84:85]
	v_pk_add_f32 v[82:83], v[82:83], v[50:51]
	v_pk_fma_f32 v[84:85], v[50:51], v[50:51], v[84:85]
	s_waitcnt lgkmcnt(0)
	v_pk_add_f32 v[108:109], v[108:109], v[128:129]
	v_pk_add_f32 v[52:53], v[52:53], v[148:149]
	v_pk_add_f32 v[110:111], v[110:111], v[130:131]
	v_pk_add_f32 v[54:55], v[54:55], v[150:151]
	v_pk_add_f32 v[52:53], v[52:53], v[108:109]
	v_pk_add_f32 v[54:55], v[54:55], v[110:111]
	v_cvt_pk_bf16_f32 v80, v52, v53
	v_cvt_pk_bf16_f32 v81, v54, v55
	buffer_store_dwordx2 v[80:81], v5, s[8:11], s28 offen
	v_pk_add_f32 v[82:83], v[82:83], v[52:53]
	v_pk_fma_f32 v[84:85], v[52:53], v[52:53], v[84:85]
	v_pk_add_f32 v[82:83], v[82:83], v[54:55]
	v_pk_fma_f32 v[84:85], v[54:55], v[54:55], v[84:85]
	v_add_f32 v82, v82, v83
	v_add_f32 v84, v84, v85
	s_add_u32 s28, s41, 0x23e8000
	s_nop 0
	v_permlane32_swap_b32 v82, v84
	v_add_f32 v82, v82, v84
	v_mov_b32 v83, v82
	s_nop 1
	v_permlane16_swap_b32 v82, v83
	v_add_f32 v82, v82, v83
	buffer_store_dword v82, v6, s[8:11], s28 offen
	s_barrier
	s_add_u32 s89, s30, 0xc000
	s_add_u32 m0, s39, 0xc000
	s_nop 0
	buffer_load_dwordx4 v1, s[8:11], s89 offen offset:0 lds
	buffer_load_dwordx4 v1, s[8:11], s89 offen offset:1024 lds
	buffer_load_dwordx4 v1, s[8:11], s89 offen offset:2048 lds
	buffer_load_dwordx4 v1, s[8:11], s89 offen offset:3072 lds
	v_mov_b32 v254, 1
	s_add_u32 s29, s45, 0x261f000
	s_waitcnt vmcnt(4)
	s_cmp_eq_u32 s25, 0
	s_cbranch_scc1 slow_53
	buffer_store_dword v254, v16, s[8:11], s29 offen
back_54:
	s_add_u32 s89, s30, 0x10000
	s_add_u32 m0, s39, 0x10000
	s_nop 0
	buffer_load_dwordx4 v1, s[8:11], s89 offen offset:0 lds
	buffer_load_dwordx4 v1, s[8:11], s89 offen offset:1024 lds
	buffer_load_dwordx4 v1, s[8:11], s89 offen offset:2048 lds
	buffer_load_dwordx4 v1, s[8:11], s89 offen offset:3072 lds
	s_add_u32 s29, s38, 0x261f000
	buffer_load_dword v255, v15, s[8:11], s29 offen sc1
	s_add_u32 s89, s30, 0x14000
	s_add_u32 m0, s39, 0x14000
	s_nop 0
	buffer_load_dwordx4 v1, s[8:11], s89 offen offset:0 lds
	buffer_load_dwordx4 v1, s[8:11], s89 offen offset:1024 lds
	buffer_load_dwordx4 v1, s[8:11], s89 offen offset:2048 lds
	buffer_load_dwordx4 v1, s[8:11], s89 offen offset:3072 lds
	s_waitcnt vmcnt(4)
	v_cmp_gt_u32 vcc, 1, v255
	s_cbranch_vccnz chkpoll_55
chkok_56:
	s_cmp_eq_u32 s25, 0
	s_cbranch_scc1 acq_57
acqb_58:
	s_add_u32 s88, s34, 0x8e8000
	buffer_load_dwordx4 a[0:3], v1, s[8:11], s88 offen offset:0 sc1
	buffer_load_dwordx4 a[4:7], v1, s[8:11], s88 offen offset:1024 sc1
	buffer_load_dwordx4 a[8:11], v1, s[8:11], s88 offen offset:2048 sc1
	buffer_load_dwordx4 a[12:15], v1, s[8:11], s88 offen offset:3072 sc1
	s_barrier
	ds_read_b128 v[56:59], v1 offset:0
	ds_read_b128 v[60:63], v1 offset:1024
	ds_read_b128 v[64:67], v1 offset:2048
	ds_read_b128 v[68:71], v1 offset:3072
	s_waitcnt lgkmcnt(3)
	s_add_u32 s88, s34, 0x8e9000
	buffer_load_dwordx4 a[16:19], v1, s[8:11], s88 offen offset:0 sc1
	buffer_load_dwordx4 a[20:23], v1, s[8:11], s88 offen offset:1024 sc1
	buffer_load_dwordx4 a[24:27], v1, s[8:11], s88 offen offset:2048 sc1
	buffer_load_dwordx4 a[28:31], v1, s[8:11], s88 offen offset:3072 sc1
	s_waitcnt vmcnt(7)
	v_mfma_f32_32x32x16_bf16 v[72:87], v[56:59], a[0:3], 0
	s_add_u32 s88, s34, 0x8ea000
	buffer_load_dwordx4 a[32:35], v1, s[8:11], s88 offen offset:0 sc1
	ds_read_b128 v[56:59], v1 offset:4096
	s_waitcnt lgkmcnt(3)
	v_mfma_f32_32x32x16_bf16 v[88:103], v[60:63], a[0:3], 0
	buffer_load_dwordx4 a[36:39], v1, s[8:11], s88 offen offset:1024 sc1
	ds_read_b128 v[60:63], v1 offset:5120
	s_waitcnt lgkmcnt(3)
	s_waitcnt vmcnt(8)
	v_mfma_f32_32x32x16_bf16 v[72:87], v[64:67], a[4:7], v[72:87]
	buffer_load_dwordx4 a[40:43], v1, s[8:11], s88 offen offset:2048 sc1
	ds_read_b128 v[64:67], v1 offset:6144
	s_waitcnt lgkmcnt(3)
	v_mfma_f32_32x32x16_bf16 v[88:103], v[68:71], a[4:7], v[88:103]
	buffer_load_dwordx4 a[44:47], v1, s[8:11], s88 offen offset:3072 sc1
	ds_read_b128 v[68:71], v1 offset:7168
	s_waitcnt lgkmcnt(3)
	s_waitcnt vmcnt(9)
	v_mfma_f32_32x32x16_bf16 v[72:87], v[56:59], a[8:11], v[72:87]
	s_add_u32 s88, s34, 0x8eb000
	buffer_load_dwordx4 a[48:51], v1, s[8:11], s88 offen offset:0 sc1
	ds_read_b128 v[56:59], v1 offset:8192
	s_waitcnt lgkmcnt(3)
	v_mfma_f32_32x32x16_bf16 v[88:103], v[60:63], a[8:11], v[88:103]
	buffer_load_dwordx4 a[52:55], v1, s[8:11], s88 offen offset:1024 sc1
	ds_read_b128 v[60:63], v1 offset:9216
	s_waitcnt lgkmcnt(3)
	s_waitcnt vmcnt(10)
	v_mfma_f32_32x32x16_bf16 v[72:87], v[64:67], a[12:15], v[72:87]
	ds_read_b128 v[64:67], v1 offset:10240
	s_waitcnt lgkmcnt(3)
	v_mfma_f32_32x32x16_bf16 v[88:103], v[68:71], a[12:15], v[88:103]
	buffer_load_dwordx4 a[56:59], v1, s[8:11], s88 offen offset:2048 sc1
	ds_read_b128 v[68:71], v1 offset:11264
	s_waitcnt lgkmcnt(3)
	s_waitcnt vmcnt(10)
	v_mfma_f32_32x32x16_bf16 v[72:87], v[56:59], a[16:19], v[72:87]
	ds_read_b128 v[56:59], v1 offset:12288
	s_waitcnt lgkmcnt(3)
	v_mfma_f32_32x32x16_bf16 v[88:103], v[60:63], a[16:19], v[88:103]
	ds_read_b128 v[60:63], v1 offset:13312
	s_waitcnt lgkmcnt(3)
	s_waitcnt vmcnt(9)
	v_mfma_f32_32x32x16_bf16 v[72:87], v[64:67], a[20:23], v[72:87]
	buffer_load_dwordx4 a[60:63], v1, s[8:11], s88 offen offset:3072 sc1
	ds_read_b128 v[64:67], v1 offset:14336
	s_waitcnt lgkmcnt(3)
	v_mfma_f32_32x32x16_bf16 v[88:103], v[68:71], a[20:23], v[88:103]
	ds_read_b128 v[68:71], v1 offset:15360
	s_waitcnt lgkmcnt(3)
	s_waitcnt vmcnt(9)
	v_mfma_f32_32x32x16_bf16 v[72:87], v[56:59], a[24:27], v[72:87]
	s_add_u32 s88, s34, 0x8ec000
	buffer_load_dwordx4 a[64:67], v1, s[8:11], s88 offen offset:0 sc1
	ds_read_b128 v[56:59], v1 offset:16384
	s_waitcnt lgkmcnt(3)
	v_mfma_f32_32x32x16_bf16 v[88:103], v[60:63], a[24:27], v[88:103]
	ds_read_b128 v[60:63], v1 offset:17408
	s_waitcnt lgkmcnt(3)
	s_waitcnt vmcnt(9)
	v_mfma_f32_32x32x16_bf16 v[72:87], v[64:67], a[28:31], v[72:87]
	buffer_load_dwordx4 a[68:71], v1, s[8:11], s88 offen offset:1024 sc1
	ds_read_b128 v[64:67], v1 offset:18432
	s_waitcnt lgkmcnt(3)
	v_mfma_f32_32x32x16_bf16 v[88:103], v[68:71], a[28:31], v[88:103]
	ds_read_b128 v[68:71], v1 offset:19456
	s_waitcnt lgkmcnt(3)
	s_waitcnt vmcnt(9)
	v_mfma_f32_32x32x16_bf16 v[72:87], v[56:59], a[32:35], v[72:87]
	buffer_load_dwordx4 a[72:75], v1, s[8:11], s88 offen offset:2048 sc1
	ds_read_b128 v[56:59], v1 offset:20480
	s_waitcnt lgkmcnt(3)
	v_mfma_f32_32x32x16_bf16 v[88:103], v[60:63], a[32:35], v[88:103]
	ds_read_b128 v[60:63], v1 offset:21504
	s_waitcnt lgkmcnt(3)
	s_waitcnt vmcnt(9)
	v_mfma_f32_32x32x16_bf16 v[72:87], v[64:67], a[36:39], v[72:87]
	buffer_load_dwordx4 a[76:79], v1, s[8:11], s88 offen offset:3072 sc1
	ds_read_b128 v[64:67], v1 offset:22528
	s_waitcnt lgkmcnt(3)
	v_mfma_f32_32x32x16_bf16 v[88:103], v[68:71], a[36:39], v[88:103]
	ds_read_b128 v[68:71], v1 offset:23552
	s_waitcnt lgkmcnt(3)
	s_waitcnt vmcnt(9)
	v_mfma_f32_32x32x16_bf16 v[72:87], v[56:59], a[40:43], v[72:87]
	s_add_u32 s88, s34, 0x8ed000
	buffer_load_dwordx4 a[80:83], v1, s[8:11], s88 offen offset:0 sc1
	ds_read_b128 v[56:59], v1 offset:24576
	s_waitcnt lgkmcnt(3)
	v_mfma_f32_32x32x16_bf16 v[88:103], v[60:63], a[40:43], v[88:103]
	ds_read_b128 v[60:63], v1 offset:25600
	s_waitcnt lgkmcnt(3)
	s_waitcnt vmcnt(9)
	v_mfma_f32_32x32x16_bf16 v[72:87], v[64:67], a[44:47], v[72:87]
	buffer_load_dwordx4 a[84:87], v1, s[8:11], s88 offen offset:1024 sc1
	ds_read_b128 v[64:67], v1 offset:26624
	s_waitcnt lgkmcnt(3)
	v_mfma_f32_32x32x16_bf16 v[88:103], v[68:71], a[44:47], v[88:103]
	ds_read_b128 v[68:71], v1 offset:27648
	s_waitcnt lgkmcnt(3)
	s_waitcnt vmcnt(9)
	v_mfma_f32_32x32x16_bf16 v[72:87], v[56:59], a[48:51], v[72:87]
	buffer_load_dwordx4 a[88:91], v1, s[8:11], s88 offen offset:2048 sc1
	ds_read_b128 v[56:59], v1 offset:28672
	s_waitcnt lgkmcnt(3)
	v_mfma_f32_32x32x16_bf16 v[88:103], v[60:63], a[48:51], v[88:103]
	ds_read_b128 v[60:63], v1 offset:29696
	s_waitcnt lgkmcnt(3)
	s_waitcnt vmcnt(9)
	v_mfma_f32_32x32x16_bf16 v[72:87], v[64:67], a[52:55], v[72:87]
	ds_read_b128 v[64:67], v1 offset:30720
	s_waitcnt lgkmcnt(3)
	v_mfma_f32_32x32x16_bf16 v[88:103], v[68:71], a[52:55], v[88:103]
	buffer_load_dwordx4 a[92:95], v1, s[8:11], s88 offen offset:3072 sc1
	ds_read_b128 v[68:71], v1 offset:31744
	s_waitcnt lgkmcnt(3)
	s_waitcnt vmcnt(9)
	v_mfma_f32_32x32x16_bf16 v[72:87], v[56:59], a[56:59], v[72:87]
	ds_read_b128 v[56:59], v1 offset:32768
	s_waitcnt lgkmcnt(3)
	v_mfma_f32_32x32x16_bf16 v[88:103], v[60:63], a[56:59], v[88:103]
	s_add_u32 s88, s34, 0x8ee000
	buffer_load_dwordx4 a[96:99], v1, s[8:11], s88 offen offset:0 sc1
	ds_read_b128 v[60:63], v1 offset:33792
	s_waitcnt lgkmcnt(3)
	s_waitcnt vmcnt(9)
	v_mfma_f32_32x32x16_bf16 v[72:87], v[64:67], a[60:63], v[72:87]
	ds_read_b128 v[64:67], v1 offset:34816
	s_waitcnt lgkmcnt(3)
	v_mfma_f32_32x32x16_bf16 v[88:103], v[68:71], a[60:63], v[88:103]
	buffer_load_dwordx4 a[100:103], v1, s[8:11], s88 offen offset:1024 sc1
	ds_read_b128 v[68:71], v1 offset:35840
	s_waitcnt lgkmcnt(3)
	s_waitcnt vmcnt(9)
	v_mfma_f32_32x32x16_bf16 v[72:87], v[56:59], a[64:67], v[72:87]
	ds_read_b128 v[56:59], v1 offset:36864
	s_waitcnt lgkmcnt(3)
	v_mfma_f32_32x32x16_bf16 v[88:103], v[60:63], a[64:67], v[88:103]
	buffer_load_dwordx4 a[104:107], v1, s[8:11], s88 offen offset:2048 sc1
	ds_read_b128 v[60:63], v1 offset:37888
	s_waitcnt lgkmcnt(3)
	s_waitcnt vmcnt(9)
	v_mfma_f32_32x32x16_bf16 v[72:87], v[64:67], a[68:71], v[72:87]
	ds_read_b128 v[64:67], v1 offset:38912
	s_waitcnt lgkmcnt(3)
	v_mfma_f32_32x32x16_bf16 v[88:103], v[68:71], a[68:71], v[88:103]
	buffer_load_dwordx4 a[108:111], v1, s[8:11], s88 offen offset:3072 sc1
	ds_read_b128 v[68:71], v1 offset:39936
	s_waitcnt lgkmcnt(3)
	s_waitcnt vmcnt(9)
	v_mfma_f32_32x32x16_bf16 v[72:87], v[56:59], a[72:75], v[72:87]
	ds_read_b128 v[56:59], v1 offset:40960
	s_waitcnt lgkmcnt(3)
	v_mfma_f32_32x32x16_bf16 v[88:103], v[60:63], a[72:75], v[88:103]
	s_add_u32 s88, s34, 0x8ef000
	buffer_load_dwordx4 a[112:115], v1, s[8:11], s88 offen offset:0 sc1
	ds_read_b128 v[60:63], v1 offset:41984
	s_waitcnt lgkmcnt(3)
	s_waitcnt vmcnt(9)
	v_mfma_f32_32x32x16_bf16 v[72:87], v[64:67], a[76:79], v[72:87]
	ds_read_b128 v[64:67], v1 offset:43008
	s_waitcnt lgkmcnt(3)
	v_mfma_f32_32x32x16_bf16 v[88:103], v[68:71], a[76:79], v[88:103]
	s_add_u32 s89, s30, 0x18000
	s_add_u32 m0, s39, 0x18000
	s_nop 0
	buffer_load_dwordx4 v1, s[8:11], s89 offen offset:0 lds
	ds_read_b128 v[68:71], v1 offset:44032
	s_waitcnt lgkmcnt(3)
	s_waitcnt vmcnt(9)
	v_mfma_f32_32x32x16_bf16 v[72:87], v[56:59], a[80:83], v[72:87]
	ds_read_b128 v[56:59], v1 offset:45056
	s_waitcnt lgkmcnt(3)
	v_mfma_f32_32x32x16_bf16 v[88:103], v[60:63], a[80:83], v[88:103]
	buffer_load_dwordx4 v1, s[8:11], s89 offen offset:1024 lds
	ds_read_b128 v[60:63], v1 offset:46080
	s_waitcnt lgkmcnt(3)
	s_waitcnt vmcnt(9)
	v_mfma_f32_32x32x16_bf16 v[72:87], v[64:67], a[84:87], v[72:87]
	ds_read_b128 v[64:67], v1 offset:47104
	s_waitcnt lgkmcnt(3)
	v_mfma_f32_32x32x16_bf16 v[88:103], v[68:71], a[84:87], v[88:103]
	ds_read_b128 v[68:71], v1 offset:48128
	s_waitcnt lgkmcnt(3)
	s_waitcnt vmcnt(8)
	v_mfma_f32_32x32x16_bf16 v[72:87], v[56:59], a[88:91], v[72:87]
	buffer_load_dwordx4 a[116:119], v1, s[8:11], s88 offen offset:1024 sc1
	ds_read_b128 v[56:59], v1 offset:49152
	s_waitcnt lgkmcnt(3)
	v_mfma_f32_32x32x16_bf16 v[88:103], v[60:63], a[88:91], v[88:103]
	ds_read_b128 v[60:63], v1 offset:50176
	s_waitcnt lgkmcnt(3)
	s_waitcnt vmcnt(8)
	v_mfma_f32_32x32x16_bf16 v[72:87], v[64:67], a[92:95], v[72:87]
	buffer_load_dwordx4 v1, s[8:11], s89 offen offset:2048 lds
	ds_read_b128 v[64:67], v1 offset:51200
	s_waitcnt lgkmcnt(3)
	v_mfma_f32_32x32x16_bf16 v[88:103], v[68:71], a[92:95], v[88:103]
	ds_read_b128 v[68:71], v1 offset:52224
	s_waitcnt lgkmcnt(3)
	s_waitcnt vmcnt(8)
	v_mfma_f32_32x32x16_bf16 v[72:87], v[56:59], a[96:99], v[72:87]
	buffer_load_dwordx4 v1, s[8:11], s89 offen offset:3072 lds
	ds_read_b128 v[56:59], v1 offset:53248
	s_waitcnt lgkmcnt(3)
	v_mfma_f32_32x32x16_bf16 v[88:103], v[60:63], a[96:99], v[88:103]
	ds_read_b128 v[60:63], v1 offset:54272
	s_waitcnt lgkmcnt(3)
	s_waitcnt vmcnt(8)
	v_mfma_f32_32x32x16_bf16 v[72:87], v[64:67], a[100:103], v[72:87]
	s_add_u32 s93, s83, 0x262a000
	v_and_b32 v253, 0x200, v1
	v_lshrrev_b32 v252, 1, v1
	v_lshl_or_b32 v253, v253, 21, v252
	buffer_load_dwordx2 v[212:213], v253, s[8:11], s93 offen offset:0
	buffer_load_dwordx2 v[214:215], v253, s[8:11], s93 offen offset:256
	buffer_load_dwordx2 v[216:217], v253, s[8:11], s93 offen offset:512
	buffer_load_dwordx2 v[218:219], v253, s[8:11], s93 offen offset:768
	ds_read_b128 v[64:67], v1 offset:55296
	s_waitcnt lgkmcnt(3)
	v_mfma_f32_32x32x16_bf16 v[88:103], v[68:71], a[100:103], v[88:103]
	buffer_load_dwordx4 a[120:123], v1, s[8:11], s88 offen offset:2048 sc1
	ds_read_b128 v[68:71], v1 offset:56320
	s_waitcnt lgkmcnt(3)
	s_waitcnt vmcnt(12)
	v_mfma_f32_32x32x16_bf16 v[72:87], v[56:59], a[104:107], v[72:87]
	s_add_u32 s93, s35, 0x23e8000
	buffer_load_dwordx2 v[184:185], v7, s[8:11], s93 offen offset:0 sc1
	buffer_load_dwordx2 v[186:187], v7, s[8:11], s93 offen offset:128 sc1
	buffer_load_dwordx2 v[188:189], v7, s[8:11], s93 offen offset:256 sc1
	buffer_load_dwordx2 v[190:191], v7, s[8:11], s93 offen offset:384 sc1
	ds_read_b128 v[56:59], v1 offset:57344
	s_waitcnt lgkmcnt(3)
	v_mfma_f32_32x32x16_bf16 v[88:103], v[60:63], a[104:107], v[88:103]
	buffer_load_dwordx4 a[124:127], v1, s[8:11], s88 offen offset:3072 sc1
	ds_read_b128 v[60:63], v1 offset:58368
	s_waitcnt lgkmcnt(3)
	s_waitcnt vmcnt(16)
	v_mfma_f32_32x32x16_bf16 v[72:87], v[64:67], a[108:111], v[72:87]
	s_add_u32 s88, s34, 0x8f0000
	buffer_load_dwordx4 a[128:131], v1, s[8:11], s88 offen offset:0 sc1
	ds_read_b128 v[64:67], v1 offset:59392
	s_waitcnt lgkmcnt(3)
	v_mfma_f32_32x32x16_bf16 v[88:103], v[68:71], a[108:111], v[88:103]
	ds_read_b128 v[68:71], v1 offset:60416
	s_waitcnt lgkmcnt(3)
	s_waitcnt vmcnt(16)
	v_mfma_f32_32x32x16_bf16 v[72:87], v[56:59], a[112:115], v[72:87]
	ds_read_b128 v[56:59], v1 offset:61440
	s_waitcnt lgkmcnt(3)
	v_mfma_f32_32x32x16_bf16 v[88:103], v[60:63], a[112:115], v[88:103]
	ds_read_b128 v[60:63], v1 offset:62464
	s_waitcnt lgkmcnt(3)
	buffer_load_dwordx4 a[132:135], v1, s[8:11], s88 offen offset:1024 sc1
	buffer_load_dwordx4 a[136:139], v1, s[8:11], s88 offen offset:2048 sc1
	s_waitcnt vmcnt(15)
	v_mfma_f32_32x32x16_bf16 v[72:87], v[64:67], a[116:119], v[72:87]
	buffer_load_dwordx4 a[140:143], v1, s[8:11], s88 offen offset:3072 sc1
	ds_read_b128 v[64:67], v1 offset:63488
	s_waitcnt lgkmcnt(3)
	v_mfma_f32_32x32x16_bf16 v[88:103], v[68:71], a[116:119], v[88:103]
	ds_read_b128 v[68:71], v1 offset:64512
	s_waitcnt lgkmcnt(3)
	s_add_u32 s88, s34, 0x8f1000
	buffer_load_dwordx4 a[144:147], v1, s[8:11], s88 offen offset:0 sc1
	s_add_u32 s89, s30, 0x1c000
	s_add_u32 m0, s39, 0x1c000
	s_nop 0
	buffer_load_dwordx4 v1, s[8:11], s89 offen offset:0 lds
	s_waitcnt vmcnt(11)
	v_mfma_f32_32x32x16_bf16 v[72:87], v[56:59], a[120:123], v[72:87]
	buffer_load_dwordx4 a[148:151], v1, s[8:11], s88 offen offset:1024 sc1
	ds_read_b128 v[56:59], v2 offset:0
	s_waitcnt lgkmcnt(3)
	v_mfma_f32_32x32x16_bf16 v[88:103], v[60:63], a[120:123], v[88:103]
	ds_read_b128 v[60:63], v2 offset:1024
	s_waitcnt lgkmcnt(3)
	s_waitcnt vmcnt(7)
	v_mfma_f32_32x32x16_bf16 v[72:87], v[64:67], a[124:127], v[72:87]
	buffer_load_dwordx4 v1, s[8:11], s89 offen offset:1024 lds
	ds_read_b128 v[64:67], v2 offset:2048
	s_waitcnt lgkmcnt(3)
	v_mfma_f32_32x32x16_bf16 v[88:103], v[68:71], a[124:127], v[88:103]
	buffer_load_dwordx4 v1, s[8:11], s89 offen offset:2048 lds
	ds_read_b128 v[68:71], v2 offset:3072
	s_waitcnt lgkmcnt(3)
	s_waitcnt vmcnt(8)
	v_mfma_f32_32x32x16_bf16 v[72:87], v[56:59], a[128:131], v[72:87]
	buffer_load_dwordx4 a[152:155], v1, s[8:11], s88 offen offset:2048 sc1
	ds_read_b128 v[56:59], v2 offset:4096
	s_waitcnt lgkmcnt(3)
	v_mfma_f32_32x32x16_bf16 v[88:103], v[60:63], a[128:131], v[88:103]
	buffer_load_dwordx4 v1, s[8:11], s89 offen offset:3072 lds
	ds_read_b128 v[60:63], v2 offset:5120
	s_waitcnt lgkmcnt(3)
	s_waitcnt vmcnt(9)
	v_mfma_f32_32x32x16_bf16 v[72:87], v[64:67], a[132:135], v[72:87]
	buffer_load_dwordx4 a[156:159], v1, s[8:11], s88 offen offset:3072 sc1
	ds_read_b128 v[64:67], v2 offset:6144
	s_waitcnt lgkmcnt(3)
	v_mfma_f32_32x32x16_bf16 v[88:103], v[68:71], a[132:135], v[88:103]
	ds_read_b128 v[68:71], v2 offset:7168
	s_waitcnt lgkmcnt(3)
	s_waitcnt vmcnt(9)
	v_mfma_f32_32x32x16_bf16 v[72:87], v[56:59], a[136:139], v[72:87]
	s_add_u32 s89, s30, 0x20000
	s_add_u32 m0, s39, 0x20000
	s_nop 0
	buffer_load_dwordx4 v27, s[8:11], s89 offen offset:0 lds
	ds_read_b128 v[56:59], v2 offset:8192
	s_waitcnt lgkmcnt(3)
	v_mfma_f32_32x32x16_bf16 v[88:103], v[60:63], a[136:139], v[88:103]
	ds_read_b128 v[60:63], v2 offset:9216
	s_waitcnt lgkmcnt(3)
	s_waitcnt vmcnt(9)
	v_mfma_f32_32x32x16_bf16 v[72:87], v[64:67], a[140:143], v[72:87]
	ds_read_b128 v[64:67], v2 offset:10240
	s_waitcnt lgkmcnt(3)
	v_mfma_f32_32x32x16_bf16 v[88:103], v[68:71], a[140:143], v[88:103]
	ds_read_b128 v[68:71], v2 offset:11264
	s_waitcnt lgkmcnt(3)
	s_waitcnt vmcnt(8)
	v_mfma_f32_32x32x16_bf16 v[72:87], v[56:59], a[144:147], v[72:87]
	ds_read_b128 v[56:59], v2 offset:12288
	s_waitcnt lgkmcnt(3)
	v_mfma_f32_32x32x16_bf16 v[88:103], v[60:63], a[144:147], v[88:103]
	v_add_f32 v184, v184, v186
	v_add_f32 v185, v185, v187
	v_add_f32 v188, v188, v190
	ds_read_b128 v[60:63], v2 offset:13312
	s_waitcnt lgkmcnt(3)
	buffer_load_dwordx4 v27, s[8:11], s89 offen offset:1024 lds
	s_waitcnt vmcnt(7)
	v_mfma_f32_32x32x16_bf16 v[72:87], v[64:67], a[148:151], v[72:87]
	v_add_f32 v189, v189, v191
	v_add_f32 v184, v184, v188
	v_add_f32 v185, v185, v189
	buffer_load_dwordx4 v27, s[8:11], s89 offen offset:2048 lds
	ds_read_b128 v[64:67], v2 offset:14336
	s_waitcnt lgkmcnt(3)
	v_mfma_f32_32x32x16_bf16 v[88:103], v[68:71], a[148:151], v[88:103]
	v_mov_b32 v186, v184
	v_mov_b32 v187, v185
	s_nop 0
	v_permlane32_swap_b32 v184, v186
	v_permlane32_swap_b32 v185, v187
	ds_read_b128 v[68:71], v2 offset:15360
	s_waitcnt lgkmcnt(3)
	buffer_load_dwordx4 v27, s[8:11], s89 offen offset:3072 lds
	s_add_u32 s89, s30, 0x24000
	s_add_u32 m0, s39, 0x24000
	s_nop 0
	buffer_load_dwordx4 v27, s[8:11], s89 offen offset:0 lds
	s_waitcnt vmcnt(7)
	v_mfma_f32_32x32x16_bf16 v[72:87], v[56:59], a[152:155], v[72:87]
	v_add_f32 v184, v184, v186
	v_add_f32 v185, v185, v187
	v_mul_f32 v184, 0x3acccccd, v184
	buffer_load_dwordx4 v27, s[8:11], s89 offen offset:1024 lds
	s_barrier
	ds_read_b128 v[56:59], v2 offset:16384
	s_waitcnt lgkmcnt(3)
	v_mfma_f32_32x32x16_bf16 v[88:103], v[60:63], a[152:155], v[88:103]
	v_mul_f32 v185, 0x3acccccd, v185
	v_fma_f32 v185, -v184, v184, v185
	v_max_f32 v185, 0, v185
	v_add_f32 v185, 0x3727c5ac, v185
	ds_read_b128 v[60:63], v2 offset:17408
	s_waitcnt lgkmcnt(3)
	buffer_load_dwordx4 v27, s[8:11], s89 offen offset:2048 lds
	s_waitcnt vmcnt(7)
	v_mfma_f32_32x32x16_bf16 v[72:87], v[64:67], a[156:159], v[72:87]
	v_cvt_pk_bf16_f32 v221, -v184, 0
	v_lshlrev_b32 v186, 16, v221
	v_sub_f32 v186, -v184, v186
	buffer_load_dwordx4 v27, s[8:11], s89 offen offset:3072 lds
	ds_read_b128 v[64:67], v2 offset:18432
	s_waitcnt lgkmcnt(3)
	v_mfma_f32_32x32x16_bf16 v[88:103], v[68:71], a[156:159], v[88:103]
	v_cvt_pk_bf16_f32 v220, -v184, v186
	v_rsq_f32 v31, v185
	s_nop 0
	v_mul_f32 v248, 0x3fb8aa3b, v31
	ds_read_b128 v[68:71], v2 offset:19456
	s_waitcnt lgkmcnt(3)
	v_mfma_f32_32x32x8_bf16 v[104:119], v[216:217], v[220:221], 0
	v_mfma_f32_32x32x8_bf16 v[120:135], v[218:219], v[220:221], 0
	v_mfma_f32_32x32x8_bf16 v[72:87], v[212:213], v[220:221], v[72:87]
	s_nop 0
	v_mfma_f32_32x32x8_bf16 v[88:103], v[214:215], v[220:221], v[88:103]
	s_nop 5
	v_mfma_f32_32x32x16_bf16 v[104:119], v[56:59], a[0:3], v[104:119]
	s_add_u32 s93, s42, 0x17e8000
	buffer_load_dword v0, v8, s[8:11], s93 offen offset:0 sc1
	ds_read_b128 v[56:59], v2 offset:20480
	s_waitcnt lgkmcnt(3)
	v_mfma_f32_32x32x16_bf16 v[104:119], v[60:63], a[4:7], v[104:119]
	s_add_u32 s93, s42, 0x17e8000
	buffer_load_dword v0, v9, s[8:11], s93 offen offset:0 sc1
	ds_read_b128 v[60:63], v2 offset:21504
	s_waitcnt lgkmcnt(3)
	v_mfma_f32_32x32x16_bf16 v[104:119], v[64:67], a[8:11], v[104:119]
	v_max3_f32 v249, v72, v73, v74
	v_min3_f32 v250, v72, v73, v74
	v_max3_f32 v249, v249, v75, v76
	v_min3_f32 v250, v250, v75, v76
	s_add_u32 s93, s42, 0x17e8000
	buffer_load_dword v0, v10, s[8:11], s93 offen offset:0 sc1
	ds_read_b128 v[64:67], v2 offset:22528
	s_waitcnt lgkmcnt(3)
	v_mfma_f32_32x32x16_bf16 v[104:119], v[68:71], a[12:15], v[104:119]
	v_max3_f32 v249, v249, v77, v78
	v_min3_f32 v250, v250, v77, v78
	v_max3_f32 v249, v249, v79, v80
	v_min3_f32 v250, v250, v79, v80
	s_barrier
	ds_read_b128 v[68:71], v2 offset:23552
	s_waitcnt lgkmcnt(3)
	v_mfma_f32_32x32x16_bf16 v[104:119], v[56:59], a[16:19], v[104:119]
	v_max3_f32 v249, v249, v81, v82
	v_min3_f32 v250, v250, v81, v82
	v_max3_f32 v249, v249, v83, v84
	v_min3_f32 v250, v250, v83, v84
	s_add_u32 s89, s31, 0
	s_add_u32 m0, s39, 0xc000
	s_nop 0
	buffer_load_dwordx4 v1, s[8:11], s89 offen offset:0 lds
	ds_read_b128 v[56:59], v2 offset:24576
	s_waitcnt lgkmcnt(3)
	v_mfma_f32_32x32x16_bf16 v[104:119], v[60:63], a[20:23], v[104:119]
	v_max3_f32 v249, v249, v85, v86
	v_min3_f32 v250, v250, v85, v86
	v_max3_f32 v249, v249, v87, v88
	buffer_load_dwordx4 v1, s[8:11], s89 offen offset:1024 lds
	ds_read_b128 v[60:63], v2 offset:25600
	s_waitcnt lgkmcnt(3)
	v_mfma_f32_32x32x16_bf16 v[104:119], v[64:67], a[24:27], v[104:119]
	v_min3_f32 v250, v250, v87, v88
	v_max3_f32 v249, v249, v89, v90
	v_min3_f32 v250, v250, v89, v90
	v_max_f32 v249, v249, v91
	buffer_load_dwordx4 v1, s[8:11], s89 offen offset:2048 lds
	ds_read_b128 v[64:67], v2 offset:26624
	s_waitcnt lgkmcnt(3)
	v_mfma_f32_32x32x16_bf16 v[104:119], v[68:71], a[28:31], v[104:119]
	v_min_f32 v250, v250, v91
	v_mul_f32 v249, v248, v249
	v_mul_f32 v250, v248, v250
	v_fma_f32 v192, v72, v248, -v249
	ds_read_b128 v[68:71], v2 offset:27648
	s_waitcnt lgkmcnt(3)
	v_mfma_f32_32x32x16_bf16 v[104:119], v[56:59], a[32:35], v[104:119]
	v_fma_f32 v72, -v72, v248, v250
	v_fma_f32 v193, v73, v248, -v249
	v_fma_f32 v73, -v73, v248, v250
	v_exp_f32 v192, v192
	ds_read_b128 v[56:59], v2 offset:28672
	s_waitcnt lgkmcnt(3)
	v_mfma_f32_32x32x16_bf16 v[104:119], v[60:63], a[36:39], v[104:119]
	v_exp_f32 v72, v72
	v_fma_f32 v194, v74, v248, -v249
	v_fma_f32 v74, -v74, v248, v250
	ds_read_b128 v[60:63], v2 offset:29696
	s_waitcnt lgkmcnt(3)
	v_mfma_f32_32x32x16_bf16 v[104:119], v[64:67], a[40:43], v[104:119]
	v_exp_f32 v193, v193
	v_exp_f32 v73, v73
	v_fma_f32 v195, v75, v248, -v249
	v_fma_f32 v75, -v75, v248, v250
	buffer_load_dwordx4 v1, s[8:11], s89 offen offset:3072 lds
	ds_read_b128 v[64:67], v2 offset:30720
	s_waitcnt lgkmcnt(3)
	v_mfma_f32_32x32x16_bf16 v[104:119], v[68:71], a[44:47], v[104:119]
	v_exp_f32 v194, v194
	v_exp_f32 v74, v74
	v_add_f32 v251, v192, v193
	v_add_f32 v252, v72, v73
	ds_read_b128 v[68:71], v2 offset:31744
	s_waitcnt lgkmcnt(3)
	v_mfma_f32_32x32x16_bf16 v[104:119], v[56:59], a[48:51], v[104:119]
	v_fma_f32 v196, v76, v248, -v249
	v_fma_f32 v76, -v76, v248, v250
	v_exp_f32 v195, v195
	v_exp_f32 v75, v75
	ds_read_b128 v[56:59], v2 offset:32768
	s_waitcnt lgkmcnt(3)
	v_mfma_f32_32x32x16_bf16 v[104:119], v[60:63], a[52:55], v[104:119]
	v_add_f32 v251, v251, v194
	v_add_f32 v252, v252, v74
	v_fma_f32 v197, v77, v248, -v249
	s_add_u32 s89, s31, 0x4000
	s_add_u32 m0, s39, 0x10000
	s_nop 0
	buffer_load_dwordx4 v1, s[8:11], s89 offen offset:0 lds
	ds_read_b128 v[60:63], v2 offset:33792
	s_waitcnt lgkmcnt(3)
	v_mfma_f32_32x32x16_bf16 v[104:119], v[64:67], a[56:59], v[104:119]
	v_fma_f32 v77, -v77, v248, v250
	v_exp_f32 v196, v196
	v_exp_f32 v76, v76
	v_add_f32 v251, v251, v195
	ds_read_b128 v[64:67], v2 offset:34816
	s_waitcnt lgkmcnt(3)
	v_mfma_f32_32x32x16_bf16 v[104:119], v[68:71], a[60:63], v[104:119]
	v_add_f32 v252, v252, v75
	v_fma_f32 v198, v78, v248, -v249
	v_fma_f32 v78, -v78, v248, v250
	v_exp_f32 v197, v197
	ds_read_b128 v[68:71], v2 offset:35840
	s_waitcnt lgkmcnt(3)
	v_mfma_f32_32x32x16_bf16 v[104:119], v[56:59], a[64:67], v[104:119]
	v_exp_f32 v77, v77
	v_add_f32 v251, v251, v196
	v_add_f32 v252, v252, v76
	v_fma_f32 v199, v79, v248, -v249
	buffer_load_dwordx4 v1, s[8:11], s89 offen offset:1024 lds
	ds_read_b128 v[56:59], v2 offset:36864
	s_waitcnt lgkmcnt(3)
	v_mfma_f32_32x32x16_bf16 v[104:119], v[60:63], a[68:71], v[104:119]
	v_fma_f32 v79, -v79, v248, v250
	v_exp_f32 v198, v198
	v_exp_f32 v78, v78
	ds_read_b128 v[60:63], v2 offset:37888
	s_waitcnt lgkmcnt(3)
	v_mfma_f32_32x32x16_bf16 v[104:119], v[64:67], a[72:75], v[104:119]
	v_add_f32 v251, v251, v197
	v_add_f32 v252, v252, v77
	v_fma_f32 v200, v80, v248, -v249
	v_fma_f32 v80, -v80, v248, v250
	ds_read_b128 v[64:67], v2 offset:38912
	s_waitcnt lgkmcnt(3)
	v_mfma_f32_32x32x16_bf16 v[104:119], v[68:71], a[76:79], v[104:119]
	v_exp_f32 v199, v199
	v_exp_f32 v79, v79
	v_add_f32 v251, v251, v198
	v_add_f32 v252, v252, v78
	ds_read_b128 v[68:71], v2 offset:39936
	s_waitcnt lgkmcnt(3)
	v_mfma_f32_32x32x16_bf16 v[104:119], v[56:59], a[80:83], v[104:119]
	v_fma_f32 v201, v81, v248, -v249
	v_fma_f32 v81, -v81, v248, v250
	v_exp_f32 v200, v200
	buffer_load_dwordx4 v1, s[8:11], s89 offen offset:2048 lds
	ds_read_b128 v[56:59], v2 offset:40960
	s_waitcnt lgkmcnt(3)
	v_mfma_f32_32x32x16_bf16 v[104:119], v[60:63], a[84:87], v[104:119]
	v_exp_f32 v80, v80
	v_add_f32 v251, v251, v199
	v_add_f32 v252, v252, v79
	v_fma_f32 v202, v82, v248, -v249
	ds_read_b128 v[60:63], v2 offset:41984
	s_waitcnt lgkmcnt(3)
	v_mfma_f32_32x32x16_bf16 v[104:119], v[64:67], a[88:91], v[104:119]
	v_fma_f32 v82, -v82, v248, v250
	v_exp_f32 v201, v201
	v_exp_f32 v81, v81
	v_add_f32 v251, v251, v200
	ds_read_b128 v[64:67], v2 offset:43008
	s_waitcnt lgkmcnt(3)
	v_mfma_f32_32x32x16_bf16 v[104:119], v[68:71], a[92:95], v[104:119]
	v_add_f32 v252, v252, v80
	v_fma_f32 v203, v83, v248, -v249
	v_fma_f32 v83, -v83, v248, v250
	v_exp_f32 v202, v202
	ds_read_b128 v[68:71], v2 offset:44032
	s_waitcnt lgkmcnt(3)
	v_mfma_f32_32x32x16_bf16 v[104:119], v[56:59], a[96:99], v[104:119]
	v_exp_f32 v82, v82
	v_add_f32 v251, v251, v201
	v_add_f32 v252, v252, v81
	buffer_load_dwordx4 v1, s[8:11], s89 offen offset:3072 lds
	ds_read_b128 v[56:59], v2 offset:45056
	s_waitcnt lgkmcnt(3)
	v_mfma_f32_32x32x16_bf16 v[104:119], v[60:63], a[100:103], v[104:119]
	v_fma_f32 v204, v84, v248, -v249
	v_fma_f32 v84, -v84, v248, v250
	v_exp_f32 v203, v203
	v_exp_f32 v83, v83
	ds_read_b128 v[60:63], v2 offset:46080
	s_waitcnt lgkmcnt(3)
	v_mfma_f32_32x32x16_bf16 v[104:119], v[64:67], a[104:107], v[104:119]
	v_add_f32 v251, v251, v202
	v_add_f32 v252, v252, v82
	v_fma_f32 v205, v85, v248, -v249
	v_fma_f32 v85, -v85, v248, v250
	ds_read_b128 v[64:67], v2 offset:47104
	s_waitcnt lgkmcnt(3)
	v_mfma_f32_32x32x16_bf16 v[104:119], v[68:71], a[108:111], v[104:119]
	v_exp_f32 v204, v204
	v_exp_f32 v84, v84
	v_add_f32 v251, v251, v203
	v_add_f32 v252, v252, v83
	ds_read_b128 v[68:71], v2 offset:48128
	s_waitcnt lgkmcnt(3)
	v_mfma_f32_32x32x16_bf16 v[104:119], v[56:59], a[112:115], v[104:119]
	v_fma_f32 v206, v86, v248, -v249
	v_fma_f32 v86, -v86, v248, v250
	v_exp_f32 v205, v205
	ds_read_b128 v[56:59], v2 offset:49152
	s_waitcnt lgkmcnt(3)
	v_mfma_f32_32x32x16_bf16 v[104:119], v[60:63], a[116:119], v[104:119]
	v_exp_f32 v85, v85
	v_add_f32 v251, v251, v204
	v_add_f32 v252, v252, v84
	v_fma_f32 v207, v87, v248, -v249
	ds_read_b128 v[60:63], v2 offset:50176
	s_waitcnt lgkmcnt(3)
	v_mfma_f32_32x32x16_bf16 v[104:119], v[64:67], a[120:123], v[104:119]
	v_fma_f32 v87, -v87, v248, v250
	v_exp_f32 v206, v206
	v_exp_f32 v86, v86
	v_add_f32 v251, v251, v205
	ds_read_b128 v[64:67], v2 offset:51200
	s_waitcnt lgkmcnt(3)
	v_mfma_f32_32x32x16_bf16 v[104:119], v[68:71], a[124:127], v[104:119]
	v_add_f32 v252, v252, v85
	v_fma_f32 v208, v88, v248, -v249
	v_fma_f32 v88, -v88, v248, v250
	v_exp_f32 v207, v207
	ds_read_b128 v[68:71], v2 offset:52224
	s_waitcnt lgkmcnt(3)
	v_mfma_f32_32x32x16_bf16 v[104:119], v[56:59], a[128:131], v[104:119]
	v_exp_f32 v87, v87
	v_add_f32 v251, v251, v206
	v_add_f32 v252, v252, v86
	ds_read_b128 v[56:59], v2 offset:53248
	s_waitcnt lgkmcnt(3)
	v_mfma_f32_32x32x16_bf16 v[104:119], v[60:63], a[132:135], v[104:119]
	v_fma_f32 v209, v89, v248, -v249
	v_fma_f32 v89, -v89, v248, v250
	v_exp_f32 v208, v208
	v_exp_f32 v88, v88
	ds_read_b128 v[60:63], v2 offset:54272
	s_waitcnt lgkmcnt(3)
	v_mfma_f32_32x32x16_bf16 v[104:119], v[64:67], a[136:139], v[104:119]
	v_add_f32 v251, v251, v207
	v_add_f32 v252, v252, v87
	v_fma_f32 v210, v90, v248, -v249
	v_fma_f32 v90, -v90, v248, v250
	ds_read_b128 v[64:67], v2 offset:55296
	s_waitcnt lgkmcnt(3)
	v_mfma_f32_32x32x16_bf16 v[104:119], v[68:71], a[140:143], v[104:119]
	v_exp_f32 v209, v209
	v_exp_f32 v89, v89
	v_add_f32 v251, v251, v208
	v_add_f32 v252, v252, v88
	ds_read_b128 v[68:71], v2 offset:56320
	s_waitcnt lgkmcnt(3)
	v_mfma_f32_32x32x16_bf16 v[104:119], v[56:59], a[144:147], v[104:119]
	v_fma_f32 v211, v91, v248, -v249
	v_fma_f32 v91, -v91, v248, v250
	v_exp_f32 v210, v210
	s_waitcnt lgkmcnt(2)
	v_mfma_f32_32x32x16_bf16 v[104:119], v[60:63], a[148:151], v[104:119]
	v_exp_f32 v90, v90
	v_add_f32 v251, v251, v209
	v_add_f32 v252, v252, v89
	v_exp_f32 v211, v211
	s_waitcnt lgkmcnt(1)
	v_mfma_f32_32x32x16_bf16 v[104:119], v[64:67], a[152:155], v[104:119]
	v_exp_f32 v91, v91
	v_add_f32 v251, v251, v210
	v_add_f32 v252, v252, v90
	v_add_f32 v251, v251, v211
	s_waitcnt lgkmcnt(0)
	v_mfma_f32_32x32x16_bf16 v[104:119], v[68:71], a[156:159], v[104:119]
	v_add_f32 v252, v252, v91
	v_rcp_f32 v251, v251
	v_rcp_f32 v252, v252
	v_pk_mul_f32 v[192:193], v[192:193], v[250:251] op_sel:[0,1] op_sel_hi:[1,1]
	v_cvt_pk_bf16_f32 v152, v192, v193
	v_pk_mul_f32 v[194:195], v[194:195], v[250:251] op_sel:[0,1] op_sel_hi:[1,1]
	v_cvt_pk_bf16_f32 v153, v194, v195
	v_pk_mul_f32 v[196:197], v[196:197], v[250:251] op_sel:[0,1] op_sel_hi:[1,1]
	v_cvt_pk_bf16_f32 v154, v196, v197
	v_pk_mul_f32 v[198:199], v[198:199], v[250:251] op_sel:[0,1] op_sel_hi:[1,1]
	v_cvt_pk_bf16_f32 v155, v198, v199
	ds_write_b128 v20, v[152:155] offset:0
	v_pk_mul_f32 v[200:201], v[200:201], v[250:251] op_sel:[0,1] op_sel_hi:[1,1]
	v_cvt_pk_bf16_f32 v156, v200, v201
	v_pk_mul_f32 v[202:203], v[202:203], v[250:251] op_sel:[0,1] op_sel_hi:[1,1]
	v_cvt_pk_bf16_f32 v157, v202, v203
	v_pk_mul_f32 v[204:205], v[204:205], v[250:251] op_sel:[0,1] op_sel_hi:[1,1]
	v_cvt_pk_bf16_f32 v158, v204, v205
	v_pk_mul_f32 v[206:207], v[206:207], v[250:251] op_sel:[0,1] op_sel_hi:[1,1]
	v_cvt_pk_bf16_f32 v159, v206, v207
	ds_write_b128 v20, v[156:159] offset:16
	v_pk_mul_f32 v[208:209], v[208:209], v[250:251] op_sel:[0,1] op_sel_hi:[1,1]
	v_cvt_pk_bf16_f32 v160, v208, v209
	v_pk_mul_f32 v[210:211], v[210:211], v[250:251] op_sel:[0,1] op_sel_hi:[1,1]
	v_cvt_pk_bf16_f32 v161, v210, v211
	v_pk_mul_f32 v[72:73], v[72:73], v[252:253] op_sel:[0,0] op_sel_hi:[1,0]
	v_cvt_pk_bf16_f32 v162, v72, v73
	v_pk_mul_f32 v[74:75], v[74:75], v[252:253] op_sel:[0,0] op_sel_hi:[1,0]
	v_cvt_pk_bf16_f32 v163, v74, v75
	ds_write_b128 v20, v[160:163] offset:32
	v_pk_mul_f32 v[76:77], v[76:77], v[252:253] op_sel:[0,0] op_sel_hi:[1,0]
	v_cvt_pk_bf16_f32 v164, v76, v77
	v_pk_mul_f32 v[78:79], v[78:79], v[252:253] op_sel:[0,0] op_sel_hi:[1,0]
	v_cvt_pk_bf16_f32 v165, v78, v79
	v_pk_mul_f32 v[80:81], v[80:81], v[252:253] op_sel:[0,0] op_sel_hi:[1,0]
	v_cvt_pk_bf16_f32 v166, v80, v81
	v_pk_mul_f32 v[82:83], v[82:83], v[252:253] op_sel:[0,0] op_sel_hi:[1,0]
	v_cvt_pk_bf16_f32 v167, v82, v83
	ds_write_b128 v20, v[164:167] offset:48
	v_pk_mul_f32 v[84:85], v[84:85], v[252:253] op_sel:[0,0] op_sel_hi:[1,0]
	v_cvt_pk_bf16_f32 v168, v84, v85
	v_pk_mul_f32 v[86:87], v[86:87], v[252:253] op_sel:[0,0] op_sel_hi:[1,0]
	v_cvt_pk_bf16_f32 v169, v86, v87
	v_pk_mul_f32 v[88:89], v[88:89], v[252:253] op_sel:[0,0] op_sel_hi:[1,0]
	v_cvt_pk_bf16_f32 v170, v88, v89
	v_pk_mul_f32 v[90:91], v[90:91], v[252:253] op_sel:[0,0] op_sel_hi:[1,0]
	v_cvt_pk_bf16_f32 v171, v90, v91
	ds_write_b128 v20, v[168:171] offset:64
	v_pk_mul_f32 v[92:93], v[92:93], v[30:31] op_sel:[0,1] op_sel_hi:[1,1]
	v_cvt_pk_bf16_f32 v172, v92, v93
	v_pk_mul_f32 v[94:95], v[94:95], v[30:31] op_sel:[0,1] op_sel_hi:[1,1]
	v_cvt_pk_bf16_f32 v173, v94, v95
	v_pk_mul_f32 v[96:97], v[96:97], v[30:31] op_sel:[0,1] op_sel_hi:[1,1]
	v_cvt_pk_bf16_f32 v174, v96, v97
	v_pk_mul_f32 v[98:99], v[98:99], v[30:31] op_sel:[0,1] op_sel_hi:[1,1]
	v_cvt_pk_bf16_f32 v175, v98, v99
	v_pk_mul_f32 v[100:101], v[100:101], v[30:31] op_sel:[0,1] op_sel_hi:[1,1]
	v_cvt_pk_bf16_f32 v176, v100, v101
	v_pk_mul_f32 v[102:103], v[102:103], v[30:31] op_sel:[0,1] op_sel_hi:[1,1]
	v_cvt_pk_bf16_f32 v177, v102, v103
	v_mov_b32 v182, 0x3f80
	v_mov_b32 v183, 0
	ds_write_b128 v20, v[172:175] offset:80
	v_pk_mul_f32 v[104:105], v[104:105], v[30:31] op_sel:[0,1] op_sel_hi:[1,1]
	v_cvt_pk_bf16_f32 v178, v104, v105
	v_pk_mul_f32 v[106:107], v[106:107], v[30:31] op_sel:[0,1] op_sel_hi:[1,1]
	v_cvt_pk_bf16_f32 v179, v106, v107
	v_pk_mul_f32 v[108:109], v[108:109], v[30:31] op_sel:[0,1] op_sel_hi:[1,1]
	v_cvt_pk_bf16_f32 v180, v108, v109
	v_pk_mul_f32 v[110:111], v[110:111], v[30:31] op_sel:[0,1] op_sel_hi:[1,1]
	v_cvt_pk_bf16_f32 v181, v110, v111
	ds_write_b128 v20, v[176:179] offset:96
	ds_write_b128 v20, v[180:183] offset:112
	s_waitcnt lgkmcnt(0)
	s_waitcnt vmcnt(11)
	s_barrier
	ds_read_b64_tr_b16 v[196:197], v22 offset:0
	ds_read_b64_tr_b16 v[198:199], v22 offset:2560
	ds_read_b64_tr_b16 v[184:185], v21 offset:0
	ds_read_b64_tr_b16 v[186:187], v21 offset:2560
	ds_read_b64_tr_b16 v[188:189], v21 offset:32
	ds_read_b64_tr_b16 v[190:191], v21 offset:2592
	ds_read_b64_tr_b16 v[192:193], v21 offset:64
	ds_read_b64_tr_b16 v[194:195], v21 offset:2624
	s_add_u32 s89, s31, 0x8000
	s_add_u32 m0, s39, 0x14000
	s_nop 0
	buffer_load_dwordx4 v1, s[8:11], s89 offen offset:0 lds
	ds_read_b64_tr_b16 v[212:213], v22 offset:5120
	ds_read_b64_tr_b16 v[214:215], v22 offset:7680
	ds_read_b64_tr_b16 v[200:201], v21 offset:5120
	ds_read_b64_tr_b16 v[202:203], v21 offset:7680
	ds_read_b64_tr_b16 v[204:205], v21 offset:5152
	ds_read_b64_tr_b16 v[206:207], v21 offset:7712
	ds_read_b64_tr_b16 v[208:209], v21 offset:5184
	ds_read_b64_tr_b16 v[210:211], v21 offset:7744
	s_waitcnt lgkmcnt(12)
	v_mfma_f32_16x16x32_bf16 v[72:75], v[184:187], v[196:199], 0
	s_waitcnt lgkmcnt(10)
	v_mfma_f32_16x16x32_bf16 v[76:79], v[188:191], v[196:199], 0
	s_waitcnt lgkmcnt(8)
	v_mfma_f32_16x16x32_bf16 v[80:83], v[192:195], v[196:199], 0
	buffer_load_dwordx4 v1, s[8:11], s89 offen offset:1024 lds
	ds_read_b64_tr_b16 v[228:229], v22 offset:10240
	ds_read_b64_tr_b16 v[230:231], v22 offset:12800
	ds_read_b64_tr_b16 v[216:217], v21 offset:10240
	ds_read_b64_tr_b16 v[218:219], v21 offset:12800
	ds_read_b64_tr_b16 v[220:221], v21 offset:10272
	ds_read_b64_tr_b16 v[222:223], v21 offset:12832
	ds_read_b64_tr_b16 v[224:225], v21 offset:10304
	ds_read_b64_tr_b16 v[226:227], v21 offset:12864
	s_waitcnt lgkmcnt(12)
	v_mfma_f32_16x16x32_bf16 v[72:75], v[200:203], v[212:215], v[72:75]
	s_waitcnt lgkmcnt(10)
	v_mfma_f32_16x16x32_bf16 v[76:79], v[204:207], v[212:215], v[76:79]
	s_waitcnt lgkmcnt(8)
	v_mfma_f32_16x16x32_bf16 v[80:83], v[208:211], v[212:215], v[80:83]
	buffer_load_dwordx4 v1, s[8:11], s89 offen offset:2048 lds
	ds_read_b64_tr_b16 v[244:245], v22 offset:15360
	ds_read_b64_tr_b16 v[246:247], v22 offset:17920
	ds_read_b64_tr_b16 v[232:233], v21 offset:15360
	ds_read_b64_tr_b16 v[234:235], v21 offset:17920
	ds_read_b64_tr_b16 v[236:237], v21 offset:15392
	ds_read_b64_tr_b16 v[238:239], v21 offset:17952
	ds_read_b64_tr_b16 v[240:241], v21 offset:15424
	ds_read_b64_tr_b16 v[242:243], v21 offset:17984
	s_waitcnt lgkmcnt(12)
	v_mfma_f32_16x16x32_bf16 v[72:75], v[216:219], v[228:231], v[72:75]
	s_waitcnt lgkmcnt(10)
	v_mfma_f32_16x16x32_bf16 v[76:79], v[220:223], v[228:231], v[76:79]
	s_waitcnt lgkmcnt(8)
	v_mfma_f32_16x16x32_bf16 v[80:83], v[224:227], v[228:231], v[80:83]
	buffer_load_dwordx4 v1, s[8:11], s89 offen offset:3072 lds
	s_waitcnt lgkmcnt(4)
	v_mfma_f32_16x16x32_bf16 v[72:75], v[232:235], v[244:247], v[72:75]
	s_waitcnt lgkmcnt(2)
	v_mfma_f32_16x16x32_bf16 v[76:79], v[236:239], v[244:247], v[76:79]
	s_waitcnt lgkmcnt(0)
	v_mfma_f32_16x16x32_bf16 v[80:83], v[240:243], v[244:247], v[80:83]
	ds_read_b128 v[56:59], v2 offset:57344
	ds_read_b128 v[60:63], v2 offset:58368
	ds_read_b128 v[64:67], v2 offset:59392
	s_nop 0
	v_cvt_pk_bf16_f32 v88, v72, v73
	v_cvt_pk_bf16_f32 v89, v74, v75
	v_cvt_pk_bf16_f32 v90, v76, v77
	v_cvt_pk_bf16_f32 v91, v78, v79
	v_cvt_pk_bf16_f32 v92, v80, v81
	v_cvt_pk_bf16_f32 v93, v82, v83
	v_min_u32 v88, 0xfffffffe, v88
	v_min_u32 v89, 0xfffffffe, v89
	v_min_u32 v90, 0xfffffffe, v90
	v_min_u32 v91, 0xfffffffe, v91
	v_min_u32 v92, 0xfffffffe, v92
	v_min_u32 v93, 0xfffffffe, v93
	s_add_u32 s28, s36, 0x2540000
	buffer_store_dwordx4 v[88:91], v17, s[8:11], s28 offen sc1
	buffer_store_dwordx2 v[92:93], v18, s[8:11], s28 offen sc1
	ds_read_b128 v[68:71], v2 offset:60416
	s_waitcnt lgkmcnt(3)
	v_mfma_f32_32x32x16_bf16 v[120:135], v[56:59], a[0:3], v[120:135]
	ds_read_b128 v[56:59], v2 offset:61440
	s_waitcnt lgkmcnt(3)
	v_mfma_f32_32x32x16_bf16 v[120:135], v[60:63], a[4:7], v[120:135]
	s_add_u32 s94, s32, 0
	buffer_load_dwordx4 a[0:3], v1, s[8:11], s94 offen offset:0
	ds_read_b128 v[60:63], v2 offset:62464
	s_waitcnt lgkmcnt(3)
	v_mfma_f32_32x32x16_bf16 v[120:135], v[64:67], a[8:11], v[120:135]
	buffer_load_dwordx4 a[4:7], v1, s[8:11], s94 offen offset:1024
	ds_read_b128 v[64:67], v2 offset:63488
	s_waitcnt lgkmcnt(3)
	v_mfma_f32_32x32x16_bf16 v[120:135], v[68:71], a[12:15], v[120:135]
	buffer_load_dwordx4 a[8:11], v1, s[8:11], s94 offen offset:2048
	ds_read_b128 v[68:71], v2 offset:64512
	s_waitcnt lgkmcnt(3)
	v_mfma_f32_32x32x16_bf16 v[120:135], v[56:59], a[16:19], v[120:135]
	ds_read_b128 v[56:59], v3 offset:0
	s_waitcnt lgkmcnt(3)
	v_mfma_f32_32x32x16_bf16 v[120:135], v[60:63], a[20:23], v[120:135]
	ds_read_b128 v[60:63], v3 offset:1024
	s_waitcnt lgkmcnt(3)
	v_mfma_f32_32x32x16_bf16 v[120:135], v[64:67], a[24:27], v[120:135]
	ds_read_b128 v[64:67], v3 offset:2048
	s_waitcnt lgkmcnt(3)
	v_mfma_f32_32x32x16_bf16 v[120:135], v[68:71], a[28:31], v[120:135]
	ds_read_b128 v[68:71], v3 offset:3072
	s_waitcnt lgkmcnt(3)
	v_mfma_f32_32x32x16_bf16 v[120:135], v[56:59], a[32:35], v[120:135]
	ds_read_b128 v[56:59], v3 offset:4096
	s_waitcnt lgkmcnt(3)
	v_mfma_f32_32x32x16_bf16 v[120:135], v[60:63], a[36:39], v[120:135]
	buffer_load_dwordx4 a[12:15], v1, s[8:11], s94 offen offset:3072
	ds_read_b128 v[60:63], v3 offset:5120
	s_waitcnt lgkmcnt(3)
	v_mfma_f32_32x32x16_bf16 v[120:135], v[64:67], a[40:43], v[120:135]
	ds_read_b128 v[64:67], v3 offset:6144
	s_waitcnt lgkmcnt(3)
	v_mfma_f32_32x32x16_bf16 v[120:135], v[68:71], a[44:47], v[120:135]
	ds_read_b128 v[68:71], v3 offset:7168
	s_waitcnt lgkmcnt(3)
	v_mfma_f32_32x32x16_bf16 v[120:135], v[56:59], a[48:51], v[120:135]
	ds_read_b128 v[56:59], v3 offset:8192
	s_waitcnt lgkmcnt(3)
	v_mfma_f32_32x32x16_bf16 v[120:135], v[60:63], a[52:55], v[120:135]
	ds_read_b128 v[60:63], v3 offset:9216
	s_waitcnt lgkmcnt(3)
	v_mfma_f32_32x32x16_bf16 v[120:135], v[64:67], a[56:59], v[120:135]
	s_add_u32 s94, s32, 0x1000
	buffer_load_dwordx4 a[16:19], v1, s[8:11], s94 offen offset:0
	ds_read_b128 v[64:67], v3 offset:10240
	s_waitcnt lgkmcnt(3)
	v_mfma_f32_32x32x16_bf16 v[120:135], v[68:71], a[60:63], v[120:135]
	ds_read_b128 v[68:71], v3 offset:11264
	s_waitcnt lgkmcnt(3)
	v_mfma_f32_32x32x16_bf16 v[120:135], v[56:59], a[64:67], v[120:135]
	ds_read_b128 v[56:59], v3 offset:12288
	s_waitcnt lgkmcnt(3)
	v_mfma_f32_32x32x16_bf16 v[120:135], v[60:63], a[68:71], v[120:135]
	ds_read_b128 v[60:63], v3 offset:13312
	s_waitcnt lgkmcnt(3)
	v_mfma_f32_32x32x16_bf16 v[120:135], v[64:67], a[72:75], v[120:135]
	buffer_load_dwordx4 a[20:23], v1, s[8:11], s94 offen offset:1024
	ds_read_b128 v[64:67], v3 offset:14336
	s_waitcnt lgkmcnt(3)
	v_mfma_f32_32x32x16_bf16 v[120:135], v[68:71], a[76:79], v[120:135]
	ds_read_b128 v[68:71], v3 offset:15360
	s_waitcnt lgkmcnt(3)
	v_mfma_f32_32x32x16_bf16 v[120:135], v[56:59], a[80:83], v[120:135]
	ds_read_b128 v[56:59], v3 offset:16384
	s_waitcnt lgkmcnt(3)
	v_mfma_f32_32x32x16_bf16 v[120:135], v[60:63], a[84:87], v[120:135]
	ds_read_b128 v[60:63], v3 offset:17408
	s_waitcnt lgkmcnt(3)
	v_mfma_f32_32x32x16_bf16 v[120:135], v[64:67], a[88:91], v[120:135]
	buffer_load_dwordx4 a[24:27], v1, s[8:11], s94 offen offset:2048
	ds_read_b128 v[64:67], v3 offset:18432
	s_waitcnt lgkmcnt(3)
	v_mfma_f32_32x32x16_bf16 v[120:135], v[68:71], a[92:95], v[120:135]
	buffer_load_dwordx4 a[28:31], v1, s[8:11], s94 offen offset:3072
	ds_read_b128 v[68:71], v3 offset:19456
	s_waitcnt lgkmcnt(3)
	v_mfma_f32_32x32x16_bf16 v[120:135], v[56:59], a[96:99], v[120:135]
	ds_read_b128 v[56:59], v3 offset:20480
	s_waitcnt lgkmcnt(3)
	v_mfma_f32_32x32x16_bf16 v[120:135], v[60:63], a[100:103], v[120:135]
	ds_read_b128 v[60:63], v3 offset:21504
	s_waitcnt lgkmcnt(3)
	v_mfma_f32_32x32x16_bf16 v[120:135], v[64:67], a[104:107], v[120:135]
	s_add_u32 s88, s37, 0x2540000
	buffer_load_dwordx4 v[184:187], v19, s[8:11], s88 offen sc1
	ds_read_b128 v[64:67], v3 offset:22528
	s_waitcnt lgkmcnt(3)
	v_mfma_f32_32x32x16_bf16 v[120:135], v[68:71], a[108:111], v[120:135]
	ds_read_b128 v[68:71], v3 offset:23552
	s_waitcnt lgkmcnt(3)
	v_mfma_f32_32x32x16_bf16 v[120:135], v[56:59], a[112:115], v[120:135]
	s_add_u32 s88, s37, 0x2540d80
	buffer_load_dwordx4 v[188:191], v19, s[8:11], s88 offen sc1
	ds_read_b128 v[56:59], v3 offset:24576
	s_waitcnt lgkmcnt(3)
	v_mfma_f32_32x32x16_bf16 v[120:135], v[60:63], a[116:119], v[120:135]
	ds_read_b128 v[60:63], v3 offset:25600
	s_waitcnt lgkmcnt(3)
	v_mfma_f32_32x32x16_bf16 v[120:135], v[64:67], a[120:123], v[120:135]
	s_add_u32 s88, s37, 0x2541b00
	buffer_load_dwordx4 v[192:195], v19, s[8:11], s88 offen sc1
	ds_read_b128 v[64:67], v3 offset:26624
	s_waitcnt lgkmcnt(3)
	v_mfma_f32_32x32x16_bf16 v[120:135], v[68:71], a[124:127], v[120:135]
	ds_read_b128 v[68:71], v3 offset:27648
	s_waitcnt lgkmcnt(3)
	v_mfma_f32_32x32x16_bf16 v[120:135], v[56:59], a[128:131], v[120:135]
	s_add_u32 s88, s37, 0x2542880
	buffer_load_dwordx4 v[196:199], v19, s[8:11], s88 offen sc1
	ds_read_b128 v[56:59], v3 offset:28672
	s_waitcnt lgkmcnt(3)
	v_mfma_f32_32x32x16_bf16 v[120:135], v[60:63], a[132:135], v[120:135]
	ds_read_b128 v[60:63], v3 offset:29696
	s_waitcnt lgkmcnt(3)
	v_mfma_f32_32x32x16_bf16 v[120:135], v[64:67], a[136:139], v[120:135]
	ds_read_b128 v[64:67], v3 offset:30720
	s_waitcnt lgkmcnt(3)
	v_mfma_f32_32x32x16_bf16 v[120:135], v[68:71], a[140:143], v[120:135]
	ds_read_b128 v[68:71], v3 offset:31744
	s_waitcnt lgkmcnt(3)
	v_mfma_f32_32x32x16_bf16 v[120:135], v[56:59], a[144:147], v[120:135]
	s_waitcnt lgkmcnt(2)
	v_mfma_f32_32x32x16_bf16 v[120:135], v[60:63], a[148:151], v[120:135]
	s_add_u32 s88, s37, 0x2543600
	buffer_load_dwordx4 v[200:203], v19, s[8:11], s88 offen sc1
	s_waitcnt lgkmcnt(1)
	v_mfma_f32_32x32x16_bf16 v[120:135], v[64:67], a[152:155], v[120:135]
	s_waitcnt lgkmcnt(0)
	v_mfma_f32_32x32x16_bf16 v[120:135], v[68:71], a[156:159], v[120:135]
	v_max3_f32 v249, v112, v113, v114
	v_min3_f32 v250, v112, v113, v114
	v_max3_f32 v249, v249, v115, v116
	v_min3_f32 v250, v250, v115, v116
	v_max3_f32 v249, v249, v117, v118
	v_min3_f32 v250, v250, v117, v118
	s_nop 5
	v_max3_f32 v249, v249, v119, v120
	v_min3_f32 v250, v250, v119, v120
	v_max3_f32 v249, v249, v121, v122
	v_min3_f32 v250, v250, v121, v122
	s_add_u32 s88, s37, 0x2544380
	buffer_load_dwordx4 v[204:207], v19, s[8:11], s88 offen sc1
	v_max3_f32 v249, v249, v123, v124
	v_min3_f32 v250, v250, v123, v124
	v_max3_f32 v249, v249, v125, v126
	v_min3_f32 v250, v250, v125, v126
	v_max3_f32 v249, v249, v127, v128
	v_min3_f32 v250, v250, v127, v128
	v_max3_f32 v249, v249, v129, v130
	v_min3_f32 v250, v250, v129, v130
	v_max_f32 v249, v249, v131
	v_min_f32 v250, v250, v131
	v_mul_f32 v249, v248, v249
	v_mul_f32 v250, v248, v250
	v_pk_fma_f32 v[88:89], v[112:113], v[248:249], v[248:249] op_sel:[0,0,1] op_sel_hi:[1,0,1] neg_lo:[0,0,1] neg_hi:[0,0,1]
	v_pk_fma_f32 v[112:113], v[112:113], v[248:249], v[250:251] op_sel:[0,0,0] op_sel_hi:[1,0,0] neg_lo:[1,0,0] neg_hi:[1,0,0]
	v_pk_fma_f32 v[90:91], v[114:115], v[248:249], v[248:249] op_sel:[0,0,1] op_sel_hi:[1,0,1] neg_lo:[0,0,1] neg_hi:[0,0,1]
	v_pk_fma_f32 v[114:115], v[114:115], v[248:249], v[250:251] op_sel:[0,0,0] op_sel_hi:[1,0,0] neg_lo:[1,0,0] neg_hi:[1,0,0]
	v_exp_f32 v88, v88
	v_exp_f32 v89, v89
	v_exp_f32 v112, v112
	v_exp_f32 v113, v113
	s_add_u32 s88, s37, 0x2545100
	buffer_load_dwordx4 v[208:211], v19, s[8:11], s88 offen sc1
	v_pk_fma_f32 v[92:93], v[116:117], v[248:249], v[248:249] op_sel:[0,0,1] op_sel_hi:[1,0,1] neg_lo:[0,0,1] neg_hi:[0,0,1]
	v_pk_fma_f32 v[116:117], v[116:117], v[248:249], v[250:251] op_sel:[0,0,0] op_sel_hi:[1,0,0] neg_lo:[1,0,0] neg_hi:[1,0,0]
	v_exp_f32 v90, v90
	v_exp_f32 v91, v91
	v_exp_f32 v114, v114
	s_add_u32 s88, s37, 0x2545e80
	buffer_load_dwordx4 v[212:215], v19, s[8:11], s88 offen sc1
	v_exp_f32 v115, v115
	v_pk_fma_f32 v[94:95], v[118:119], v[248:249], v[248:249] op_sel:[0,0,1] op_sel_hi:[1,0,1] neg_lo:[0,0,1] neg_hi:[0,0,1]
	v_pk_fma_f32 v[118:119], v[118:119], v[248:249], v[250:251] op_sel:[0,0,0] op_sel_hi:[1,0,0] neg_lo:[1,0,0] neg_hi:[1,0,0]
	v_exp_f32 v92, v92
	v_exp_f32 v93, v93
	v_exp_f32 v116, v116
	v_exp_f32 v117, v117
	v_pk_add_f32 v[252:253], v[88:89], v[90:91]
	v_pk_add_f32 v[254:255], v[112:113], v[114:115]
	v_pk_fma_f32 v[96:97], v[120:121], v[248:249], v[248:249] op_sel:[0,0,1] op_sel_hi:[1,0,1] neg_lo:[0,0,1] neg_hi:[0,0,1]
	v_pk_fma_f32 v[120:121], v[120:121], v[248:249], v[250:251] op_sel:[0,0,0] op_sel_hi:[1,0,0] neg_lo:[1,0,0] neg_hi:[1,0,0]
	v_exp_f32 v94, v94
	v_exp_f32 v95, v95
	v_exp_f32 v118, v118
	v_exp_f32 v119, v119
	v_pk_add_f32 v[252:253], v[252:253], v[92:93]
	v_pk_add_f32 v[254:255], v[254:255], v[116:117]
	v_pk_fma_f32 v[98:99], v[122:123], v[248:249], v[248:249] op_sel:[0,0,1] op_sel_hi:[1,0,1] neg_lo:[0,0,1] neg_hi:[0,0,1]
	v_pk_fma_f32 v[122:123], v[122:123], v[248:249], v[250:251] op_sel:[0,0,0] op_sel_hi:[1,0,0] neg_lo:[1,0,0] neg_hi:[1,0,0]
	v_exp_f32 v96, v96
	v_exp_f32 v97, v97
	v_exp_f32 v120, v120
	v_exp_f32 v121, v121
	v_pk_add_f32 v[252:253], v[252:253], v[94:95]
	v_pk_add_f32 v[254:255], v[254:255], v[118:119]
	v_pk_fma_f32 v[100:101], v[124:125], v[248:249], v[248:249] op_sel:[0,0,1] op_sel_hi:[1,0,1] neg_lo:[0,0,1] neg_hi:[0,0,1]
	v_pk_fma_f32 v[124:125], v[124:125], v[248:249], v[250:251] op_sel:[0,0,0] op_sel_hi:[1,0,0] neg_lo:[1,0,0] neg_hi:[1,0,0]
	v_exp_f32 v98, v98
	v_exp_f32 v99, v99
	v_exp_f32 v122, v122
	v_exp_f32 v123, v123
	v_pk_add_f32 v[252:253], v[252:253], v[96:97]
	v_pk_add_f32 v[254:255], v[254:255], v[120:121]
	v_pk_fma_f32 v[102:103], v[126:127], v[248:249], v[248:249] op_sel:[0,0,1] op_sel_hi:[1,0,1] neg_lo:[0,0,1] neg_hi:[0,0,1]
	v_pk_fma_f32 v[126:127], v[126:127], v[248:249], v[250:251] op_sel:[0,0,0] op_sel_hi:[1,0,0] neg_lo:[1,0,0] neg_hi:[1,0,0]
	v_exp_f32 v100, v100
	v_exp_f32 v101, v101
	v_exp_f32 v124, v124
	v_exp_f32 v125, v125
	v_pk_add_f32 v[252:253], v[252:253], v[98:99]
	v_pk_add_f32 v[254:255], v[254:255], v[122:123]
	v_pk_fma_f32 v[72:73], v[128:129], v[248:249], v[248:249] op_sel:[0,0,1] op_sel_hi:[1,0,1] neg_lo:[0,0,1] neg_hi:[0,0,1]
	v_pk_fma_f32 v[128:129], v[128:129], v[248:249], v[250:251] op_sel:[0,0,0] op_sel_hi:[1,0,0] neg_lo:[1,0,0] neg_hi:[1,0,0]
	v_exp_f32 v102, v102
	v_exp_f32 v103, v103
	v_exp_f32 v126, v126
	v_exp_f32 v127, v127
	v_pk_add_f32 v[252:253], v[252:253], v[100:101]
	v_pk_add_f32 v[254:255], v[254:255], v[124:125]
	v_pk_fma_f32 v[74:75], v[130:131], v[248:249], v[248:249] op_sel:[0,0,1] op_sel_hi:[1,0,1] neg_lo:[0,0,1] neg_hi:[0,0,1]
	v_pk_fma_f32 v[130:131], v[130:131], v[248:249], v[250:251] op_sel:[0,0,0] op_sel_hi:[1,0,0] neg_lo:[1,0,0] neg_hi:[1,0,0]
	v_exp_f32 v72, v72
	v_exp_f32 v73, v73
	v_exp_f32 v128, v128
	v_exp_f32 v129, v129
	v_pk_add_f32 v[252:253], v[252:253], v[102:103]
	v_pk_add_f32 v[254:255], v[254:255], v[126:127]
	v_exp_f32 v74, v74
	v_exp_f32 v75, v75
	v_exp_f32 v130, v130
	v_exp_f32 v131, v131
	v_pk_add_f32 v[252:253], v[252:253], v[72:73]
	v_pk_add_f32 v[254:255], v[254:255], v[128:129]
	v_pk_add_f32 v[252:253], v[252:253], v[74:75]
	v_pk_add_f32 v[254:255], v[254:255], v[130:131]
	v_add_f32 v252, v252, v253
	v_add_f32 v254, v254, v255
	v_rcp_f32 v252, v252
	v_rcp_f32 v254, v254
	v_pk_mul_f32 v[88:89], v[88:89], v[252:253] op_sel:[0,0] op_sel_hi:[1,0]
	v_pk_mul_f32 v[90:91], v[90:91], v[252:253] op_sel:[0,0] op_sel_hi:[1,0]
	v_cvt_pk_bf16_f32 v152, v88, v89
	v_cvt_pk_bf16_f32 v153, v90, v91
	v_pk_mul_f32 v[92:93], v[92:93], v[252:253] op_sel:[0,0] op_sel_hi:[1,0]
	v_pk_mul_f32 v[94:95], v[94:95], v[252:253] op_sel:[0,0] op_sel_hi:[1,0]
	v_cvt_pk_bf16_f32 v156, v92, v93
	v_cvt_pk_bf16_f32 v157, v94, v95
	v_pk_mul_f32 v[96:97], v[96:97], v[252:253] op_sel:[0,0] op_sel_hi:[1,0]
	v_pk_mul_f32 v[98:99], v[98:99], v[252:253] op_sel:[0,0] op_sel_hi:[1,0]
	v_cvt_pk_bf16_f32 v160, v96, v97
	v_cvt_pk_bf16_f32 v161, v98, v99
	v_pk_mul_f32 v[100:101], v[100:101], v[252:253] op_sel:[0,0] op_sel_hi:[1,0]
	v_pk_mul_f32 v[102:103], v[102:103], v[252:253] op_sel:[0,0] op_sel_hi:[1,0]
	v_cvt_pk_bf16_f32 v164, v100, v101
	v_cvt_pk_bf16_f32 v165, v102, v103
	v_pk_mul_f32 v[72:73], v[72:73], v[252:253] op_sel:[0,0] op_sel_hi:[1,0]
	v_pk_mul_f32 v[74:75], v[74:75], v[252:253] op_sel:[0,0] op_sel_hi:[1,0]
	v_cvt_pk_bf16_f32 v154, v72, v73
	v_cvt_pk_bf16_f32 v155, v74, v75
	v_pk_mul_f32 v[112:113], v[112:113], v[254:255] op_sel:[0,0] op_sel_hi:[1,0]
	v_pk_mul_f32 v[114:115], v[114:115], v[254:255] op_sel:[0,0] op_sel_hi:[1,0]
	v_cvt_pk_bf16_f32 v158, v112, v113
	v_cvt_pk_bf16_f32 v159, v114, v115
	v_pk_mul_f32 v[116:117], v[116:117], v[254:255] op_sel:[0,0] op_sel_hi:[1,0]
	v_pk_mul_f32 v[118:119], v[118:119], v[254:255] op_sel:[0,0] op_sel_hi:[1,0]
	v_cvt_pk_bf16_f32 v162, v116, v117
	v_cvt_pk_bf16_f32 v163, v118, v119
	v_pk_mul_f32 v[120:121], v[120:121], v[254:255] op_sel:[0,0] op_sel_hi:[1,0]
	v_pk_mul_f32 v[122:123], v[122:123], v[254:255] op_sel:[0,0] op_sel_hi:[1,0]
	v_cvt_pk_bf16_f32 v166, v120, v121
	v_cvt_pk_bf16_f32 v167, v122, v123
	v_pk_mul_f32 v[124:125], v[124:125], v[254:255] op_sel:[0,0] op_sel_hi:[1,0]
	v_pk_mul_f32 v[126:127], v[126:127], v[254:255] op_sel:[0,0] op_sel_hi:[1,0]
	v_cvt_pk_bf16_f32 v168, v124, v125
	v_cvt_pk_bf16_f32 v169, v126, v127
	v_pk_mul_f32 v[128:129], v[128:129], v[254:255] op_sel:[0,0] op_sel_hi:[1,0]
	v_pk_mul_f32 v[130:131], v[130:131], v[254:255] op_sel:[0,0] op_sel_hi:[1,0]
	v_cvt_pk_bf16_f32 v170, v128, v129
	v_cvt_pk_bf16_f32 v171, v130, v131
	s_add_u32 s88, s37, 0x2546c00
	buffer_load_dwordx4 v[216:219], v19, s[8:11], s88 offen sc1
	s_add_u32 s88, s37, 0x2547980
	buffer_load_dwordx4 v[220:223], v19, s[8:11], s88 offen sc1
	s_add_u32 s88, s37, 0x2548700
	buffer_load_dwordx4 v[224:227], v19, s[8:11], s88 offen sc1
	s_add_u32 s88, s37, 0x2549480
	buffer_load_dwordx4 v[228:231], v19, s[8:11], s88 offen sc1
	s_add_u32 s88, s37, 0x254a200
	buffer_load_dwordx4 v[232:235], v19, s[8:11], s88 offen sc1
	s_add_u32 s88, s37, 0x254af80
	buffer_load_dwordx4 v[236:239], v19, s[8:11], s88 offen sc1
	s_add_u32 s88, s37, 0x254bd00
	buffer_load_dwordx4 v[240:243], v19, s[8:11], s88 offen sc1
	s_add_u32 s88, s37, 0x254ca80
	buffer_load_dwordx4 v[244:247], v19, s[8:11], s88 offen sc1
	s_mov_b32 s47, 0
kvre_59:
	s_waitcnt vmcnt(15)
	v_mfma_f32_32x32x16_bf16 v[136:151], v[32:35], v[184:187], 0
	v_max_u32 v253, v184, v185
	v_max3_u32 v253, v253, v186, v187
	s_waitcnt vmcnt(14)
	v_mfma_f32_32x32x16_bf16 v[136:151], v[32:35], v[188:191], v[136:151]
	v_max3_u32 v253, v253, v188, v189
	v_max3_u32 v253, v253, v190, v191
	s_waitcnt vmcnt(13)
	v_mfma_f32_32x32x16_bf16 v[136:151], v[32:35], v[192:195], v[136:151]
	v_max3_u32 v253, v253, v192, v193
	v_max3_u32 v253, v253, v194, v195
	s_waitcnt vmcnt(12)
	v_mfma_f32_32x32x16_bf16 v[136:151], v[32:35], v[196:199], v[136:151]
	v_max3_u32 v253, v253, v196, v197
	v_max3_u32 v253, v253, v198, v199
	s_waitcnt vmcnt(11)
	v_mfma_f32_32x32x16_bf16 v[136:151], v[32:35], v[200:203], v[136:151]
	v_max3_u32 v253, v253, v200, v201
	v_max3_u32 v253, v253, v202, v203
	s_waitcnt vmcnt(10)
	v_mfma_f32_32x32x16_bf16 v[136:151], v[32:35], v[204:207], v[136:151]
	v_max3_u32 v253, v253, v204, v205
	v_max3_u32 v253, v253, v206, v207
	s_waitcnt vmcnt(9)
	v_mfma_f32_32x32x16_bf16 v[136:151], v[32:35], v[208:211], v[136:151]
	v_max3_u32 v253, v253, v208, v209
	v_max3_u32 v253, v253, v210, v211
	s_waitcnt vmcnt(8)
	v_mfma_f32_32x32x16_bf16 v[136:151], v[32:35], v[212:215], v[136:151]
	v_max3_u32 v253, v253, v212, v213
	v_max3_u32 v253, v253, v214, v215
	s_waitcnt vmcnt(7)
	v_mfma_f32_32x32x16_bf16 v[136:151], v[32:35], v[216:219], v[136:151]
	s_add_u32 s94, s32, 0x2000
	buffer_load_dwordx4 a[32:35], v1, s[8:11], s94 offen offset:0
	v_max3_u32 v253, v253, v216, v217
	v_max3_u32 v253, v253, v218, v219
	s_waitcnt vmcnt(7)
	v_mfma_f32_32x32x16_bf16 v[136:151], v[32:35], v[220:223], v[136:151]
	buffer_load_dwordx4 a[36:39], v1, s[8:11], s94 offen offset:1024
	v_max3_u32 v253, v253, v220, v221
	v_max3_u32 v253, v253, v222, v223
	s_waitcnt vmcnt(7)
	v_mfma_f32_32x32x16_bf16 v[136:151], v[32:35], v[224:227], v[136:151]
	buffer_load_dwordx4 a[40:43], v1, s[8:11], s94 offen offset:2048
	v_max3_u32 v253, v253, v224, v225
	v_max3_u32 v253, v253, v226, v227
	s_waitcnt vmcnt(7)
	v_mfma_f32_32x32x16_bf16 v[136:151], v[32:35], v[228:231], v[136:151]
	buffer_load_dwordx4 a[44:47], v1, s[8:11], s94 offen offset:3072
	v_max3_u32 v253, v253, v228, v229
	v_max3_u32 v253, v253, v230, v231
	s_waitcnt vmcnt(7)
	v_mfma_f32_32x32x16_bf16 v[136:151], v[32:35], v[232:235], v[136:151]
	s_add_u32 s94, s32, 0x3000
	buffer_load_dwordx4 a[48:51], v1, s[8:11], s94 offen offset:0
	v_max3_u32 v253, v253, v232, v233
	v_max3_u32 v253, v253, v234, v235
	s_waitcnt vmcnt(7)
	v_mfma_f32_32x32x16_bf16 v[136:151], v[32:35], v[236:239], v[136:151]
	buffer_load_dwordx4 a[52:55], v1, s[8:11], s94 offen offset:1024
	v_max3_u32 v253, v253, v236, v237
	v_max3_u32 v253, v253, v238, v239
	s_waitcnt vmcnt(7)
	v_mfma_f32_32x32x16_bf16 v[136:151], v[32:35], v[240:243], v[136:151]
	buffer_load_dwordx4 a[56:59], v1, s[8:11], s94 offen offset:2048
	v_max3_u32 v253, v253, v240, v241
	v_max3_u32 v253, v253, v242, v243
	s_waitcnt vmcnt(7)
	v_mfma_f32_32x32x16_bf16 v[136:151], v[32:35], v[244:247], v[136:151]
	buffer_load_dwordx4 a[60:63], v1, s[8:11], s94 offen offset:3072
	v_max3_u32 v253, v253, v244, v245
	v_max3_u32 v253, v253, v246, v247
	v_cmp_eq_u32 vcc, -1, v253
	s_cbranch_vccnz kvretry_60
kvok_61:
	s_nop 6
	v_cvt_pk_bf16_f32 v248, v136, v137
	v_cvt_pk_bf16_f32 v249, v138, v139
	v_cvt_pk_bf16_f32 v250, v140, v141
	v_cvt_pk_bf16_f32 v251, v142, v143
	ds_write_b128 v23, v[248:251]
	s_add_u32 s94, s32, 0x4000
	buffer_load_dwordx4 a[64:67], v1, s[8:11], s94 offen offset:0
	s_waitcnt lgkmcnt(0)
	s_barrier
	ds_read_b128 v[204:207], v25 offset:0
	ds_read_b128 v[208:211], v25 offset:16
	ds_read_b128 v[212:215], v25 offset:32
	ds_read_b128 v[216:219], v25 offset:48
	ds_read_b128 v[220:223], v25 offset:64
	ds_read_b128 v[184:187], v24 offset:0
	ds_read_b128 v[188:191], v24 offset:16
	ds_read_b128 v[192:195], v24 offset:32
	ds_read_b128 v[196:199], v24 offset:48
	ds_read_b128 v[200:203], v24 offset:64
	s_waitcnt lgkmcnt(9)
	v_mfma_f32_32x32x16_bf16 v[88:103], v[204:207], v[152:155], 0
	buffer_load_dwordx4 a[68:71], v1, s[8:11], s94 offen offset:1024
	s_waitcnt lgkmcnt(8)
	v_mfma_f32_32x32x16_bf16 v[88:103], v[208:211], v[156:159], v[88:103]
	buffer_load_dwordx4 a[72:75], v1, s[8:11], s94 offen offset:2048
	s_waitcnt lgkmcnt(7)
	v_mfma_f32_32x32x16_bf16 v[88:103], v[212:215], v[160:163], v[88:103]
	buffer_load_dwordx4 a[76:79], v1, s[8:11], s94 offen offset:3072
	s_waitcnt lgkmcnt(6)
	v_mfma_f32_32x32x16_bf16 v[88:103], v[216:219], v[164:167], v[88:103]
	s_add_u32 s94, s32, 0x5000
	buffer_load_dwordx4 a[80:83], v1, s[8:11], s94 offen offset:0
	s_waitcnt lgkmcnt(5)
	v_mfma_f32_32x32x16_bf16 v[88:103], v[220:223], v[168:171], v[88:103]
	s_waitcnt lgkmcnt(4)
	v_mfma_f32_32x32x16_bf16 v[72:87], v[184:187], v[152:155], 0
	s_waitcnt lgkmcnt(3)
	v_mfma_f32_32x32x16_bf16 v[72:87], v[188:191], v[156:159], v[72:87]
	s_waitcnt lgkmcnt(2)
	v_mfma_f32_32x32x16_bf16 v[72:87], v[192:195], v[160:163], v[72:87]
	buffer_load_dwordx4 a[84:87], v1, s[8:11], s94 offen offset:1024
	s_waitcnt lgkmcnt(1)
	v_mfma_f32_32x32x16_bf16 v[72:87], v[196:199], v[164:167], v[72:87]
	s_waitcnt lgkmcnt(0)
	v_mfma_f32_32x32x16_bf16 v[72:87], v[200:203], v[168:171], v[72:87]
	s_nop 0
	v_add_f32 v249, 0x358637bd, v92
	v_rcp_f32 v249, v249
	s_add_u32 s28, s42, 0x17e8000
	v_pk_mul_f32 v[88:89], v[88:89], v[248:249] op_sel:[0,1] op_sel_hi:[1,1]
	v_cvt_pk_bf16_f32 v144, v88, v89
	v_pk_mul_f32 v[90:91], v[90:91], v[248:249] op_sel:[0,1] op_sel_hi:[1,1]
	v_cvt_pk_bf16_f32 v145, v90, v91
	buffer_store_dwordx2 v[144:145], v10, s[8:11], s28 offen
	s_nop 2
	v_pk_mul_f32 v[72:73], v[72:73], v[248:249] op_sel:[0,1] op_sel_hi:[1,1]
	v_cvt_pk_bf16_f32 v136, v72, v73
	v_pk_mul_f32 v[74:75], v[74:75], v[248:249] op_sel:[0,1] op_sel_hi:[1,1]
	v_cvt_pk_bf16_f32 v137, v74, v75
	v_pk_mul_f32 v[76:77], v[76:77], v[248:249] op_sel:[0,1] op_sel_hi:[1,1]
	v_cvt_pk_bf16_f32 v138, v76, v77
	v_pk_mul_f32 v[78:79], v[78:79], v[248:249] op_sel:[0,1] op_sel_hi:[1,1]
	v_cvt_pk_bf16_f32 v139, v78, v79
	buffer_store_dwordx4 v[136:139], v8, s[8:11], s28 offen
	v_pk_mul_f32 v[80:81], v[80:81], v[248:249] op_sel:[0,1] op_sel_hi:[1,1]
	v_cvt_pk_bf16_f32 v140, v80, v81
	v_pk_mul_f32 v[82:83], v[82:83], v[248:249] op_sel:[0,1] op_sel_hi:[1,1]
	v_cvt_pk_bf16_f32 v141, v82, v83
	v_pk_mul_f32 v[84:85], v[84:85], v[248:249] op_sel:[0,1] op_sel_hi:[1,1]
	v_cvt_pk_bf16_f32 v142, v84, v85
	v_pk_mul_f32 v[86:87], v[86:87], v[248:249] op_sel:[0,1] op_sel_hi:[1,1]
	v_cvt_pk_bf16_f32 v143, v86, v87
	buffer_store_dwordx4 v[140:143], v9, s[8:11], s28 offen
	buffer_load_dwordx4 a[88:91], v1, s[8:11], s94 offen offset:2048
	buffer_load_dwordx4 a[92:95], v1, s[8:11], s94 offen offset:3072
	s_add_u32 s94, s32, 0x6000
	buffer_load_dwordx4 a[96:99], v1, s[8:11], s94 offen offset:0
	s_add_u32 s93, s40, 0x8e8000
	buffer_load_dword v0, v4, s[8:11], s93 offen offset:0 sc1
	s_add_u32 s93, s40, 0x8e8000
	buffer_load_dword v0, v4, s[8:11], s93 offen offset:2048 sc1
	s_add_u32 s93, s40, 0x8e8000
	buffer_load_dword v0, v5, s[8:11], s93 offen offset:0 sc1
	s_add_u32 s93, s41, 0x23e8000
	buffer_load_dword v0, v6, s[8:11], s93 offen offset:0 sc1
	v_mov_b32 v254, 1
	s_add_u32 s29, s44, 0x261c000
	s_waitcnt vmcnt(7)
	s_cmp_eq_u32 s25, 0
	s_cbranch_scc1 slow_62
	buffer_store_dword v254, v16, s[8:11], s29 offen
back_63:
	s_add_u32 s93, s38, 0x261c000
	buffer_load_dword v0, v14, s[8:11], s93 offen offset:0 sc1
	s_add_u32 s89, s31, 0xc000
	s_add_u32 m0, s39, 0
	s_nop 0
	buffer_load_dwordx4 v1, s[8:11], s89 offen offset:0 lds
	buffer_load_dwordx4 v1, s[8:11], s89 offen offset:1024 lds
	s_add_u32 s94, s33, 0
	buffer_load_dwordx4 v[152:155], v1, s[8:11], s94 offen offset:0
	s_add_u32 s29, s38, 0x261c000
	buffer_load_dword v255, v14, s[8:11], s29 offen sc1
	buffer_load_dwordx4 v1, s[8:11], s89 offen offset:2048 lds
	buffer_load_dwordx4 v[156:159], v1, s[8:11], s94 offen offset:1024
	buffer_load_dwordx4 v1, s[8:11], s89 offen offset:3072 lds
	buffer_load_dwordx4 v[160:163], v1, s[8:11], s94 offen offset:2048
	s_waitcnt vmcnt(4)
	v_cmp_gt_u32 vcc, 1, v255
	s_cbranch_vccnz chkpoll_64
chkok_65:
	s_cmp_eq_u32 s25, 0
	s_cbranch_scc1 acq_66
acqb_67:
	s_add_u32 s88, s48, 0x17e8000
	buffer_load_dwordx4 a[100:103], v1, s[8:11], s88 offen offset:0 sc1
	s_add_u32 s88, s49, 0x17e8000
	buffer_load_dwordx4 a[104:107], v1, s[8:11], s88 offen offset:0 sc1
	s_add_u32 s88, s50, 0x17e8000
	buffer_load_dwordx4 a[108:111], v1, s[8:11], s88 offen offset:0 sc1
	s_add_u32 s88, s51, 0x17e8000
	buffer_load_dwordx4 a[112:115], v1, s[8:11], s88 offen offset:0 sc1
	s_add_u32 s88, s48, 0x17e8000
	buffer_load_dwordx4 a[116:119], v1, s[8:11], s88 offen offset:1024 sc1
	s_add_u32 s88, s49, 0x17e8000
	buffer_load_dwordx4 a[120:123], v1, s[8:11], s88 offen offset:1024 sc1
	s_add_u32 s88, s50, 0x17e8000
	buffer_load_dwordx4 a[124:127], v1, s[8:11], s88 offen offset:1024 sc1
	s_add_u32 s88, s51, 0x17e8000
	buffer_load_dwordx4 a[128:131], v1, s[8:11], s88 offen offset:1024 sc1
	s_waitcnt vmcnt(7)
	v_mfma_f32_16x16x32_bf16 v[72:75], a[0:3], a[100:103], 0
	s_add_u32 s88, s48, 0x17e8000
	buffer_load_dwordx4 a[132:135], v1, s[8:11], s88 offen offset:2048 sc1
	v_mfma_f32_16x16x32_bf16 v[76:79], a[4:7], a[100:103], 0
	v_mfma_f32_16x16x32_bf16 v[80:83], a[8:11], a[100:103], 0
	s_add_u32 s88, s49, 0x17e8000
	buffer_load_dwordx4 a[136:139], v1, s[8:11], s88 offen offset:2048 sc1
	v_mfma_f32_16x16x32_bf16 v[84:87], a[12:15], a[100:103], 0
	v_mfma_f32_16x16x32_bf16 v[88:91], a[16:19], a[100:103], 0
	s_add_u32 s88, s50, 0x17e8000
	buffer_load_dwordx4 a[140:143], v1, s[8:11], s88 offen offset:2048 sc1
	s_waitcnt vmcnt(9)
	v_mfma_f32_16x16x32_bf16 v[92:95], a[0:3], a[104:107], 0
	v_mfma_f32_16x16x32_bf16 v[96:99], a[4:7], a[104:107], 0
	v_mfma_f32_16x16x32_bf16 v[100:103], a[8:11], a[104:107], 0
	v_mfma_f32_16x16x32_bf16 v[104:107], a[12:15], a[104:107], 0
	v_mfma_f32_16x16x32_bf16 v[108:111], a[16:19], a[104:107], 0
	s_add_u32 s88, s51, 0x17e8000
	buffer_load_dwordx4 a[144:147], v1, s[8:11], s88 offen offset:2048 sc1
	s_waitcnt vmcnt(9)
	v_mfma_f32_16x16x32_bf16 v[112:115], a[0:3], a[108:111], 0
	v_mfma_f32_16x16x32_bf16 v[116:119], a[4:7], a[108:111], 0
	v_mfma_f32_16x16x32_bf16 v[120:123], a[8:11], a[108:111], 0
	v_mfma_f32_16x16x32_bf16 v[124:127], a[12:15], a[108:111], 0
	v_mfma_f32_16x16x32_bf16 v[128:131], a[16:19], a[108:111], 0
	s_add_u32 s88, s49, 0x17e8000
	buffer_load_dwordx4 a[152:155], v1, s[8:11], s88 offen offset:3072 sc1
	s_waitcnt vmcnt(9)
	v_mfma_f32_16x16x32_bf16 v[132:135], a[0:3], a[112:115], 0
	v_mfma_f32_16x16x32_bf16 v[136:139], a[4:7], a[112:115], 0
	v_mfma_f32_16x16x32_bf16 v[140:143], a[8:11], a[112:115], 0
	s_add_u32 s88, s50, 0x17e8000
	buffer_load_dwordx4 a[156:159], v1, s[8:11], s88 offen offset:3072 sc1
	v_mfma_f32_16x16x32_bf16 v[144:147], a[12:15], a[112:115], 0
	v_mfma_f32_16x16x32_bf16 v[148:151], a[16:19], a[112:115], 0
	s_waitcnt vmcnt(9)
	v_mfma_f32_16x16x32_bf16 v[72:75], a[20:23], a[116:119], v[72:75]
	v_mfma_f32_16x16x32_bf16 v[76:79], a[24:27], a[116:119], v[76:79]
	v_mfma_f32_16x16x32_bf16 v[80:83], a[28:31], a[116:119], v[80:83]
	s_add_u32 s88, s51, 0x17e8000
	buffer_load_dwordx4 v[228:231], v1, s[8:11], s88 offen offset:3072 sc1
	v_mfma_f32_16x16x32_bf16 v[84:87], a[32:35], a[116:119], v[84:87]
	v_mfma_f32_16x16x32_bf16 v[88:91], a[36:39], a[116:119], v[88:91]
	s_waitcnt vmcnt(9)
	v_mfma_f32_16x16x32_bf16 v[92:95], a[20:23], a[120:123], v[92:95]
	v_mfma_f32_16x16x32_bf16 v[96:99], a[24:27], a[120:123], v[96:99]
	v_mfma_f32_16x16x32_bf16 v[100:103], a[28:31], a[120:123], v[100:103]
	s_add_u32 s88, s48, 0x17e8000
	buffer_load_dwordx4 a[148:151], v1, s[8:11], s88 offen offset:3072 sc1
	v_mfma_f32_16x16x32_bf16 v[104:107], a[32:35], a[120:123], v[104:107]
	v_mfma_f32_16x16x32_bf16 v[108:111], a[36:39], a[120:123], v[108:111]
	s_waitcnt vmcnt(9)
	v_mfma_f32_16x16x32_bf16 v[112:115], a[20:23], a[124:127], v[112:115]
	s_add_u32 s88, s49, 0x17e9000
	buffer_load_dwordx4 v[236:239], v1, s[8:11], s88 offen offset:0 sc1
	v_mfma_f32_16x16x32_bf16 v[116:119], a[24:27], a[124:127], v[116:119]
	v_mfma_f32_16x16x32_bf16 v[120:123], a[28:31], a[124:127], v[120:123]
	v_mfma_f32_16x16x32_bf16 v[124:127], a[32:35], a[124:127], v[124:127]
	v_mfma_f32_16x16x32_bf16 v[128:131], a[36:39], a[124:127], v[128:131]
	s_add_u32 s88, s50, 0x17e9000
	buffer_load_dwordx4 v[240:243], v1, s[8:11], s88 offen offset:0 sc1
	s_waitcnt vmcnt(10)
	v_mfma_f32_16x16x32_bf16 v[132:135], a[20:23], a[128:131], v[132:135]
	v_mfma_f32_16x16x32_bf16 v[136:139], a[24:27], a[128:131], v[136:139]
	v_mfma_f32_16x16x32_bf16 v[140:143], a[28:31], a[128:131], v[140:143]
	v_mfma_f32_16x16x32_bf16 v[144:147], a[32:35], a[128:131], v[144:147]
	v_mfma_f32_16x16x32_bf16 v[148:151], a[36:39], a[128:131], v[148:151]
	s_add_u32 s88, s51, 0x17e9000
	buffer_load_dwordx4 v[244:247], v1, s[8:11], s88 offen offset:0 sc1
	s_waitcnt vmcnt(10)
	v_mfma_f32_16x16x32_bf16 v[72:75], a[40:43], a[132:135], v[72:75]
	v_mfma_f32_16x16x32_bf16 v[76:79], a[44:47], a[132:135], v[76:79]
	v_mfma_f32_16x16x32_bf16 v[80:83], a[48:51], a[132:135], v[80:83]
	v_mfma_f32_16x16x32_bf16 v[84:87], a[52:55], a[132:135], v[84:87]
	v_mfma_f32_16x16x32_bf16 v[88:91], a[56:59], a[132:135], v[88:91]
	s_add_u32 s88, s48, 0x17e9000
	buffer_load_dwordx4 v[232:235], v1, s[8:11], s88 offen offset:0 sc1
	s_waitcnt vmcnt(10)
	v_mfma_f32_16x16x32_bf16 v[92:95], a[40:43], a[136:139], v[92:95]
	v_mfma_f32_16x16x32_bf16 v[96:99], a[44:47], a[136:139], v[96:99]
	v_mfma_f32_16x16x32_bf16 v[100:103], a[48:51], a[136:139], v[100:103]
	s_add_u32 s89, s31, 0x10000
	s_add_u32 m0, s39, 0x4000
	s_nop 0
	buffer_load_dwordx4 v1, s[8:11], s89 offen offset:0 lds
	v_mfma_f32_16x16x32_bf16 v[104:107], a[52:55], a[136:139], v[104:107]
	v_mfma_f32_16x16x32_bf16 v[108:111], a[56:59], a[136:139], v[108:111]
	s_waitcnt vmcnt(10)
	v_mfma_f32_16x16x32_bf16 v[112:115], a[40:43], a[140:143], v[112:115]
	v_mfma_f32_16x16x32_bf16 v[116:119], a[44:47], a[140:143], v[116:119]
	v_mfma_f32_16x16x32_bf16 v[120:123], a[48:51], a[140:143], v[120:123]
	buffer_load_dwordx4 v1, s[8:11], s89 offen offset:1024 lds
	v_mfma_f32_16x16x32_bf16 v[124:127], a[52:55], a[140:143], v[124:127]
	v_mfma_f32_16x16x32_bf16 v[128:131], a[56:59], a[140:143], v[128:131]
	s_waitcnt vmcnt(10)
	v_mfma_f32_16x16x32_bf16 v[132:135], a[40:43], a[144:147], v[132:135]
	buffer_load_dwordx4 v1, s[8:11], s89 offen offset:2048 lds
	v_mfma_f32_16x16x32_bf16 v[136:139], a[44:47], a[144:147], v[136:139]
	v_mfma_f32_16x16x32_bf16 v[140:143], a[48:51], a[144:147], v[140:143]
	v_mfma_f32_16x16x32_bf16 v[144:147], a[52:55], a[144:147], v[144:147]
	v_mfma_f32_16x16x32_bf16 v[148:151], a[56:59], a[144:147], v[148:151]
	buffer_load_dwordx4 v[164:167], v1, s[8:11], s94 offen offset:3072
	s_waitcnt vmcnt(11)
	v_mfma_f32_16x16x32_bf16 v[92:95], a[60:63], a[152:155], v[92:95]
	v_mfma_f32_16x16x32_bf16 v[96:99], a[64:67], a[152:155], v[96:99]
	v_mfma_f32_16x16x32_bf16 v[100:103], a[68:71], a[152:155], v[100:103]
	v_mfma_f32_16x16x32_bf16 v[104:107], a[72:75], a[152:155], v[104:107]
	v_mfma_f32_16x16x32_bf16 v[108:111], a[76:79], a[152:155], v[108:111]
	buffer_load_dwordx4 v1, s[8:11], s89 offen offset:3072 lds
	s_waitcnt vmcnt(8)
	v_mfma_f32_16x16x32_bf16 v[92:95], a[80:83], v[236:239], v[92:95]
	v_mfma_f32_16x16x32_bf16 v[96:99], a[84:87], v[236:239], v[96:99]
	v_mfma_f32_16x16x32_bf16 v[100:103], a[88:91], v[236:239], v[100:103]
	v_mfma_f32_16x16x32_bf16 v[104:107], a[92:95], v[236:239], v[104:107]
	v_mfma_f32_16x16x32_bf16 v[108:111], a[96:99], v[236:239], v[108:111]
	s_add_u32 s94, s33, 0x1000
	buffer_load_dwordx4 v[168:171], v1, s[8:11], s94 offen offset:0
	v_mfma_f32_16x16x32_bf16 v[112:115], a[60:63], a[156:159], v[112:115]
	s_nop 0
	ds_write_b64 v28, v[92:93] offset:0
	v_mfma_f32_16x16x32_bf16 v[116:119], a[64:67], a[156:159], v[116:119]
	ds_write_b64 v28, v[94:95] offset:8
	v_mfma_f32_16x16x32_bf16 v[120:123], a[68:71], a[156:159], v[120:123]
	ds_write_b64 v28, v[96:97] offset:1024
	s_add_u32 s89, s31, 0x14000
	s_add_u32 m0, s39, 0x8000
	s_nop 0
	buffer_load_dwordx4 v1, s[8:11], s89 offen offset:0 lds
	v_mfma_f32_16x16x32_bf16 v[124:127], a[72:75], a[156:159], v[124:127]
	ds_write_b64 v28, v[98:99] offset:1032
	v_mfma_f32_16x16x32_bf16 v[128:131], a[76:79], a[156:159], v[128:131]
	ds_write_b64 v28, v[100:101] offset:2048
	s_waitcnt vmcnt(9)
	v_mfma_f32_16x16x32_bf16 v[112:115], a[80:83], v[240:243], v[112:115]
	ds_write_b64 v28, v[102:103] offset:2056
	v_mfma_f32_16x16x32_bf16 v[116:119], a[84:87], v[240:243], v[116:119]
	ds_write_b64 v28, v[104:105] offset:3072
	v_mfma_f32_16x16x32_bf16 v[120:123], a[88:91], v[240:243], v[120:123]
	ds_write_b64 v28, v[106:107] offset:3080
	s_add_u32 s94, s33, 0x3000
	buffer_load_dwordx4 v[172:175], v1, s[8:11], s94 offen offset:3072
	v_mfma_f32_16x16x32_bf16 v[124:127], a[92:95], v[240:243], v[124:127]
	ds_write_b64 v28, v[108:109] offset:4096
	v_mfma_f32_16x16x32_bf16 v[128:131], a[96:99], v[240:243], v[128:131]
	ds_write_b64 v28, v[110:111] offset:4104
	v_mfma_f32_16x16x32_bf16 v[132:135], a[60:63], v[228:231], v[132:135]
	ds_write_b64 v29, v[112:113] offset:0
	v_mfma_f32_16x16x32_bf16 v[136:139], a[64:67], v[228:231], v[136:139]
	ds_write_b64 v29, v[114:115] offset:8
	v_mfma_f32_16x16x32_bf16 v[140:143], a[68:71], v[228:231], v[140:143]
	ds_write_b64 v29, v[116:117] offset:1024
	v_mfma_f32_16x16x32_bf16 v[144:147], a[72:75], v[228:231], v[144:147]
	ds_write_b64 v29, v[118:119] offset:1032
	v_mfma_f32_16x16x32_bf16 v[148:151], a[76:79], v[228:231], v[148:151]
	ds_write_b64 v29, v[120:121] offset:2048
	s_waitcnt vmcnt(9)
	v_mfma_f32_16x16x32_bf16 v[132:135], a[80:83], v[244:247], v[132:135]
	ds_write_b64 v29, v[122:123] offset:2056
	v_mfma_f32_16x16x32_bf16 v[136:139], a[84:87], v[244:247], v[136:139]
	ds_write_b64 v29, v[124:125] offset:3072
	v_mfma_f32_16x16x32_bf16 v[140:143], a[88:91], v[244:247], v[140:143]
	ds_write_b64 v29, v[126:127] offset:3080
	v_mfma_f32_16x16x32_bf16 v[144:147], a[92:95], v[244:247], v[144:147]
	ds_write_b64 v29, v[128:129] offset:4096
	v_mfma_f32_16x16x32_bf16 v[148:151], a[96:99], v[244:247], v[148:151]
	ds_write_b64 v29, v[130:131] offset:4104
	v_mfma_f32_16x16x32_bf16 v[72:75], a[60:63], a[148:151], v[72:75]
	ds_write_b64 v30, v[132:133] offset:0
	v_mfma_f32_16x16x32_bf16 v[76:79], a[64:67], a[148:151], v[76:79]
	ds_write_b64 v30, v[134:135] offset:8
	v_mfma_f32_16x16x32_bf16 v[80:83], a[68:71], a[148:151], v[80:83]
	ds_write_b64 v30, v[136:137] offset:1024
	v_mfma_f32_16x16x32_bf16 v[84:87], a[72:75], a[148:151], v[84:87]
	ds_write_b64 v30, v[138:139] offset:1032
	v_mfma_f32_16x16x32_bf16 v[88:91], a[76:79], a[148:151], v[88:91]
	ds_write_b64 v30, v[140:141] offset:2048
	s_waitcnt vmcnt(8)
	v_mfma_f32_16x16x32_bf16 v[72:75], a[80:83], v[232:235], v[72:75]
	ds_write_b64 v30, v[142:143] offset:2056
	v_mfma_f32_16x16x32_bf16 v[76:79], a[84:87], v[232:235], v[76:79]
	ds_write_b64 v30, v[144:145] offset:3072
	v_mfma_f32_16x16x32_bf16 v[80:83], a[88:91], v[232:235], v[80:83]
	ds_write_b64 v30, v[146:147] offset:3080
	v_mfma_f32_16x16x32_bf16 v[84:87], a[92:95], v[232:235], v[84:87]
	ds_write_b64 v30, v[148:149] offset:4096
	v_mfma_f32_16x16x32_bf16 v[88:91], a[96:99], v[232:235], v[88:91]
	ds_write_b64 v30, v[150:151] offset:4104
	s_waitcnt lgkmcnt(0)
	s_barrier
	ds_read_b128 v[92:95], v26 offset:0
	ds_read_b128 v[112:115], v26 offset:5120
	ds_read_b128 v[132:135], v26 offset:10240
	ds_read_b128 v[96:99], v26 offset:1024
	ds_read_b128 v[116:119], v26 offset:6144
	ds_read_b128 v[136:139], v26 offset:11264
	ds_read_b128 v[100:103], v26 offset:2048
	ds_read_b128 v[120:123], v26 offset:7168
	ds_read_b128 v[140:143], v26 offset:12288
	ds_read_b128 v[104:107], v26 offset:3072
	ds_read_b128 v[124:127], v26 offset:8192
	ds_read_b128 v[144:147], v26 offset:13312
	ds_read_b128 v[108:111], v26 offset:4096
	ds_read_b128 v[128:131], v26 offset:9216
	ds_read_b128 v[148:151], v26 offset:14336
	v_pk_add_f32 v[36:37], v[36:37], v[72:73]
	v_pk_add_f32 v[38:39], v[38:39], v[74:75]
	v_pk_add_f32 v[40:41], v[40:41], v[76:77]
	v_pk_add_f32 v[42:43], v[42:43], v[78:79]
	v_pk_add_f32 v[44:45], v[44:45], v[80:81]
	v_pk_add_f32 v[46:47], v[46:47], v[82:83]
	v_pk_add_f32 v[48:49], v[48:49], v[84:85]
	v_pk_add_f32 v[50:51], v[50:51], v[86:87]
	v_pk_add_f32 v[52:53], v[52:53], v[88:89]
	v_pk_add_f32 v[54:55], v[54:55], v[90:91]
	s_add_u32 s28, s40, 0x8e8000
	buffer_load_dwordx4 v1, s[8:11], s89 offen offset:1024 lds
	buffer_load_dwordx4 v1, s[8:11], s89 offen offset:2048 lds
	s_waitcnt lgkmcnt(12)
	v_pk_add_f32 v[92:93], v[92:93], v[112:113]
	v_pk_add_f32 v[36:37], v[36:37], v[132:133]
	v_pk_add_f32 v[94:95], v[94:95], v[114:115]
	v_pk_add_f32 v[38:39], v[38:39], v[134:135]
	v_pk_add_f32 v[36:37], v[36:37], v[92:93]
	v_pk_add_f32 v[38:39], v[38:39], v[94:95]
	v_cvt_pk_bf16_f32 v72, v36, v37
	v_cvt_pk_bf16_f32 v73, v38, v39
	v_pk_add_f32 v[82:83], v[36:37], v[38:39]
	v_pk_mul_f32 v[84:85], v[36:37], v[36:37]
	v_pk_fma_f32 v[84:85], v[38:39], v[38:39], v[84:85]
	s_add_u32 s94, s33, 0x4000
	buffer_load_dwordx4 v[176:179], v1, s[8:11], s94 offen offset:0
	buffer_load_dwordx4 v1, s[8:11], s89 offen offset:3072 lds
	s_waitcnt lgkmcnt(9)
	v_pk_add_f32 v[96:97], v[96:97], v[116:117]
	v_pk_add_f32 v[40:41], v[40:41], v[136:137]
	v_pk_add_f32 v[98:99], v[98:99], v[118:119]
	v_pk_add_f32 v[42:43], v[42:43], v[138:139]
	v_pk_add_f32 v[40:41], v[40:41], v[96:97]
	v_pk_add_f32 v[42:43], v[42:43], v[98:99]
	v_cvt_pk_bf16_f32 v74, v40, v41
	v_cvt_pk_bf16_f32 v75, v42, v43
	buffer_store_dwordx4 v[72:75], v4, s[8:11], s28 offen
	v_pk_add_f32 v[82:83], v[82:83], v[40:41]
	v_pk_fma_f32 v[84:85], v[40:41], v[40:41], v[84:85]
	v_pk_add_f32 v[82:83], v[82:83], v[42:43]
	v_pk_fma_f32 v[84:85], v[42:43], v[42:43], v[84:85]
	s_waitcnt lgkmcnt(6)
	v_pk_add_f32 v[100:101], v[100:101], v[120:121]
	v_pk_add_f32 v[44:45], v[44:45], v[140:141]
	v_pk_add_f32 v[102:103], v[102:103], v[122:123]
	v_pk_add_f32 v[46:47], v[46:47], v[142:143]
	v_pk_add_f32 v[44:45], v[44:45], v[100:101]
	v_pk_add_f32 v[46:47], v[46:47], v[102:103]
	v_cvt_pk_bf16_f32 v76, v44, v45
	v_cvt_pk_bf16_f32 v77, v46, v47
	v_pk_add_f32 v[82:83], v[82:83], v[44:45]
	v_pk_fma_f32 v[84:85], v[44:45], v[44:45], v[84:85]
	v_pk_add_f32 v[82:83], v[82:83], v[46:47]
	v_pk_fma_f32 v[84:85], v[46:47], v[46:47], v[84:85]
	s_add_u32 s93, s43, 0x17e8000
	buffer_load_dword v0, v11, s[8:11], s93 offen offset:0 sc1
	s_add_u32 s93, s43, 0x17e8000
	buffer_load_dword v0, v11, s[8:11], s93 offen offset:512 sc1
	s_waitcnt lgkmcnt(3)
	v_pk_add_f32 v[104:105], v[104:105], v[124:125]
	v_pk_add_f32 v[48:49], v[48:49], v[144:145]
	v_pk_add_f32 v[106:107], v[106:107], v[126:127]
	v_pk_add_f32 v[50:51], v[50:51], v[146:147]
	v_pk_add_f32 v[48:49], v[48:49], v[104:105]
	v_pk_add_f32 v[50:51], v[50:51], v[106:107]
	v_cvt_pk_bf16_f32 v78, v48, v49
	v_cvt_pk_bf16_f32 v79, v50, v51
	buffer_store_dwordx4 v[76:79], v4, s[8:11], s28 offen offset:2048
	v_pk_add_f32 v[82:83], v[82:83], v[48:49]
	v_pk_fma_f32 v[84:85], v[48:49], v[48:49], v[84:85]
	v_pk_add_f32 v[82:83], v[82:83], v[50:51]
	v_pk_fma_f32 v[84:85], v[50:51], v[50:51], v[84:85]
	s_add_u32 s93, s38, 0x261d000
	buffer_load_dword v0, v15, s[8:11], s93 offen offset:0 sc1
	s_add_u32 s93, s61, 0x263a000
	v_and_b32 v253, 0x200, v1
	v_lshrrev_b32 v252, 1, v1
	v_lshl_or_b32 v253, v253, 21, v252
	buffer_load_dwordx2 a[244:245], v253, s[8:11], s93 offen offset:0
	buffer_load_dwordx2 a[246:247], v253, s[8:11], s93 offen offset:256
	buffer_load_dwordx2 a[248:249], v253, s[8:11], s93 offen offset:512
	buffer_load_dwordx2 a[250:251], v253, s[8:11], s93 offen offset:768
	buffer_load_dwordx2 a[252:253], v253, s[8:11], s93 offen offset:1024
	buffer_load_dwordx2 a[254:255], v253, s[8:11], s93 offen offset:1280
	s_waitcnt lgkmcnt(0)
	v_pk_add_f32 v[108:109], v[108:109], v[128:129]
	v_pk_add_f32 v[52:53], v[52:53], v[148:149]
	v_pk_add_f32 v[110:111], v[110:111], v[130:131]
	v_pk_add_f32 v[54:55], v[54:55], v[150:151]
	v_pk_add_f32 v[52:53], v[52:53], v[108:109]
	v_pk_add_f32 v[54:55], v[54:55], v[110:111]
	v_cvt_pk_bf16_f32 v80, v52, v53
	v_cvt_pk_bf16_f32 v81, v54, v55
	buffer_store_dwordx2 v[80:81], v5, s[8:11], s28 offen
	v_pk_add_f32 v[82:83], v[82:83], v[52:53]
	v_pk_fma_f32 v[84:85], v[52:53], v[52:53], v[84:85]
	v_pk_add_f32 v[82:83], v[82:83], v[54:55]
	v_pk_fma_f32 v[84:85], v[54:55], v[54:55], v[84:85]
	v_add_f32 v82, v82, v83
	v_add_f32 v84, v84, v85
	s_add_u32 s28, s41, 0x23e8000
	s_nop 0
	v_permlane32_swap_b32 v82, v84
	v_add_f32 v82, v82, v84
	v_mov_b32 v83, v82
	s_nop 1
	v_permlane16_swap_b32 v82, v83
	v_add_f32 v82, v82, v83
	buffer_store_dword v82, v6, s[8:11], s28 offen
	s_barrier
	s_add_u32 s89, s31, 0x18000
	s_add_u32 m0, s39, 0x18000
	s_nop 0
	buffer_load_dwordx4 v1, s[8:11], s89 offen offset:0 lds
	buffer_load_dwordx4 v[180:183], v1, s[8:11], s94 offen offset:1024
	buffer_load_dwordx4 v1, s[8:11], s89 offen offset:1024 lds
	buffer_load_dwordx4 v1, s[8:11], s89 offen offset:2048 lds
	v_mov_b32 v254, 1
	s_add_u32 s29, s45, 0x261d000
	s_waitcnt vmcnt(4)
	s_cmp_eq_u32 s25, 0
	s_cbranch_scc1 slow_68
	buffer_store_dword v254, v16, s[8:11], s29 offen
back_69:
	buffer_load_dwordx4 v[184:187], v1, s[8:11], s94 offen offset:2048
	buffer_load_dwordx4 v1, s[8:11], s89 offen offset:3072 lds
	buffer_load_dwordx4 v[188:191], v1, s[8:11], s94 offen offset:3072
	s_add_u32 s89, s31, 0x1c000
	s_add_u32 m0, s39, 0x1c000
	s_nop 0
	buffer_load_dwordx4 v1, s[8:11], s89 offen offset:0 lds
	s_add_u32 s29, s38, 0x261d000
	buffer_load_dword v255, v15, s[8:11], s29 offen sc1
	s_add_u32 s94, s33, 0x7000
	buffer_load_dwordx4 v[192:195], v1, s[8:11], s94 offen offset:2048
	buffer_load_dwordx4 v1, s[8:11], s89 offen offset:1024 lds
	buffer_load_dwordx4 v[196:199], v1, s[8:11], s94 offen offset:3072
	buffer_load_dwordx4 v1, s[8:11], s89 offen offset:2048 lds
	s_waitcnt vmcnt(4)
	v_cmp_gt_u32 vcc, 1, v255
	s_cbranch_vccnz chkpoll_70
chkok_71:
	s_cmp_eq_u32 s25, 0
	s_cbranch_scc1 acq_72
acqb_73:
	s_add_u32 s88, s34, 0x8e8000
	buffer_load_dwordx4 a[0:3], v1, s[8:11], s88 offen offset:0 sc1
	buffer_load_dwordx4 a[4:7], v1, s[8:11], s88 offen offset:1024 sc1
	buffer_load_dwordx4 a[8:11], v1, s[8:11], s88 offen offset:2048 sc1
	buffer_load_dwordx4 a[12:15], v1, s[8:11], s88 offen offset:3072 sc1
	s_barrier
	ds_read_b128 v[56:59], v1 offset:49152
	ds_read_b128 v[60:63], v1 offset:50176
	ds_read_b128 v[64:67], v1 offset:51200
	ds_read_b128 v[68:71], v1 offset:52224
	s_waitcnt lgkmcnt(3)
	s_add_u32 s88, s34, 0x8e9000
	buffer_load_dwordx4 a[16:19], v1, s[8:11], s88 offen offset:0 sc1
	buffer_load_dwordx4 a[20:23], v1, s[8:11], s88 offen offset:1024 sc1
	buffer_load_dwordx4 a[24:27], v1, s[8:11], s88 offen offset:2048 sc1
	buffer_load_dwordx4 a[28:31], v1, s[8:11], s88 offen offset:3072 sc1
	s_waitcnt vmcnt(7)
	v_mfma_f32_32x32x16_bf16 v[72:87], v[56:59], a[0:3], 0
	s_add_u32 s88, s34, 0x8ea000
	buffer_load_dwordx4 a[32:35], v1, s[8:11], s88 offen offset:0 sc1
	ds_read_b128 v[56:59], v1 offset:53248
	s_waitcnt lgkmcnt(3)
	v_mfma_f32_32x32x16_bf16 v[88:103], v[60:63], a[0:3], 0
	buffer_load_dwordx4 a[36:39], v1, s[8:11], s88 offen offset:1024 sc1
	ds_read_b128 v[60:63], v1 offset:54272
	s_waitcnt lgkmcnt(3)
	s_waitcnt vmcnt(8)
	v_mfma_f32_32x32x16_bf16 v[72:87], v[64:67], a[4:7], v[72:87]
	buffer_load_dwordx4 a[40:43], v1, s[8:11], s88 offen offset:2048 sc1
	ds_read_b128 v[64:67], v1 offset:55296
	s_waitcnt lgkmcnt(3)
	v_mfma_f32_32x32x16_bf16 v[88:103], v[68:71], a[4:7], v[88:103]
	ds_read_b128 v[68:71], v1 offset:56320
	s_waitcnt lgkmcnt(3)
	s_waitcnt vmcnt(8)
	v_mfma_f32_32x32x16_bf16 v[72:87], v[56:59], a[8:11], v[72:87]
	ds_read_b128 v[56:59], v1 offset:57344
	s_waitcnt lgkmcnt(3)
	v_mfma_f32_32x32x16_bf16 v[88:103], v[60:63], a[8:11], v[88:103]
	buffer_load_dwordx4 a[44:47], v1, s[8:11], s88 offen offset:3072 sc1
	ds_read_b128 v[60:63], v1 offset:58368
	s_waitcnt lgkmcnt(3)
	s_waitcnt vmcnt(8)
	v_mfma_f32_32x32x16_bf16 v[72:87], v[64:67], a[12:15], v[72:87]
	ds_read_b128 v[64:67], v1 offset:59392
	s_waitcnt lgkmcnt(3)
	v_mfma_f32_32x32x16_bf16 v[88:103], v[68:71], a[12:15], v[88:103]
	s_add_u32 s88, s34, 0x8eb000
	buffer_load_dwordx4 a[48:51], v1, s[8:11], s88 offen offset:0 sc1
	ds_read_b128 v[68:71], v1 offset:60416
	s_waitcnt lgkmcnt(3)
	s_waitcnt vmcnt(8)
	v_mfma_f32_32x32x16_bf16 v[72:87], v[56:59], a[16:19], v[72:87]
	ds_read_b128 v[56:59], v1 offset:61440
	s_waitcnt lgkmcnt(3)
	v_mfma_f32_32x32x16_bf16 v[88:103], v[60:63], a[16:19], v[88:103]
	buffer_load_dwordx4 a[52:55], v1, s[8:11], s88 offen offset:1024 sc1
	ds_read_b128 v[60:63], v1 offset:62464
	s_waitcnt lgkmcnt(3)
	s_waitcnt vmcnt(8)
	v_mfma_f32_32x32x16_bf16 v[72:87], v[64:67], a[20:23], v[72:87]
	ds_read_b128 v[64:67], v1 offset:63488
	s_waitcnt lgkmcnt(3)
	v_mfma_f32_32x32x16_bf16 v[88:103], v[68:71], a[20:23], v[88:103]
	buffer_load_dwordx4 a[56:59], v1, s[8:11], s88 offen offset:2048 sc1
	ds_read_b128 v[68:71], v1 offset:64512
	s_waitcnt lgkmcnt(3)
	s_waitcnt vmcnt(8)
	v_mfma_f32_32x32x16_bf16 v[72:87], v[56:59], a[24:27], v[72:87]
	ds_read_b128 v[56:59], v2 offset:0
	s_waitcnt lgkmcnt(3)
	v_mfma_f32_32x32x16_bf16 v[88:103], v[60:63], a[24:27], v[88:103]
	buffer_load_dwordx4 a[60:63], v1, s[8:11], s88 offen offset:3072 sc1
	ds_read_b128 v[60:63], v2 offset:1024
	s_waitcnt lgkmcnt(3)
	s_waitcnt vmcnt(8)
	v_mfma_f32_32x32x16_bf16 v[72:87], v[64:67], a[28:31], v[72:87]
	ds_read_b128 v[64:67], v2 offset:2048
	s_waitcnt lgkmcnt(3)
	v_mfma_f32_32x32x16_bf16 v[88:103], v[68:71], a[28:31], v[88:103]
	s_add_u32 s88, s34, 0x8ec000
	buffer_load_dwordx4 a[64:67], v1, s[8:11], s88 offen offset:0 sc1
	ds_read_b128 v[68:71], v2 offset:3072
	s_waitcnt lgkmcnt(3)
	s_waitcnt vmcnt(8)
	v_mfma_f32_32x32x16_bf16 v[72:87], v[56:59], a[32:35], v[72:87]
	ds_read_b128 v[56:59], v2 offset:4096
	s_waitcnt lgkmcnt(3)
	v_mfma_f32_32x32x16_bf16 v[88:103], v[60:63], a[32:35], v[88:103]
	buffer_load_dwordx4 a[68:71], v1, s[8:11], s88 offen offset:1024 sc1
	ds_read_b128 v[60:63], v2 offset:5120
	s_waitcnt lgkmcnt(3)
	s_waitcnt vmcnt(8)
	v_mfma_f32_32x32x16_bf16 v[72:87], v[64:67], a[36:39], v[72:87]
	ds_read_b128 v[64:67], v2 offset:6144
	s_waitcnt lgkmcnt(3)
	v_mfma_f32_32x32x16_bf16 v[88:103], v[68:71], a[36:39], v[88:103]
	buffer_load_dwordx4 a[72:75], v1, s[8:11], s88 offen offset:2048 sc1
	ds_read_b128 v[68:71], v2 offset:7168
	s_waitcnt lgkmcnt(3)
	s_waitcnt vmcnt(8)
	v_mfma_f32_32x32x16_bf16 v[72:87], v[56:59], a[40:43], v[72:87]
	ds_read_b128 v[56:59], v2 offset:8192
	s_waitcnt lgkmcnt(3)
	v_mfma_f32_32x32x16_bf16 v[88:103], v[60:63], a[40:43], v[88:103]
	ds_read_b128 v[60:63], v2 offset:9216
	s_waitcnt lgkmcnt(3)
	s_waitcnt vmcnt(7)
	v_mfma_f32_32x32x16_bf16 v[72:87], v[64:67], a[44:47], v[72:87]
	buffer_load_dwordx4 a[76:79], v1, s[8:11], s88 offen offset:3072 sc1
	ds_read_b128 v[64:67], v2 offset:10240
	s_waitcnt lgkmcnt(3)
	v_mfma_f32_32x32x16_bf16 v[88:103], v[68:71], a[44:47], v[88:103]
	ds_read_b128 v[68:71], v2 offset:11264
	s_waitcnt lgkmcnt(3)
	s_waitcnt vmcnt(7)
	v_mfma_f32_32x32x16_bf16 v[72:87], v[56:59], a[48:51], v[72:87]
	s_add_u32 s88, s34, 0x8ed000
	buffer_load_dwordx4 a[80:83], v1, s[8:11], s88 offen offset:0 sc1
	ds_read_b128 v[56:59], v2 offset:12288
	s_waitcnt lgkmcnt(3)
	v_mfma_f32_32x32x16_bf16 v[88:103], v[60:63], a[48:51], v[88:103]
	ds_read_b128 v[60:63], v2 offset:13312
	s_waitcnt lgkmcnt(3)
	s_waitcnt vmcnt(7)
	v_mfma_f32_32x32x16_bf16 v[72:87], v[64:67], a[52:55], v[72:87]
	buffer_load_dwordx4 a[84:87], v1, s[8:11], s88 offen offset:1024 sc1
	ds_read_b128 v[64:67], v2 offset:14336
	s_waitcnt lgkmcnt(3)
	v_mfma_f32_32x32x16_bf16 v[88:103], v[68:71], a[52:55], v[88:103]
	ds_read_b128 v[68:71], v2 offset:15360
	s_waitcnt lgkmcnt(3)
	s_waitcnt vmcnt(7)
	v_mfma_f32_32x32x16_bf16 v[72:87], v[56:59], a[56:59], v[72:87]
	buffer_load_dwordx4 a[88:91], v1, s[8:11], s88 offen offset:2048 sc1
	ds_read_b128 v[56:59], v2 offset:16384
	s_waitcnt lgkmcnt(3)
	v_mfma_f32_32x32x16_bf16 v[88:103], v[60:63], a[56:59], v[88:103]
	ds_read_b128 v[60:63], v2 offset:17408
	s_waitcnt lgkmcnt(3)
	s_waitcnt vmcnt(7)
	v_mfma_f32_32x32x16_bf16 v[72:87], v[64:67], a[60:63], v[72:87]
	buffer_load_dwordx4 a[92:95], v1, s[8:11], s88 offen offset:3072 sc1
	ds_read_b128 v[64:67], v2 offset:18432
	s_waitcnt lgkmcnt(3)
	v_mfma_f32_32x32x16_bf16 v[88:103], v[68:71], a[60:63], v[88:103]
	ds_read_b128 v[68:71], v2 offset:19456
	s_waitcnt lgkmcnt(3)
	s_waitcnt vmcnt(7)
	v_mfma_f32_32x32x16_bf16 v[72:87], v[56:59], a[64:67], v[72:87]
	s_add_u32 s88, s34, 0x8ee000
	buffer_load_dwordx4 a[96:99], v1, s[8:11], s88 offen offset:0 sc1
	ds_read_b128 v[56:59], v2 offset:20480
	s_waitcnt lgkmcnt(3)
	v_mfma_f32_32x32x16_bf16 v[88:103], v[60:63], a[64:67], v[88:103]
	ds_read_b128 v[60:63], v2 offset:21504
	s_waitcnt lgkmcnt(3)
	s_waitcnt vmcnt(7)
	v_mfma_f32_32x32x16_bf16 v[72:87], v[64:67], a[68:71], v[72:87]
	buffer_load_dwordx4 a[100:103], v1, s[8:11], s88 offen offset:1024 sc1
	ds_read_b128 v[64:67], v2 offset:22528
	s_waitcnt lgkmcnt(3)
	v_mfma_f32_32x32x16_bf16 v[88:103], v[68:71], a[68:71], v[88:103]
	ds_read_b128 v[68:71], v2 offset:23552
	s_waitcnt lgkmcnt(3)
	s_waitcnt vmcnt(7)
	v_mfma_f32_32x32x16_bf16 v[72:87], v[56:59], a[72:75], v[72:87]
	buffer_load_dwordx4 a[104:107], v1, s[8:11], s88 offen offset:2048 sc1
	ds_read_b128 v[56:59], v2 offset:24576
	s_waitcnt lgkmcnt(3)
	v_mfma_f32_32x32x16_bf16 v[88:103], v[60:63], a[72:75], v[88:103]
	ds_read_b128 v[60:63], v2 offset:25600
	s_waitcnt lgkmcnt(3)
	s_waitcnt vmcnt(7)
	v_mfma_f32_32x32x16_bf16 v[72:87], v[64:67], a[76:79], v[72:87]
	buffer_load_dwordx4 a[108:111], v1, s[8:11], s88 offen offset:3072 sc1
	ds_read_b128 v[64:67], v2 offset:26624
	s_waitcnt lgkmcnt(3)
	v_mfma_f32_32x32x16_bf16 v[88:103], v[68:71], a[76:79], v[88:103]
	ds_read_b128 v[68:71], v2 offset:27648
	s_waitcnt lgkmcnt(3)
	s_waitcnt vmcnt(7)
	v_mfma_f32_32x32x16_bf16 v[72:87], v[56:59], a[80:83], v[72:87]
	s_add_u32 s88, s34, 0x8ef000
	buffer_load_dwordx4 a[112:115], v1, s[8:11], s88 offen offset:0 sc1
	ds_read_b128 v[56:59], v2 offset:28672
	s_waitcnt lgkmcnt(3)
	v_mfma_f32_32x32x16_bf16 v[88:103], v[60:63], a[80:83], v[88:103]
	ds_read_b128 v[60:63], v2 offset:29696
	s_waitcnt lgkmcnt(3)
	s_waitcnt vmcnt(7)
	v_mfma_f32_32x32x16_bf16 v[72:87], v[64:67], a[84:87], v[72:87]
	buffer_load_dwordx4 a[116:119], v1, s[8:11], s88 offen offset:1024 sc1
	ds_read_b128 v[64:67], v2 offset:30720
	s_waitcnt lgkmcnt(3)
	v_mfma_f32_32x32x16_bf16 v[88:103], v[68:71], a[84:87], v[88:103]
	ds_read_b128 v[68:71], v2 offset:31744
	s_waitcnt lgkmcnt(3)
	s_waitcnt vmcnt(7)
	v_mfma_f32_32x32x16_bf16 v[72:87], v[56:59], a[88:91], v[72:87]
	buffer_load_dwordx4 a[120:123], v1, s[8:11], s88 offen offset:2048 sc1
	ds_read_b128 v[56:59], v1 offset:0
	s_waitcnt lgkmcnt(3)
	v_mfma_f32_32x32x16_bf16 v[88:103], v[60:63], a[88:91], v[88:103]
	ds_read_b128 v[60:63], v1 offset:1024
	s_waitcnt lgkmcnt(3)
	s_waitcnt vmcnt(7)
	v_mfma_f32_32x32x16_bf16 v[72:87], v[64:67], a[92:95], v[72:87]
	s_add_u32 s93, s35, 0x23e8000
	buffer_load_dwordx2 v[136:137], v7, s[8:11], s93 offen offset:0 sc1
	buffer_load_dwordx2 v[138:139], v7, s[8:11], s93 offen offset:128 sc1
	buffer_load_dwordx2 v[140:141], v7, s[8:11], s93 offen offset:256 sc1
	buffer_load_dwordx2 v[142:143], v7, s[8:11], s93 offen offset:384 sc1
	ds_read_b128 v[64:67], v1 offset:2048
	s_waitcnt lgkmcnt(3)
	v_mfma_f32_32x32x16_bf16 v[88:103], v[68:71], a[92:95], v[88:103]
	buffer_load_dwordx4 a[124:127], v1, s[8:11], s88 offen offset:3072 sc1
	ds_read_b128 v[68:71], v1 offset:3072
	s_waitcnt lgkmcnt(3)
	s_waitcnt vmcnt(11)
	v_mfma_f32_32x32x16_bf16 v[72:87], v[56:59], a[96:99], v[72:87]
	s_add_u32 s88, s34, 0x8f0000
	buffer_load_dwordx4 a[128:131], v1, s[8:11], s88 offen offset:0 sc1
	ds_read_b128 v[56:59], v1 offset:4096
	s_waitcnt lgkmcnt(3)
	v_mfma_f32_32x32x16_bf16 v[88:103], v[60:63], a[96:99], v[88:103]
	ds_read_b128 v[60:63], v1 offset:5120
	s_waitcnt lgkmcnt(3)
	s_waitcnt vmcnt(11)
	v_mfma_f32_32x32x16_bf16 v[72:87], v[64:67], a[100:103], v[72:87]
	buffer_load_dwordx4 a[132:135], v1, s[8:11], s88 offen offset:1024 sc1
	ds_read_b128 v[64:67], v1 offset:6144
	s_waitcnt lgkmcnt(3)
	v_mfma_f32_32x32x16_bf16 v[88:103], v[68:71], a[100:103], v[88:103]
	ds_read_b128 v[68:71], v1 offset:7168
	s_waitcnt lgkmcnt(3)
	s_waitcnt vmcnt(11)
	v_mfma_f32_32x32x16_bf16 v[72:87], v[56:59], a[104:107], v[72:87]
	buffer_load_dwordx4 a[136:139], v1, s[8:11], s88 offen offset:2048 sc1
	ds_read_b128 v[56:59], v1 offset:8192
	s_waitcnt lgkmcnt(3)
	v_mfma_f32_32x32x16_bf16 v[88:103], v[60:63], a[104:107], v[88:103]
	ds_read_b128 v[60:63], v1 offset:9216
	s_waitcnt lgkmcnt(3)
	s_waitcnt vmcnt(11)
	v_mfma_f32_32x32x16_bf16 v[72:87], v[64:67], a[108:111], v[72:87]
	buffer_load_dwordx4 a[140:143], v1, s[8:11], s88 offen offset:3072 sc1
	ds_read_b128 v[64:67], v1 offset:10240
	s_waitcnt lgkmcnt(3)
	v_mfma_f32_32x32x16_bf16 v[88:103], v[68:71], a[108:111], v[88:103]
	ds_read_b128 v[68:71], v1 offset:11264
	s_waitcnt lgkmcnt(3)
	s_waitcnt vmcnt(11)
	v_mfma_f32_32x32x16_bf16 v[72:87], v[56:59], a[112:115], v[72:87]
	s_add_u32 s88, s34, 0x8f1000
	buffer_load_dwordx4 a[144:147], v1, s[8:11], s88 offen offset:0 sc1
	ds_read_b128 v[56:59], v1 offset:12288
	s_waitcnt lgkmcnt(3)
	v_mfma_f32_32x32x16_bf16 v[88:103], v[60:63], a[112:115], v[88:103]
	ds_read_b128 v[60:63], v1 offset:13312
	s_waitcnt lgkmcnt(3)
	s_waitcnt vmcnt(11)
	v_mfma_f32_32x32x16_bf16 v[72:87], v[64:67], a[116:119], v[72:87]
	buffer_load_dwordx4 v1, s[8:11], s89 offen offset:3072 lds
	ds_read_b128 v[64:67], v1 offset:14336
	s_waitcnt lgkmcnt(3)
	v_mfma_f32_32x32x16_bf16 v[88:103], v[68:71], a[116:119], v[88:103]
	ds_read_b128 v[68:71], v1 offset:15360
	s_waitcnt lgkmcnt(3)
	s_waitcnt vmcnt(11)
	v_mfma_f32_32x32x16_bf16 v[72:87], v[56:59], a[120:123], v[72:87]
	buffer_load_dwordx4 a[148:151], v1, s[8:11], s88 offen offset:1024 sc1
	ds_read_b128 v[56:59], v1 offset:16384
	s_waitcnt lgkmcnt(3)
	v_mfma_f32_32x32x16_bf16 v[88:103], v[60:63], a[120:123], v[88:103]
	ds_read_b128 v[60:63], v1 offset:17408
	s_waitcnt lgkmcnt(3)
	s_waitcnt vmcnt(7)
	v_mfma_f32_32x32x16_bf16 v[72:87], v[64:67], a[124:127], v[72:87]
	buffer_load_dwordx4 a[152:155], v1, s[8:11], s88 offen offset:2048 sc1
	ds_read_b128 v[64:67], v1 offset:18432
	s_waitcnt lgkmcnt(3)
	v_mfma_f32_32x32x16_bf16 v[88:103], v[68:71], a[124:127], v[88:103]
	buffer_load_dwordx4 a[156:159], v1, s[8:11], s88 offen offset:3072 sc1
	ds_read_b128 v[68:71], v1 offset:19456
	s_waitcnt lgkmcnt(3)
	s_waitcnt vmcnt(8)
	v_mfma_f32_32x32x16_bf16 v[72:87], v[56:59], a[128:131], v[72:87]
	s_add_u32 s89, s31, 0x20000
	s_add_u32 m0, s39, 0x20000
	s_nop 0
	buffer_load_dwordx4 v1, s[8:11], s89 offen offset:0 lds
	ds_read_b128 v[56:59], v1 offset:20480
	s_waitcnt lgkmcnt(3)
	v_mfma_f32_32x32x16_bf16 v[88:103], v[60:63], a[128:131], v[88:103]
	s_add_u32 s94, s33, 0x8000
	buffer_load_dwordx4 v[200:203], v1, s[8:11], s94 offen offset:0
	ds_read_b128 v[60:63], v1 offset:21504
	s_waitcnt lgkmcnt(3)
	s_waitcnt vmcnt(9)
	v_mfma_f32_32x32x16_bf16 v[72:87], v[64:67], a[132:135], v[72:87]
	buffer_load_dwordx4 v1, s[8:11], s89 offen offset:1024 lds
	ds_read_b128 v[64:67], v1 offset:22528
	s_waitcnt lgkmcnt(3)
	v_mfma_f32_32x32x16_bf16 v[88:103], v[68:71], a[132:135], v[88:103]
	ds_read_b128 v[68:71], v1 offset:23552
	s_waitcnt lgkmcnt(3)
	s_waitcnt vmcnt(9)
	v_mfma_f32_32x32x16_bf16 v[72:87], v[56:59], a[136:139], v[72:87]
	buffer_load_dwordx4 v[204:207], v1, s[8:11], s94 offen offset:1024
	ds_read_b128 v[56:59], v1 offset:24576
	s_waitcnt lgkmcnt(3)
	v_mfma_f32_32x32x16_bf16 v[88:103], v[60:63], a[136:139], v[88:103]
	ds_read_b128 v[60:63], v1 offset:25600
	s_waitcnt lgkmcnt(3)
	s_waitcnt vmcnt(9)
	v_mfma_f32_32x32x16_bf16 v[72:87], v[64:67], a[140:143], v[72:87]
	ds_read_b128 v[64:67], v1 offset:26624
	s_waitcnt lgkmcnt(3)
	v_mfma_f32_32x32x16_bf16 v[88:103], v[68:71], a[140:143], v[88:103]
	ds_read_b128 v[68:71], v1 offset:27648
	s_waitcnt lgkmcnt(3)
	s_waitcnt vmcnt(8)
	v_mfma_f32_32x32x16_bf16 v[72:87], v[56:59], a[144:147], v[72:87]
	ds_read_b128 v[56:59], v1 offset:28672
	s_waitcnt lgkmcnt(3)
	v_mfma_f32_32x32x16_bf16 v[88:103], v[60:63], a[144:147], v[88:103]
	v_add_f32 v136, v136, v138
	v_add_f32 v137, v137, v139
	v_add_f32 v140, v140, v142
	ds_read_b128 v[60:63], v1 offset:29696
	s_waitcnt lgkmcnt(3)
	buffer_load_dwordx4 v1, s[8:11], s89 offen offset:2048 lds
	s_waitcnt vmcnt(7)
	v_mfma_f32_32x32x16_bf16 v[72:87], v[64:67], a[148:151], v[72:87]
	v_add_f32 v141, v141, v143
	v_add_f32 v136, v136, v140
	v_add_f32 v137, v137, v141
	buffer_load_dwordx4 v1, s[8:11], s89 offen offset:3072 lds
	ds_read_b128 v[64:67], v1 offset:30720
	s_waitcnt lgkmcnt(3)
	v_mfma_f32_32x32x16_bf16 v[88:103], v[68:71], a[148:151], v[88:103]
	v_mov_b32 v138, v136
	v_mov_b32 v139, v137
	s_nop 0
	v_permlane32_swap_b32 v136, v138
	buffer_load_dwordx4 v[208:211], v1, s[8:11], s94 offen offset:2048
	ds_read_b128 v[68:71], v1 offset:31744
	s_waitcnt lgkmcnt(3)
	s_waitcnt vmcnt(8)
	v_mfma_f32_32x32x16_bf16 v[72:87], v[56:59], a[152:155], v[72:87]
	v_permlane32_swap_b32 v137, v139
	v_add_f32 v136, v136, v138
	v_add_f32 v137, v137, v139
	v_mul_f32 v136, 0x3acccccd, v136
	s_add_u32 s89, s31, 0x24000
	s_add_u32 m0, s39, 0x24000
	s_nop 0
	buffer_load_dwordx4 v1, s[8:11], s89 offen offset:0 lds
	ds_read_b128 v[56:59], v1 offset:32768
	s_waitcnt lgkmcnt(3)
	v_mfma_f32_32x32x16_bf16 v[88:103], v[60:63], a[152:155], v[88:103]
	v_mul_f32 v137, 0x3acccccd, v137
	v_fma_f32 v137, -v136, v136, v137
	v_max_f32 v137, 0, v137
	ds_read_b128 v[60:63], v1 offset:33792
	s_waitcnt lgkmcnt(3)
	s_waitcnt vmcnt(8)
	v_mfma_f32_32x32x16_bf16 v[72:87], v[64:67], a[156:159], v[72:87]
	v_add_f32 v137, 0x3727c5ac, v137
	v_cvt_pk_bf16_f32 v141, -v136, 0
	v_lshlrev_b32 v138, 16, v141
	ds_read_b128 v[64:67], v1 offset:34816
	s_waitcnt lgkmcnt(3)
	v_mfma_f32_32x32x16_bf16 v[88:103], v[68:71], a[156:159], v[88:103]
	v_sub_f32 v138, -v136, v138
	v_cvt_pk_bf16_f32 v140, -v136, v138
	v_rcp_f32 v31, v137
	ds_read_b128 v[68:71], v1 offset:35840
	s_waitcnt lgkmcnt(3)
	v_mfma_f32_32x32x8_bf16 v[104:119], a[248:249], v[140:141], 0
	v_mfma_f32_32x32x8_bf16 v[120:135], a[250:251], v[140:141], 0
	v_mfma_f32_32x32x8_bf16 v[72:87], a[244:245], v[140:141], v[72:87]
	s_nop 1
	v_mfma_f32_32x32x8_bf16 v[88:103], a[246:247], v[140:141], v[88:103]
	s_nop 4
	v_mfma_f32_32x32x16_bf16 v[104:119], v[56:59], a[0:3], v[104:119]
	s_add_u32 s94, s33, 0xb000
	buffer_load_dwordx4 v[212:215], v1, s[8:11], s94 offen offset:1024
	ds_read_b128 v[56:59], v1 offset:36864
	s_waitcnt lgkmcnt(3)
	v_mfma_f32_32x32x16_bf16 v[120:135], v[60:63], a[0:3], v[120:135]
	buffer_load_dwordx4 v1, s[8:11], s89 offen offset:1024 lds
	ds_read_b128 v[60:63], v1 offset:37888
	s_waitcnt lgkmcnt(3)
	v_mfma_f32_32x32x16_bf16 v[104:119], v[64:67], a[4:7], v[104:119]
	ds_read_b128 v[64:67], v1 offset:38912
	s_waitcnt lgkmcnt(3)
	v_mfma_f32_32x32x16_bf16 v[120:135], v[68:71], a[4:7], v[120:135]
	v_max_f32 v72, 0, v72
	v_max_f32 v73, 0, v73
	buffer_load_dwordx4 v[216:219], v1, s[8:11], s94 offen offset:2048
	s_barrier
	ds_read_b128 v[68:71], v1 offset:39936
	s_waitcnt lgkmcnt(3)
	v_mfma_f32_32x32x16_bf16 v[104:119], v[56:59], a[8:11], v[104:119]
	v_mul_f32 v88, v31, v88
	v_mul_f32 v89, v31, v89
	buffer_load_dwordx4 v1, s[8:11], s89 offen offset:2048 lds
	ds_read_b128 v[56:59], v1 offset:40960
	s_waitcnt lgkmcnt(3)
	v_mfma_f32_32x32x16_bf16 v[120:135], v[60:63], a[8:11], v[120:135]
	v_mul_f32 v72, v72, v88
	v_mul_f32 v73, v73, v89
	ds_read_b128 v[60:63], v1 offset:41984
	s_waitcnt lgkmcnt(3)
	v_mfma_f32_32x32x16_bf16 v[104:119], v[64:67], a[12:15], v[104:119]
	v_cvt_pk_bf16_f32 v144, v72, v73
	v_max_f32 v74, 0, v74
	ds_read_b128 v[64:67], v1 offset:43008
	s_waitcnt lgkmcnt(3)
	v_mfma_f32_32x32x16_bf16 v[120:135], v[68:71], a[12:15], v[120:135]
	v_max_f32 v75, 0, v75
	v_mul_f32 v90, v31, v90
	ds_read_b128 v[68:71], v1 offset:44032
	s_waitcnt lgkmcnt(3)
	v_mfma_f32_32x32x16_bf16 v[104:119], v[56:59], a[16:19], v[104:119]
	v_mul_f32 v91, v31, v91
	v_mul_f32 v74, v74, v90
	ds_read_b128 v[56:59], v1 offset:45056
	s_waitcnt lgkmcnt(3)
	v_mfma_f32_32x32x16_bf16 v[120:135], v[60:63], a[16:19], v[120:135]
	v_mul_f32 v75, v75, v91
	v_cvt_pk_bf16_f32 v145, v74, v75
	ds_read_b128 v[60:63], v1 offset:46080
	s_waitcnt lgkmcnt(3)
	v_mfma_f32_32x32x16_bf16 v[104:119], v[64:67], a[20:23], v[104:119]
	v_max_f32 v76, 0, v76
	v_max_f32 v77, 0, v77
	ds_read_b128 v[64:67], v1 offset:47104
	s_waitcnt lgkmcnt(3)
	v_mfma_f32_32x32x16_bf16 v[120:135], v[68:71], a[20:23], v[120:135]
	v_mul_f32 v92, v31, v92
	v_mul_f32 v93, v31, v93
	buffer_load_dwordx4 v[220:223], v1, s[8:11], s94 offen offset:3072
	ds_read_b128 v[68:71], v1 offset:48128
	s_waitcnt lgkmcnt(3)
	v_mfma_f32_32x32x16_bf16 v[104:119], v[56:59], a[24:27], v[104:119]
	v_mul_f32 v76, v76, v92
	v_mul_f32 v77, v77, v93
	ds_read_b128 v[56:59], v2 offset:32768
	s_waitcnt lgkmcnt(3)
	v_mfma_f32_32x32x16_bf16 v[120:135], v[60:63], a[24:27], v[120:135]
	v_cvt_pk_bf16_f32 v146, v76, v77
	v_max_f32 v78, 0, v78
	ds_read_b128 v[60:63], v2 offset:33792
	s_waitcnt lgkmcnt(3)
	v_mfma_f32_32x32x16_bf16 v[104:119], v[64:67], a[28:31], v[104:119]
	v_max_f32 v79, 0, v79
	v_mul_f32 v94, v31, v94
	ds_read_b128 v[64:67], v2 offset:34816
	s_waitcnt lgkmcnt(3)
	v_mfma_f32_32x32x16_bf16 v[120:135], v[68:71], a[28:31], v[120:135]
	v_mul_f32 v95, v31, v95
	v_mul_f32 v78, v78, v94
	buffer_load_dwordx4 v1, s[8:11], s89 offen offset:3072 lds
	ds_read_b128 v[68:71], v2 offset:35840
	s_waitcnt lgkmcnt(3)
	v_mfma_f32_32x32x16_bf16 v[104:119], v[56:59], a[32:35], v[104:119]
	v_mul_f32 v79, v79, v95
	v_cvt_pk_bf16_f32 v147, v78, v79
	ds_read_b128 v[56:59], v2 offset:36864
	s_waitcnt lgkmcnt(3)
	v_mfma_f32_32x32x16_bf16 v[120:135], v[60:63], a[32:35], v[120:135]
	s_add_u32 s28, s43, 0x17e8000
	buffer_store_dwordx4 v[144:147], v11, s[8:11], s28 offen offset:0
	v_max_f32 v80, 0, v80
	ds_read_b128 v[60:63], v2 offset:37888
	s_waitcnt lgkmcnt(3)
	v_mfma_f32_32x32x16_bf16 v[104:119], v[64:67], a[36:39], v[104:119]
	v_max_f32 v81, 0, v81
	v_mul_f32 v96, v31, v96
	ds_read_b128 v[64:67], v2 offset:38912
	s_waitcnt lgkmcnt(3)
	v_mfma_f32_32x32x16_bf16 v[120:135], v[68:71], a[36:39], v[120:135]
	v_mul_f32 v97, v31, v97
	v_mul_f32 v80, v80, v96
	ds_read_b128 v[68:71], v2 offset:39936
	s_waitcnt lgkmcnt(3)
	v_mfma_f32_32x32x16_bf16 v[104:119], v[56:59], a[40:43], v[104:119]
	v_mul_f32 v81, v81, v97
	v_cvt_pk_bf16_f32 v148, v80, v81
	s_add_u32 s89, s31, 0x28000
	s_add_u32 m0, s39, 0xc000
	s_nop 0
	buffer_load_dwordx4 v1, s[8:11], s89 offen offset:0 lds
	ds_read_b128 v[56:59], v2 offset:40960
	s_waitcnt lgkmcnt(3)
	v_mfma_f32_32x32x16_bf16 v[120:135], v[60:63], a[40:43], v[120:135]
	v_max_f32 v82, 0, v82
	v_max_f32 v83, 0, v83
	ds_read_b128 v[60:63], v2 offset:41984
	s_waitcnt lgkmcnt(3)
	v_mfma_f32_32x32x16_bf16 v[104:119], v[64:67], a[44:47], v[104:119]
	v_mul_f32 v98, v31, v98
	v_mul_f32 v99, v31, v99
	ds_read_b128 v[64:67], v2 offset:43008
	s_waitcnt lgkmcnt(3)
	v_mfma_f32_32x32x16_bf16 v[120:135], v[68:71], a[44:47], v[120:135]
	v_mul_f32 v82, v82, v98
	v_mul_f32 v83, v83, v99
	ds_read_b128 v[68:71], v2 offset:44032
	s_waitcnt lgkmcnt(3)
	v_mfma_f32_32x32x16_bf16 v[104:119], v[56:59], a[48:51], v[104:119]
	v_cvt_pk_bf16_f32 v149, v82, v83
	v_max_f32 v84, 0, v84
	buffer_load_dwordx4 v1, s[8:11], s89 offen offset:1024 lds
	ds_read_b128 v[56:59], v2 offset:45056
	s_waitcnt lgkmcnt(3)
	v_mfma_f32_32x32x16_bf16 v[120:135], v[60:63], a[48:51], v[120:135]
	v_max_f32 v85, 0, v85
	v_mul_f32 v100, v31, v100
	ds_read_b128 v[60:63], v2 offset:46080
	s_waitcnt lgkmcnt(3)
	v_mfma_f32_32x32x16_bf16 v[104:119], v[64:67], a[52:55], v[104:119]
	v_mul_f32 v101, v31, v101
	v_mul_f32 v84, v84, v100
	buffer_load_dwordx4 v1, s[8:11], s89 offen offset:2048 lds
	ds_read_b128 v[64:67], v2 offset:47104
	s_waitcnt lgkmcnt(3)
	v_mfma_f32_32x32x16_bf16 v[120:135], v[68:71], a[52:55], v[120:135]
	v_mul_f32 v85, v85, v101
	v_cvt_pk_bf16_f32 v150, v84, v85
	ds_read_b128 v[68:71], v2 offset:48128
	s_waitcnt lgkmcnt(3)
	v_mfma_f32_32x32x16_bf16 v[104:119], v[56:59], a[56:59], v[104:119]
	v_max_f32 v86, 0, v86
	v_max_f32 v87, 0, v87
	ds_read_b128 v[56:59], v2 offset:49152
	s_waitcnt lgkmcnt(3)
	v_mfma_f32_32x32x16_bf16 v[120:135], v[60:63], a[56:59], v[120:135]
	v_mul_f32 v102, v31, v102
	v_mul_f32 v103, v31, v103
	ds_read_b128 v[60:63], v2 offset:50176
	s_waitcnt lgkmcnt(3)
	v_mfma_f32_32x32x16_bf16 v[104:119], v[64:67], a[60:63], v[104:119]
	v_mul_f32 v86, v86, v102
	v_mul_f32 v87, v87, v103
	buffer_load_dwordx4 v1, s[8:11], s89 offen offset:3072 lds
	ds_read_b128 v[64:67], v2 offset:51200
	s_waitcnt lgkmcnt(3)
	v_mfma_f32_32x32x16_bf16 v[120:135], v[68:71], a[60:63], v[120:135]
	v_cvt_pk_bf16_f32 v151, v86, v87
	s_add_u32 s28, s43, 0x17e8000
	buffer_store_dwordx4 v[148:151], v11, s[8:11], s28 offen offset:512
	ds_read_b128 v[68:71], v2 offset:52224
	s_waitcnt lgkmcnt(3)
	v_mfma_f32_32x32x16_bf16 v[104:119], v[56:59], a[64:67], v[104:119]
	ds_read_b128 v[56:59], v2 offset:53248
	s_waitcnt lgkmcnt(3)
	v_mfma_f32_32x32x16_bf16 v[120:135], v[60:63], a[64:67], v[120:135]
	ds_read_b128 v[60:63], v2 offset:54272
	s_waitcnt lgkmcnt(3)
	v_mfma_f32_32x32x16_bf16 v[104:119], v[64:67], a[68:71], v[104:119]
	ds_read_b128 v[64:67], v2 offset:55296
	s_waitcnt lgkmcnt(3)
	v_mfma_f32_32x32x16_bf16 v[120:135], v[68:71], a[68:71], v[120:135]
	ds_read_b128 v[68:71], v2 offset:56320
	s_waitcnt lgkmcnt(3)
	v_mfma_f32_32x32x16_bf16 v[104:119], v[56:59], a[72:75], v[104:119]
	s_add_u32 s89, s31, 0x2c000
	s_add_u32 m0, s39, 0x10000
	s_nop 0
	buffer_load_dwordx4 v1, s[8:11], s89 offen offset:0 lds
	ds_read_b128 v[56:59], v2 offset:57344
	s_waitcnt lgkmcnt(3)
	v_mfma_f32_32x32x16_bf16 v[120:135], v[60:63], a[72:75], v[120:135]
	ds_read_b128 v[60:63], v2 offset:58368
	s_waitcnt lgkmcnt(3)
	v_mfma_f32_32x32x16_bf16 v[104:119], v[64:67], a[76:79], v[104:119]
	buffer_load_dwordx4 v1, s[8:11], s89 offen offset:1024 lds
	ds_read_b128 v[64:67], v2 offset:59392
	s_waitcnt lgkmcnt(3)
	v_mfma_f32_32x32x16_bf16 v[120:135], v[68:71], a[76:79], v[120:135]
	buffer_load_dwordx4 v1, s[8:11], s89 offen offset:2048 lds
	ds_read_b128 v[68:71], v2 offset:60416
	s_waitcnt lgkmcnt(3)
	v_mfma_f32_32x32x16_bf16 v[104:119], v[56:59], a[80:83], v[104:119]
	ds_read_b128 v[56:59], v2 offset:61440
	s_waitcnt lgkmcnt(3)
	v_mfma_f32_32x32x16_bf16 v[120:135], v[60:63], a[80:83], v[120:135]
	ds_read_b128 v[60:63], v2 offset:62464
	s_waitcnt lgkmcnt(3)
	v_mfma_f32_32x32x16_bf16 v[104:119], v[64:67], a[84:87], v[104:119]
	ds_read_b128 v[64:67], v2 offset:63488
	s_waitcnt lgkmcnt(3)
	v_mfma_f32_32x32x16_bf16 v[120:135], v[68:71], a[84:87], v[120:135]
	s_add_u32 s94, s33, 0xc000
	buffer_load_dwordx4 v[224:227], v1, s[8:11], s94 offen offset:0
	ds_read_b128 v[68:71], v2 offset:64512
	s_waitcnt lgkmcnt(3)
	v_mfma_f32_32x32x16_bf16 v[104:119], v[56:59], a[88:91], v[104:119]
	s_waitcnt vmcnt(10)
	s_barrier
	ds_read_b128 v[56:59], v3 offset:0
	s_waitcnt lgkmcnt(3)
	v_mfma_f32_32x32x16_bf16 v[120:135], v[60:63], a[88:91], v[120:135]
	ds_read_b128 v[60:63], v3 offset:1024
	s_waitcnt lgkmcnt(3)
	v_mfma_f32_32x32x16_bf16 v[104:119], v[64:67], a[92:95], v[104:119]
	buffer_load_dwordx4 v1, s[8:11], s89 offen offset:3072 lds
	ds_read_b128 v[64:67], v3 offset:2048
	s_waitcnt lgkmcnt(3)
	v_mfma_f32_32x32x16_bf16 v[120:135], v[68:71], a[92:95], v[120:135]
	ds_read_b128 v[68:71], v3 offset:3072
	s_waitcnt lgkmcnt(3)
	v_mfma_f32_32x32x16_bf16 v[104:119], v[56:59], a[96:99], v[104:119]
	ds_read_b128 v[56:59], v3 offset:4096
	s_waitcnt lgkmcnt(3)
	v_mfma_f32_32x32x16_bf16 v[120:135], v[60:63], a[96:99], v[120:135]
	ds_read_b128 v[60:63], v3 offset:5120
	s_waitcnt lgkmcnt(3)
	v_mfma_f32_32x32x16_bf16 v[104:119], v[64:67], a[100:103], v[104:119]
	buffer_load_dwordx4 v[228:231], v1, s[8:11], s94 offen offset:1024
	ds_read_b128 v[64:67], v3 offset:6144
	s_waitcnt lgkmcnt(3)
	v_mfma_f32_32x32x16_bf16 v[120:135], v[68:71], a[100:103], v[120:135]
	ds_read_b128 v[68:71], v3 offset:7168
	s_waitcnt lgkmcnt(3)
	v_mfma_f32_32x32x16_bf16 v[104:119], v[56:59], a[104:107], v[104:119]
	ds_read_b128 v[56:59], v3 offset:8192
	s_waitcnt lgkmcnt(3)
	v_mfma_f32_32x32x16_bf16 v[120:135], v[60:63], a[104:107], v[120:135]
	ds_read_b128 v[60:63], v3 offset:9216
	s_waitcnt lgkmcnt(3)
	v_mfma_f32_32x32x16_bf16 v[104:119], v[64:67], a[108:111], v[104:119]
	ds_read_b128 v[64:67], v3 offset:10240
	s_waitcnt lgkmcnt(3)
	v_mfma_f32_32x32x16_bf16 v[120:135], v[68:71], a[108:111], v[120:135]
	s_add_u32 s89, s31, 0x30000
	s_add_u32 m0, s39, 0x14000
	s_nop 0
	buffer_load_dwordx4 v1, s[8:11], s89 offen offset:0 lds
	ds_read_b128 v[68:71], v3 offset:11264
	s_waitcnt lgkmcnt(3)
	v_mfma_f32_32x32x16_bf16 v[104:119], v[56:59], a[112:115], v[104:119]
	buffer_load_dwordx4 v1, s[8:11], s89 offen offset:1024 lds
	ds_read_b128 v[56:59], v3 offset:12288
	s_waitcnt lgkmcnt(3)
	v_mfma_f32_32x32x16_bf16 v[120:135], v[60:63], a[112:115], v[120:135]
	ds_read_b128 v[60:63], v3 offset:13312
	s_waitcnt lgkmcnt(3)
	v_mfma_f32_32x32x16_bf16 v[104:119], v[64:67], a[116:119], v[104:119]
	ds_read_b128 v[64:67], v3 offset:14336
	s_waitcnt lgkmcnt(3)
	v_mfma_f32_32x32x16_bf16 v[120:135], v[68:71], a[116:119], v[120:135]
	s_add_u32 s94, s33, 0x1000
	buffer_load_dwordx4 v[232:235], v1, s[8:11], s94 offen offset:1024
	ds_read_b128 v[68:71], v3 offset:15360
	s_waitcnt lgkmcnt(3)
	v_mfma_f32_32x32x16_bf16 v[104:119], v[56:59], a[120:123], v[104:119]
	ds_read_b128 v[56:59], v3 offset:16384
	s_waitcnt lgkmcnt(3)
	v_mfma_f32_32x32x16_bf16 v[120:135], v[60:63], a[120:123], v[120:135]
	ds_read_b128 v[60:63], v3 offset:17408
	s_waitcnt lgkmcnt(3)
	v_mfma_f32_32x32x16_bf16 v[104:119], v[64:67], a[124:127], v[104:119]
	ds_read_b128 v[64:67], v3 offset:18432
	s_waitcnt lgkmcnt(3)
	v_mfma_f32_32x32x16_bf16 v[120:135], v[68:71], a[124:127], v[120:135]
	buffer_load_dwordx4 v1, s[8:11], s89 offen offset:2048 lds
	ds_read_b128 v[68:71], v3 offset:19456
	s_waitcnt lgkmcnt(3)
	v_mfma_f32_32x32x16_bf16 v[104:119], v[56:59], a[128:131], v[104:119]
	ds_read_b128 v[56:59], v3 offset:20480
	s_waitcnt lgkmcnt(3)
	v_mfma_f32_32x32x16_bf16 v[120:135], v[60:63], a[128:131], v[120:135]
	ds_read_b128 v[60:63], v3 offset:21504
	s_waitcnt lgkmcnt(3)
	v_mfma_f32_32x32x16_bf16 v[104:119], v[64:67], a[132:135], v[104:119]
	ds_read_b128 v[64:67], v3 offset:22528
	s_waitcnt lgkmcnt(3)
	v_mfma_f32_32x32x16_bf16 v[120:135], v[68:71], a[132:135], v[120:135]
	buffer_load_dwordx4 v[236:239], v1, s[8:11], s94 offen offset:2048
	ds_read_b128 v[68:71], v3 offset:23552
	s_waitcnt lgkmcnt(3)
	v_mfma_f32_32x32x16_bf16 v[104:119], v[56:59], a[136:139], v[104:119]
	ds_read_b128 v[56:59], v3 offset:24576
	s_waitcnt lgkmcnt(3)
	v_mfma_f32_32x32x16_bf16 v[120:135], v[60:63], a[136:139], v[120:135]
	ds_read_b128 v[60:63], v3 offset:25600
	s_waitcnt lgkmcnt(3)
	v_mfma_f32_32x32x16_bf16 v[104:119], v[64:67], a[140:143], v[104:119]
	ds_read_b128 v[64:67], v3 offset:26624
	s_waitcnt lgkmcnt(3)
	v_mfma_f32_32x32x16_bf16 v[120:135], v[68:71], a[140:143], v[120:135]
	buffer_load_dwordx4 v1, s[8:11], s89 offen offset:3072 lds
	ds_read_b128 v[68:71], v3 offset:27648
	s_waitcnt lgkmcnt(3)
	v_mfma_f32_32x32x16_bf16 v[104:119], v[56:59], a[144:147], v[104:119]
	ds_read_b128 v[56:59], v3 offset:28672
	s_waitcnt lgkmcnt(3)
	v_mfma_f32_32x32x16_bf16 v[120:135], v[60:63], a[144:147], v[120:135]
	s_add_u32 s89, s31, 0x34000
	s_add_u32 m0, s39, 0
	s_nop 0
	buffer_load_dwordx4 v1, s[8:11], s89 offen offset:0 lds
	ds_read_b128 v[60:63], v3 offset:29696
	s_waitcnt lgkmcnt(3)
	v_mfma_f32_32x32x16_bf16 v[104:119], v[64:67], a[148:151], v[104:119]
	ds_read_b128 v[64:67], v3 offset:30720
	s_waitcnt lgkmcnt(3)
	v_mfma_f32_32x32x16_bf16 v[120:135], v[68:71], a[148:151], v[120:135]
	ds_read_b128 v[68:71], v3 offset:31744
	s_waitcnt lgkmcnt(3)
	v_mfma_f32_32x32x8_bf16 v[72:87], a[252:253], v[140:141], 0
	v_mfma_f32_32x32x8_bf16 v[88:103], a[254:255], v[140:141], 0
	v_mfma_f32_32x32x16_bf16 v[104:119], v[56:59], a[152:155], v[104:119]
	buffer_load_dwordx4 v1, s[8:11], s89 offen offset:1024 lds
	s_waitcnt vmcnt(9)
	s_barrier
	ds_read_b128 v[56:59], v1 offset:49152
	s_waitcnt lgkmcnt(3)
	v_mfma_f32_32x32x16_bf16 v[120:135], v[60:63], a[152:155], v[120:135]
	buffer_load_dwordx4 v[240:243], v1, s[8:11], s94 offen offset:3072
	ds_read_b128 v[60:63], v1 offset:50176
	s_waitcnt lgkmcnt(3)
	v_mfma_f32_32x32x16_bf16 v[104:119], v[64:67], a[156:159], v[104:119]
	ds_read_b128 v[64:67], v1 offset:51200
	s_waitcnt lgkmcnt(3)
	v_mfma_f32_32x32x16_bf16 v[120:135], v[68:71], a[156:159], v[120:135]
	ds_read_b128 v[68:71], v1 offset:52224
	s_waitcnt lgkmcnt(3)
	v_mfma_f32_32x32x16_bf16 v[72:87], v[56:59], a[0:3], v[72:87]
	buffer_load_dwordx4 v1, s[8:11], s89 offen offset:2048 lds
	ds_read_b128 v[56:59], v1 offset:53248
	s_waitcnt lgkmcnt(3)
	v_mfma_f32_32x32x16_bf16 v[88:103], v[60:63], a[0:3], v[88:103]
	ds_read_b128 v[60:63], v1 offset:54272
	s_waitcnt lgkmcnt(3)
	v_mfma_f32_32x32x16_bf16 v[72:87], v[64:67], a[4:7], v[72:87]
	v_max_f32 v104, 0, v104
	v_max_f32 v105, 0, v105
	v_mul_f32 v120, v31, v120
	v_mul_f32 v121, v31, v121
	ds_read_b128 v[64:67], v1 offset:55296
	s_waitcnt lgkmcnt(3)
	v_mfma_f32_32x32x16_bf16 v[88:103], v[68:71], a[4:7], v[88:103]
	v_mul_f32 v104, v104, v120
	v_mul_f32 v105, v105, v121
	v_cvt_pk_bf16_f32 v144, v104, v105
	v_max_f32 v106, 0, v106
	ds_read_b128 v[68:71], v1 offset:56320
	s_waitcnt lgkmcnt(3)
	v_mfma_f32_32x32x16_bf16 v[72:87], v[56:59], a[8:11], v[72:87]
	v_max_f32 v107, 0, v107
	v_mul_f32 v122, v31, v122
	v_mul_f32 v123, v31, v123
	s_add_u32 s94, s33, 0x2000
	buffer_load_dwordx4 v[244:247], v1, s[8:11], s94 offen offset:0
	ds_read_b128 v[56:59], v1 offset:57344
	s_waitcnt lgkmcnt(3)
	v_mfma_f32_32x32x16_bf16 v[88:103], v[60:63], a[8:11], v[88:103]
	v_mul_f32 v106, v106, v122
	v_mul_f32 v107, v107, v123
	v_cvt_pk_bf16_f32 v145, v106, v107
	v_max_f32 v108, 0, v108
	ds_read_b128 v[60:63], v1 offset:58368
	s_waitcnt lgkmcnt(3)
	v_mfma_f32_32x32x16_bf16 v[72:87], v[64:67], a[12:15], v[72:87]
	v_max_f32 v109, 0, v109
	v_mul_f32 v124, v31, v124
	v_mul_f32 v125, v31, v125
	v_mul_f32 v108, v108, v124
	buffer_load_dwordx4 v1, s[8:11], s89 offen offset:3072 lds
	ds_read_b128 v[64:67], v1 offset:59392
	s_waitcnt lgkmcnt(3)
	v_mfma_f32_32x32x16_bf16 v[88:103], v[68:71], a[12:15], v[88:103]
	v_mul_f32 v109, v109, v125
	v_cvt_pk_bf16_f32 v146, v108, v109
	v_max_f32 v110, 0, v110
	ds_read_b128 v[68:71], v1 offset:60416
	s_waitcnt lgkmcnt(3)
	v_mfma_f32_32x32x16_bf16 v[72:87], v[56:59], a[16:19], v[72:87]
	v_max_f32 v111, 0, v111
	v_mul_f32 v126, v31, v126
	v_mul_f32 v127, v31, v127
	v_mul_f32 v110, v110, v126
	ds_read_b128 v[56:59], v1 offset:61440
	s_waitcnt lgkmcnt(3)
	v_mfma_f32_32x32x16_bf16 v[88:103], v[60:63], a[16:19], v[88:103]
	v_mul_f32 v111, v111, v127
	v_cvt_pk_bf16_f32 v147, v110, v111
	s_add_u32 s28, s43, 0x17e8000
	buffer_store_dwordx4 v[144:147], v11, s[8:11], s28 offen offset:1024
	ds_read_b128 v[60:63], v1 offset:62464
	s_waitcnt lgkmcnt(3)
	v_mfma_f32_32x32x16_bf16 v[72:87], v[64:67], a[20:23], v[72:87]
	v_max_f32 v112, 0, v112
	v_max_f32 v113, 0, v113
	v_mul_f32 v128, v31, v128
	v_mul_f32 v129, v31, v129
	ds_read_b128 v[64:67], v1 offset:63488
	s_waitcnt lgkmcnt(3)
	v_mfma_f32_32x32x16_bf16 v[88:103], v[68:71], a[20:23], v[88:103]
	v_mul_f32 v112, v112, v128
	v_mul_f32 v113, v113, v129
	v_cvt_pk_bf16_f32 v148, v112, v113
	v_max_f32 v114, 0, v114
	ds_read_b128 v[68:71], v1 offset:64512
	s_waitcnt lgkmcnt(3)
	v_mfma_f32_32x32x16_bf16 v[72:87], v[56:59], a[24:27], v[72:87]
	v_max_f32 v115, 0, v115
	v_mul_f32 v130, v31, v130
	v_mul_f32 v131, v31, v131
	s_add_u32 s89, s31, 0x38000
	s_add_u32 m0, s39, 0x4000
	s_nop 0
	buffer_load_dwordx4 v1, s[8:11], s89 offen offset:0 lds
	ds_read_b128 v[56:59], v2 offset:0
	s_waitcnt lgkmcnt(3)
	v_mfma_f32_32x32x16_bf16 v[88:103], v[60:63], a[24:27], v[88:103]
	v_mul_f32 v114, v114, v130
	v_mul_f32 v115, v115, v131
	v_cvt_pk_bf16_f32 v149, v114, v115
	v_max_f32 v116, 0, v116
	ds_read_b128 v[60:63], v2 offset:1024
	s_waitcnt lgkmcnt(3)
	v_mfma_f32_32x32x16_bf16 v[72:87], v[64:67], a[28:31], v[72:87]
	v_max_f32 v117, 0, v117
	v_mul_f32 v132, v31, v132
	v_mul_f32 v133, v31, v133
	v_mul_f32 v116, v116, v132
	ds_read_b128 v[64:67], v2 offset:2048
	s_waitcnt lgkmcnt(3)
	v_mfma_f32_32x32x16_bf16 v[88:103], v[68:71], a[28:31], v[88:103]
	v_mul_f32 v117, v117, v133
	v_cvt_pk_bf16_f32 v150, v116, v117
	v_max_f32 v118, 0, v118
	ds_read_b128 v[68:71], v2 offset:3072
	s_waitcnt lgkmcnt(3)
	v_mfma_f32_32x32x16_bf16 v[72:87], v[56:59], a[32:35], v[72:87]
	v_max_f32 v119, 0, v119
	v_mul_f32 v134, v31, v134
	v_mul_f32 v135, v31, v135
	v_mul_f32 v118, v118, v134
	buffer_load_dwordx4 v1, s[8:11], s89 offen offset:1024 lds
	ds_read_b128 v[56:59], v2 offset:4096
	s_waitcnt lgkmcnt(3)
	v_mfma_f32_32x32x16_bf16 v[88:103], v[60:63], a[32:35], v[88:103]
	v_mul_f32 v119, v119, v135
	v_cvt_pk_bf16_f32 v151, v118, v119
	s_add_u32 s28, s43, 0x17e8000
	buffer_store_dwordx4 v[148:151], v11, s[8:11], s28 offen offset:1536
	ds_read_b128 v[60:63], v2 offset:5120
	s_waitcnt lgkmcnt(3)
	v_mfma_f32_32x32x16_bf16 v[72:87], v[64:67], a[36:39], v[72:87]
	ds_read_b128 v[64:67], v2 offset:6144
	s_waitcnt lgkmcnt(3)
	v_mfma_f32_32x32x16_bf16 v[88:103], v[68:71], a[36:39], v[88:103]
	ds_read_b128 v[68:71], v2 offset:7168
	s_waitcnt lgkmcnt(3)
	v_mfma_f32_32x32x16_bf16 v[72:87], v[56:59], a[40:43], v[72:87]
	ds_read_b128 v[56:59], v2 offset:8192
	s_waitcnt lgkmcnt(3)
	v_mfma_f32_32x32x16_bf16 v[88:103], v[60:63], a[40:43], v[88:103]
	ds_read_b128 v[60:63], v2 offset:9216
	s_waitcnt lgkmcnt(3)
	v_mfma_f32_32x32x16_bf16 v[72:87], v[64:67], a[44:47], v[72:87]
	buffer_load_dwordx4 v1, s[8:11], s89 offen offset:2048 lds
	ds_read_b128 v[64:67], v2 offset:10240
	s_waitcnt lgkmcnt(3)
	v_mfma_f32_32x32x16_bf16 v[88:103], v[68:71], a[44:47], v[88:103]
	ds_read_b128 v[68:71], v2 offset:11264
	s_waitcnt lgkmcnt(3)
	v_mfma_f32_32x32x16_bf16 v[72:87], v[56:59], a[48:51], v[72:87]
	buffer_load_dwordx4 v1, s[8:11], s89 offen offset:3072 lds
	ds_read_b128 v[56:59], v2 offset:12288
	s_waitcnt lgkmcnt(3)
	v_mfma_f32_32x32x16_bf16 v[88:103], v[60:63], a[48:51], v[88:103]
	ds_read_b128 v[60:63], v2 offset:13312
	s_waitcnt lgkmcnt(3)
	v_mfma_f32_32x32x16_bf16 v[72:87], v[64:67], a[52:55], v[72:87]
	ds_read_b128 v[64:67], v2 offset:14336
	s_waitcnt lgkmcnt(3)
	v_mfma_f32_32x32x16_bf16 v[88:103], v[68:71], a[52:55], v[88:103]
	ds_read_b128 v[68:71], v2 offset:15360
	s_waitcnt lgkmcnt(3)
	v_mfma_f32_32x32x16_bf16 v[72:87], v[56:59], a[56:59], v[72:87]
	s_add_u32 s93, s38, 0x261e000
	buffer_load_dword v0, v14, s[8:11], s93 offen offset:0 sc1
	s_add_u32 s94, s33, 0x6000
	buffer_load_dwordx4 a[244:247], v1, s[8:11], s94 offen offset:1024
	s_waitcnt vmcnt(8)
	s_barrier
	ds_read_b128 v[56:59], v2 offset:16384
	s_waitcnt lgkmcnt(3)
	v_mfma_f32_32x32x16_bf16 v[88:103], v[60:63], a[56:59], v[88:103]
	buffer_load_dwordx4 a[248:251], v1, s[8:11], s94 offen offset:2048
	ds_read_b128 v[60:63], v2 offset:17408
	s_waitcnt lgkmcnt(3)
	v_mfma_f32_32x32x16_bf16 v[72:87], v[64:67], a[60:63], v[72:87]
	buffer_load_dwordx4 a[252:255], v1, s[8:11], s94 offen offset:3072
	ds_read_b128 v[64:67], v2 offset:18432
	s_waitcnt lgkmcnt(3)
	v_mfma_f32_32x32x16_bf16 v[88:103], v[68:71], a[60:63], v[88:103]
	ds_read_b128 v[68:71], v2 offset:19456
	s_waitcnt lgkmcnt(3)
	v_mfma_f32_32x32x16_bf16 v[72:87], v[56:59], a[64:67], v[72:87]
	s_add_u32 s94, s33, 0x7000
	buffer_load_dwordx4 a[0:3], v1, s[8:11], s94 offen offset:0
	ds_read_b128 v[56:59], v2 offset:20480
	s_waitcnt lgkmcnt(3)
	v_mfma_f32_32x32x16_bf16 v[88:103], v[60:63], a[64:67], v[88:103]
	ds_read_b128 v[60:63], v2 offset:21504
	s_waitcnt lgkmcnt(3)
	v_mfma_f32_32x32x16_bf16 v[72:87], v[64:67], a[68:71], v[72:87]
	ds_read_b128 v[64:67], v2 offset:22528
	s_waitcnt lgkmcnt(3)
	v_mfma_f32_32x32x16_bf16 v[88:103], v[68:71], a[68:71], v[88:103]
	ds_read_b128 v[68:71], v2 offset:23552
	s_waitcnt lgkmcnt(3)
	v_mfma_f32_32x32x16_bf16 v[72:87], v[56:59], a[72:75], v[72:87]
	buffer_load_dwordx4 a[4:7], v1, s[8:11], s94 offen offset:1024
	ds_read_b128 v[56:59], v2 offset:24576
	s_waitcnt lgkmcnt(3)
	v_mfma_f32_32x32x16_bf16 v[88:103], v[60:63], a[72:75], v[88:103]
	s_add_u32 s94, s33, 0xa000
	buffer_load_dwordx4 a[8:11], v1, s[8:11], s94 offen offset:0
	ds_read_b128 v[60:63], v2 offset:25600
	s_waitcnt lgkmcnt(3)
	v_mfma_f32_32x32x16_bf16 v[72:87], v[64:67], a[76:79], v[72:87]
	ds_read_b128 v[64:67], v2 offset:26624
	s_waitcnt lgkmcnt(3)
	v_mfma_f32_32x32x16_bf16 v[88:103], v[68:71], a[76:79], v[88:103]
	ds_read_b128 v[68:71], v2 offset:27648
	s_waitcnt lgkmcnt(3)
	v_mfma_f32_32x32x16_bf16 v[72:87], v[56:59], a[80:83], v[72:87]
	ds_read_b128 v[56:59], v2 offset:28672
	s_waitcnt lgkmcnt(3)
	v_mfma_f32_32x32x16_bf16 v[88:103], v[60:63], a[80:83], v[88:103]
	ds_read_b128 v[60:63], v2 offset:29696
	s_waitcnt lgkmcnt(3)
	v_mfma_f32_32x32x16_bf16 v[72:87], v[64:67], a[84:87], v[72:87]
	buffer_load_dwordx4 a[12:15], v1, s[8:11], s94 offen offset:1024
	ds_read_b128 v[64:67], v2 offset:30720
	s_waitcnt lgkmcnt(3)
	v_mfma_f32_32x32x16_bf16 v[88:103], v[68:71], a[84:87], v[88:103]
	ds_read_b128 v[68:71], v2 offset:31744
	s_waitcnt lgkmcnt(3)
	v_mfma_f32_32x32x16_bf16 v[72:87], v[56:59], a[88:91], v[72:87]
	v_mov_b32 v254, 2
	s_add_u32 s29, s44, 0x261e000
	s_waitcnt vmcnt(10)
	s_cmp_eq_u32 s25, 0
	s_cbranch_scc1 slow_74
	buffer_store_dword v254, v16, s[8:11], s29 offen
back_75:
	ds_read_b128 v[56:59], v1 offset:0
	s_waitcnt lgkmcnt(3)
	v_mfma_f32_32x32x16_bf16 v[88:103], v[60:63], a[88:91], v[88:103]
	ds_read_b128 v[60:63], v1 offset:1024
	s_waitcnt lgkmcnt(3)
	v_mfma_f32_32x32x16_bf16 v[72:87], v[64:67], a[92:95], v[72:87]
	buffer_load_dwordx4 a[16:19], v1, s[8:11], s94 offen offset:2048
	ds_read_b128 v[64:67], v1 offset:2048
	s_waitcnt lgkmcnt(3)
	v_mfma_f32_32x32x16_bf16 v[88:103], v[68:71], a[92:95], v[88:103]
	ds_read_b128 v[68:71], v1 offset:3072
	s_waitcnt lgkmcnt(3)
	v_mfma_f32_32x32x16_bf16 v[72:87], v[56:59], a[96:99], v[72:87]
	ds_read_b128 v[56:59], v1 offset:4096
	s_waitcnt lgkmcnt(3)
	v_mfma_f32_32x32x16_bf16 v[88:103], v[60:63], a[96:99], v[88:103]
	ds_read_b128 v[60:63], v1 offset:5120
	s_waitcnt lgkmcnt(3)
	v_mfma_f32_32x32x16_bf16 v[72:87], v[64:67], a[100:103], v[72:87]
	ds_read_b128 v[64:67], v1 offset:6144
	s_waitcnt lgkmcnt(3)
	v_mfma_f32_32x32x16_bf16 v[88:103], v[68:71], a[100:103], v[88:103]
	buffer_load_dwordx4 a[20:23], v1, s[8:11], s94 offen offset:3072
	ds_read_b128 v[68:71], v1 offset:7168
	s_waitcnt lgkmcnt(3)
	v_mfma_f32_32x32x16_bf16 v[72:87], v[56:59], a[104:107], v[72:87]
	ds_read_b128 v[56:59], v1 offset:8192
	s_waitcnt lgkmcnt(3)
	v_mfma_f32_32x32x16_bf16 v[88:103], v[60:63], a[104:107], v[88:103]
	s_add_u32 s94, s33, 0xb000
	buffer_load_dwordx4 a[24:27], v1, s[8:11], s94 offen offset:0
	ds_read_b128 v[60:63], v1 offset:9216
	s_waitcnt lgkmcnt(3)
	v_mfma_f32_32x32x16_bf16 v[72:87], v[64:67], a[108:111], v[72:87]
	ds_read_b128 v[64:67], v1 offset:10240
	s_waitcnt lgkmcnt(3)
	v_mfma_f32_32x32x16_bf16 v[88:103], v[68:71], a[108:111], v[88:103]
	s_add_u32 s94, s33, 0xd000
	buffer_load_dwordx4 a[28:31], v1, s[8:11], s94 offen offset:3072
	ds_read_b128 v[68:71], v1 offset:11264
	s_waitcnt lgkmcnt(3)
	v_mfma_f32_32x32x16_bf16 v[72:87], v[56:59], a[112:115], v[72:87]
	ds_read_b128 v[56:59], v1 offset:12288
	s_waitcnt lgkmcnt(3)
	v_mfma_f32_32x32x16_bf16 v[88:103], v[60:63], a[112:115], v[88:103]
	s_add_u32 s94, s33, 0xe000
	buffer_load_dwordx4 a[32:35], v1, s[8:11], s94 offen offset:0
	ds_read_b128 v[60:63], v1 offset:13312
	s_waitcnt lgkmcnt(3)
	v_mfma_f32_32x32x16_bf16 v[72:87], v[64:67], a[116:119], v[72:87]
	ds_read_b128 v[64:67], v1 offset:14336
	s_waitcnt lgkmcnt(3)
	v_mfma_f32_32x32x16_bf16 v[88:103], v[68:71], a[116:119], v[88:103]
	buffer_load_dwordx4 a[36:39], v1, s[8:11], s94 offen offset:1024
	ds_read_b128 v[68:71], v1 offset:15360
	s_waitcnt lgkmcnt(3)
	v_mfma_f32_32x32x16_bf16 v[72:87], v[56:59], a[120:123], v[72:87]
	s_waitcnt vmcnt(15)
	s_barrier
	ds_read_b128 v[56:59], v1 offset:16384
	s_waitcnt lgkmcnt(3)
	v_mfma_f32_32x32x16_bf16 v[88:103], v[60:63], a[120:123], v[88:103]
	buffer_load_dwordx4 a[40:43], v1, s[8:11], s94 offen offset:2048
	ds_read_b128 v[60:63], v1 offset:17408
	s_waitcnt lgkmcnt(3)
	v_mfma_f32_32x32x16_bf16 v[72:87], v[64:67], a[124:127], v[72:87]
	ds_read_b128 v[64:67], v1 offset:18432
	s_waitcnt lgkmcnt(3)
	v_mfma_f32_32x32x16_bf16 v[88:103], v[68:71], a[124:127], v[88:103]
	ds_read_b128 v[68:71], v1 offset:19456
	s_waitcnt lgkmcnt(3)
	v_mfma_f32_32x32x16_bf16 v[72:87], v[56:59], a[128:131], v[72:87]
	buffer_load_dwordx4 a[44:47], v1, s[8:11], s94 offen offset:3072
	ds_read_b128 v[56:59], v1 offset:20480
	s_waitcnt lgkmcnt(3)
	v_mfma_f32_32x32x16_bf16 v[88:103], v[60:63], a[128:131], v[88:103]
	ds_read_b128 v[60:63], v1 offset:21504
	s_waitcnt lgkmcnt(3)
	v_mfma_f32_32x32x16_bf16 v[72:87], v[64:67], a[132:135], v[72:87]
	s_add_u32 s29, s38, 0x261e000
	buffer_load_dword v255, v14, s[8:11], s29 offen sc1
	ds_read_b128 v[64:67], v1 offset:22528
	s_waitcnt lgkmcnt(3)
	v_mfma_f32_32x32x16_bf16 v[88:103], v[68:71], a[132:135], v[88:103]
	ds_read_b128 v[68:71], v1 offset:23552
	s_waitcnt lgkmcnt(3)
	v_mfma_f32_32x32x16_bf16 v[72:87], v[56:59], a[136:139], v[72:87]
	ds_read_b128 v[56:59], v1 offset:24576
	s_waitcnt lgkmcnt(3)
	v_mfma_f32_32x32x16_bf16 v[88:103], v[60:63], a[136:139], v[88:103]
	ds_read_b128 v[60:63], v1 offset:25600
	s_waitcnt lgkmcnt(3)
	v_mfma_f32_32x32x16_bf16 v[72:87], v[64:67], a[140:143], v[72:87]
	ds_read_b128 v[64:67], v1 offset:26624
	s_waitcnt lgkmcnt(3)
	v_mfma_f32_32x32x16_bf16 v[88:103], v[68:71], a[140:143], v[88:103]
	ds_read_b128 v[68:71], v1 offset:27648
	s_waitcnt lgkmcnt(3)
	v_mfma_f32_32x32x16_bf16 v[72:87], v[56:59], a[144:147], v[72:87]
	ds_read_b128 v[56:59], v1 offset:28672
	s_waitcnt lgkmcnt(3)
	v_mfma_f32_32x32x16_bf16 v[88:103], v[60:63], a[144:147], v[88:103]
	ds_read_b128 v[60:63], v1 offset:29696
	s_waitcnt lgkmcnt(3)
	v_mfma_f32_32x32x16_bf16 v[72:87], v[64:67], a[148:151], v[72:87]
	ds_read_b128 v[64:67], v1 offset:30720
	s_waitcnt lgkmcnt(3)
	v_mfma_f32_32x32x16_bf16 v[88:103], v[68:71], a[148:151], v[88:103]
	ds_read_b128 v[68:71], v1 offset:31744
	s_waitcnt lgkmcnt(3)
	v_mfma_f32_32x32x16_bf16 v[72:87], v[56:59], a[152:155], v[72:87]
	s_waitcnt lgkmcnt(2)
	v_mfma_f32_32x32x16_bf16 v[88:103], v[60:63], a[152:155], v[88:103]
	s_waitcnt lgkmcnt(1)
	v_mfma_f32_32x32x16_bf16 v[72:87], v[64:67], a[156:159], v[72:87]
	s_waitcnt lgkmcnt(0)
	v_mfma_f32_32x32x16_bf16 v[88:103], v[68:71], a[156:159], v[88:103]
	s_waitcnt vmcnt(0)
	v_cmp_gt_u32 vcc, 2, v255
	s_cbranch_vccnz chkpoll_76
chkok_77:
	s_cmp_eq_u32 s25, 0
	s_cbranch_scc1 acq_78
acqb_79:
	s_nop 4
	v_max_f32 v72, 0, v72
	v_max_f32 v73, 0, v73
	v_pk_mul_f32 v[88:89], v[88:89], v[30:31] op_sel:[0,1] op_sel_hi:[1,1]
	v_pk_mul_f32 v[72:73], v[72:73], v[88:89]
	s_add_u32 s88, s52, 0x17e8000
	buffer_load_dwordx4 a[48:51], v1, s[8:11], s88 offen offset:0 sc1
	v_cvt_pk_bf16_f32 v144, v72, v73
	v_max_f32 v74, 0, v74
	v_max_f32 v75, 0, v75
	v_pk_mul_f32 v[90:91], v[90:91], v[30:31] op_sel:[0,1] op_sel_hi:[1,1]
	s_add_u32 s88, s53, 0x17e8000
	buffer_load_dwordx4 a[52:55], v1, s[8:11], s88 offen offset:0 sc1
	v_pk_mul_f32 v[74:75], v[74:75], v[90:91]
	v_cvt_pk_bf16_f32 v145, v74, v75
	v_max_f32 v76, 0, v76
	v_max_f32 v77, 0, v77
	s_add_u32 s88, s54, 0x17e8000
	buffer_load_dwordx4 a[56:59], v1, s[8:11], s88 offen offset:0 sc1
	v_pk_mul_f32 v[92:93], v[92:93], v[30:31] op_sel:[0,1] op_sel_hi:[1,1]
	v_pk_mul_f32 v[76:77], v[76:77], v[92:93]
	v_cvt_pk_bf16_f32 v146, v76, v77
	v_max_f32 v78, 0, v78
	s_add_u32 s88, s55, 0x17e8000
	buffer_load_dwordx4 a[60:63], v1, s[8:11], s88 offen offset:0 sc1
	v_max_f32 v79, 0, v79
	v_pk_mul_f32 v[94:95], v[94:95], v[30:31] op_sel:[0,1] op_sel_hi:[1,1]
	v_pk_mul_f32 v[78:79], v[78:79], v[94:95]
	v_cvt_pk_bf16_f32 v147, v78, v79
	s_add_u32 s88, s52, 0x17e8000
	buffer_load_dwordx4 a[64:67], v1, s[8:11], s88 offen offset:3072 sc1
	s_add_u32 s28, s43, 0x17e8000
	buffer_store_dwordx4 v[144:147], v11, s[8:11], s28 offen offset:2048
	v_max_f32 v80, 0, v80
	v_max_f32 v81, 0, v81
	v_pk_mul_f32 v[96:97], v[96:97], v[30:31] op_sel:[0,1] op_sel_hi:[1,1]
	s_add_u32 s88, s53, 0x17e8000
	buffer_load_dwordx4 a[68:71], v1, s[8:11], s88 offen offset:3072 sc1
	v_pk_mul_f32 v[80:81], v[80:81], v[96:97]
	v_cvt_pk_bf16_f32 v148, v80, v81
	v_max_f32 v82, 0, v82
	v_max_f32 v83, 0, v83
	s_add_u32 s88, s54, 0x17e8000
	buffer_load_dwordx4 a[72:75], v1, s[8:11], s88 offen offset:3072 sc1
	v_pk_mul_f32 v[98:99], v[98:99], v[30:31] op_sel:[0,1] op_sel_hi:[1,1]
	v_pk_mul_f32 v[82:83], v[82:83], v[98:99]
	v_cvt_pk_bf16_f32 v149, v82, v83
	v_max_f32 v84, 0, v84
	v_max_f32 v85, 0, v85
	v_pk_mul_f32 v[100:101], v[100:101], v[30:31] op_sel:[0,1] op_sel_hi:[1,1]
	v_pk_mul_f32 v[84:85], v[84:85], v[100:101]
	v_cvt_pk_bf16_f32 v150, v84, v85
	v_max_f32 v86, 0, v86
	v_max_f32 v87, 0, v87
	v_pk_mul_f32 v[102:103], v[102:103], v[30:31] op_sel:[0,1] op_sel_hi:[1,1]
	v_pk_mul_f32 v[86:87], v[86:87], v[102:103]
	v_cvt_pk_bf16_f32 v151, v86, v87
	s_add_u32 s28, s43, 0x17e8000
	buffer_store_dwordx4 v[148:151], v11, s[8:11], s28 offen offset:2560
	s_waitcnt vmcnt(8)
	v_mfma_f32_16x16x32_bf16 v[72:75], v[152:155], a[48:51], 0
	v_mfma_f32_16x16x32_bf16 v[76:79], v[156:159], a[48:51], 0
	v_mfma_f32_16x16x32_bf16 v[80:83], v[160:163], a[48:51], 0
	v_mfma_f32_16x16x32_bf16 v[84:87], v[164:167], a[48:51], 0
	v_mfma_f32_16x16x32_bf16 v[88:91], v[168:171], a[48:51], 0
	s_add_u32 s88, s55, 0x17e8000
	buffer_load_dwordx4 a[76:79], v1, s[8:11], s88 offen offset:3072 sc1
	s_waitcnt vmcnt(8)
	v_mfma_f32_16x16x32_bf16 v[92:95], v[152:155], a[52:55], 0
	v_mfma_f32_16x16x32_bf16 v[96:99], v[156:159], a[52:55], 0
	v_mfma_f32_16x16x32_bf16 v[100:103], v[160:163], a[52:55], 0
	v_mfma_f32_16x16x32_bf16 v[104:107], v[164:167], a[52:55], 0
	v_mfma_f32_16x16x32_bf16 v[108:111], v[168:171], a[52:55], 0
	s_add_u32 s88, s52, 0x17e9000
	buffer_load_dwordx4 a[80:83], v1, s[8:11], s88 offen offset:2048 sc1
	s_waitcnt vmcnt(8)
	v_mfma_f32_16x16x32_bf16 v[112:115], v[152:155], a[56:59], 0
	v_mfma_f32_16x16x32_bf16 v[116:119], v[156:159], a[56:59], 0
	v_mfma_f32_16x16x32_bf16 v[120:123], v[160:163], a[56:59], 0
	v_mfma_f32_16x16x32_bf16 v[124:127], v[164:167], a[56:59], 0
	v_mfma_f32_16x16x32_bf16 v[128:131], v[168:171], a[56:59], 0
	s_add_u32 s88, s53, 0x17e9000
	buffer_load_dwordx4 a[84:87], v1, s[8:11], s88 offen offset:2048 sc1
	s_waitcnt vmcnt(8)
	v_mfma_f32_16x16x32_bf16 v[132:135], v[152:155], a[60:63], 0
	v_mfma_f32_16x16x32_bf16 v[136:139], v[156:159], a[60:63], 0
	v_mfma_f32_16x16x32_bf16 v[140:143], v[160:163], a[60:63], 0
	s_add_u32 s88, s54, 0x17e9000
	buffer_load_dwordx4 a[88:91], v1, s[8:11], s88 offen offset:2048 sc1
	v_mfma_f32_16x16x32_bf16 v[144:147], v[164:167], a[60:63], 0
	v_mfma_f32_16x16x32_bf16 v[148:151], v[168:171], a[60:63], 0
	s_waitcnt vmcnt(8)
	v_mfma_f32_16x16x32_bf16 v[72:75], v[172:175], a[64:67], v[72:75]
	v_mfma_f32_16x16x32_bf16 v[76:79], v[176:179], a[64:67], v[76:79]
	v_mfma_f32_16x16x32_bf16 v[80:83], v[180:183], a[64:67], v[80:83]
	v_mfma_f32_16x16x32_bf16 v[84:87], v[184:187], a[64:67], v[84:87]
	v_mfma_f32_16x16x32_bf16 v[88:91], v[188:191], a[64:67], v[88:91]
	s_add_u32 s88, s55, 0x17e9000
	buffer_load_dwordx4 a[92:95], v1, s[8:11], s88 offen offset:2048 sc1
	s_waitcnt vmcnt(7)
	v_mfma_f32_16x16x32_bf16 v[92:95], v[172:175], a[68:71], v[92:95]
	s_add_u32 s88, s52, 0x17ea000
	buffer_load_dwordx4 a[96:99], v1, s[8:11], s88 offen offset:1024 sc1
	v_mfma_f32_16x16x32_bf16 v[96:99], v[176:179], a[68:71], v[96:99]
	v_mfma_f32_16x16x32_bf16 v[100:103], v[180:183], a[68:71], v[100:103]
	v_mfma_f32_16x16x32_bf16 v[104:107], v[184:187], a[68:71], v[104:107]
	v_mfma_f32_16x16x32_bf16 v[108:111], v[188:191], a[68:71], v[108:111]
	s_add_u32 s88, s53, 0x17ea000
	buffer_load_dwordx4 a[100:103], v1, s[8:11], s88 offen offset:1024 sc1
	s_waitcnt vmcnt(8)
	v_mfma_f32_16x16x32_bf16 v[112:115], v[172:175], a[72:75], v[112:115]
	v_mfma_f32_16x16x32_bf16 v[116:119], v[176:179], a[72:75], v[116:119]
	v_mfma_f32_16x16x32_bf16 v[120:123], v[180:183], a[72:75], v[120:123]
	v_mfma_f32_16x16x32_bf16 v[124:127], v[184:187], a[72:75], v[124:127]
	v_mfma_f32_16x16x32_bf16 v[128:131], v[188:191], a[72:75], v[128:131]
	s_add_u32 s88, s54, 0x17ea000
	buffer_load_dwordx4 a[104:107], v1, s[8:11], s88 offen offset:1024 sc1
	s_waitcnt vmcnt(7)
	v_mfma_f32_16x16x32_bf16 v[132:135], v[172:175], a[76:79], v[132:135]
	s_add_u32 s88, s55, 0x17ea000
	buffer_load_dwordx4 a[108:111], v1, s[8:11], s88 offen offset:1024 sc1
	v_mfma_f32_16x16x32_bf16 v[136:139], v[176:179], a[76:79], v[136:139]
	v_mfma_f32_16x16x32_bf16 v[140:143], v[180:183], a[76:79], v[140:143]
	v_mfma_f32_16x16x32_bf16 v[144:147], v[184:187], a[76:79], v[144:147]
	v_mfma_f32_16x16x32_bf16 v[148:151], v[188:191], a[76:79], v[148:151]
	s_add_u32 s88, s52, 0x17e8000
	buffer_load_dwordx4 a[112:115], v1, s[8:11], s88 offen offset:1024 sc1
	s_waitcnt vmcnt(8)
	v_mfma_f32_16x16x32_bf16 v[72:75], v[192:195], a[80:83], v[72:75]
	v_mfma_f32_16x16x32_bf16 v[76:79], v[196:199], a[80:83], v[76:79]
	v_mfma_f32_16x16x32_bf16 v[80:83], v[200:203], a[80:83], v[80:83]
	v_mfma_f32_16x16x32_bf16 v[84:87], v[204:207], a[80:83], v[84:87]
	v_mfma_f32_16x16x32_bf16 v[88:91], v[208:211], a[80:83], v[88:91]
	s_add_u32 s88, s53, 0x17e8000
	buffer_load_dwordx4 a[116:119], v1, s[8:11], s88 offen offset:1024 sc1
	s_waitcnt vmcnt(8)
	v_mfma_f32_16x16x32_bf16 v[92:95], v[192:195], a[84:87], v[92:95]
	v_mfma_f32_16x16x32_bf16 v[96:99], v[196:199], a[84:87], v[96:99]
	v_mfma_f32_16x16x32_bf16 v[100:103], v[200:203], a[84:87], v[100:103]
	v_mov_b32 v254, 3
	s_add_u32 s29, s44, 0x261e000
	s_cmp_eq_u32 s25, 0
	s_cbranch_scc1 slow_80
	buffer_store_dword v254, v16, s[8:11], s29 offen
back_81:
	s_add_u32 s88, s54, 0x17e8000
	buffer_load_dwordx4 a[120:123], v1, s[8:11], s88 offen offset:1024 sc1
	v_mfma_f32_16x16x32_bf16 v[104:107], v[204:207], a[84:87], v[104:107]
	v_mfma_f32_16x16x32_bf16 v[108:111], v[208:211], a[84:87], v[108:111]
	s_waitcnt vmcnt(9)
	v_mfma_f32_16x16x32_bf16 v[112:115], v[192:195], a[88:91], v[112:115]
	v_mfma_f32_16x16x32_bf16 v[116:119], v[196:199], a[88:91], v[116:119]
	v_mfma_f32_16x16x32_bf16 v[120:123], v[200:203], a[88:91], v[120:123]
	s_add_u32 s88, s55, 0x17e8000
	buffer_load_dwordx4 a[124:127], v1, s[8:11], s88 offen offset:1024 sc1
	v_mfma_f32_16x16x32_bf16 v[124:127], v[204:207], a[88:91], v[124:127]
	v_mfma_f32_16x16x32_bf16 v[128:131], v[208:211], a[88:91], v[128:131]
	s_waitcnt vmcnt(9)
	v_mfma_f32_16x16x32_bf16 v[132:135], v[192:195], a[92:95], v[132:135]
	s_add_u32 s88, s52, 0x17e9000
	buffer_load_dwordx4 a[128:131], v1, s[8:11], s88 offen offset:0 sc1
	v_mfma_f32_16x16x32_bf16 v[136:139], v[196:199], a[92:95], v[136:139]
	v_mfma_f32_16x16x32_bf16 v[140:143], v[200:203], a[92:95], v[140:143]
	v_mfma_f32_16x16x32_bf16 v[144:147], v[204:207], a[92:95], v[144:147]
	v_mfma_f32_16x16x32_bf16 v[148:151], v[208:211], a[92:95], v[148:151]
	s_add_u32 s88, s53, 0x17e9000
	buffer_load_dwordx4 a[132:135], v1, s[8:11], s88 offen offset:0 sc1
	s_waitcnt vmcnt(10)
	v_mfma_f32_16x16x32_bf16 v[72:75], v[212:215], a[96:99], v[72:75]
	v_mfma_f32_16x16x32_bf16 v[76:79], v[216:219], a[96:99], v[76:79]
	v_mfma_f32_16x16x32_bf16 v[80:83], v[220:223], a[96:99], v[80:83]
	v_mfma_f32_16x16x32_bf16 v[84:87], v[224:227], a[96:99], v[84:87]
	v_mfma_f32_16x16x32_bf16 v[88:91], v[228:231], a[96:99], v[88:91]
	s_add_u32 s88, s54, 0x17e9000
	buffer_load_dwordx4 a[136:139], v1, s[8:11], s88 offen offset:0 sc1
	s_waitcnt vmcnt(10)
	v_mfma_f32_16x16x32_bf16 v[92:95], v[212:215], a[100:103], v[92:95]
	v_mfma_f32_16x16x32_bf16 v[96:99], v[216:219], a[100:103], v[96:99]
	v_mfma_f32_16x16x32_bf16 v[100:103], v[220:223], a[100:103], v[100:103]
	v_mfma_f32_16x16x32_bf16 v[104:107], v[224:227], a[100:103], v[104:107]
	v_mfma_f32_16x16x32_bf16 v[108:111], v[228:231], a[100:103], v[108:111]
	s_add_u32 s88, s55, 0x17e9000
	buffer_load_dwordx4 a[140:143], v1, s[8:11], s88 offen offset:0 sc1
	s_waitcnt vmcnt(10)
	v_mfma_f32_16x16x32_bf16 v[112:115], v[212:215], a[104:107], v[112:115]
	v_mfma_f32_16x16x32_bf16 v[116:119], v[216:219], a[104:107], v[116:119]
	v_mfma_f32_16x16x32_bf16 v[120:123], v[220:223], a[104:107], v[120:123]
	s_add_u32 s88, s52, 0x17e9000
	buffer_load_dwordx4 a[144:147], v1, s[8:11], s88 offen offset:3072 sc1
	v_mfma_f32_16x16x32_bf16 v[124:127], v[224:227], a[104:107], v[124:127]
	v_mfma_f32_16x16x32_bf16 v[128:131], v[228:231], a[104:107], v[128:131]
	s_waitcnt vmcnt(10)
	v_mfma_f32_16x16x32_bf16 v[132:135], v[212:215], a[108:111], v[132:135]
	v_mfma_f32_16x16x32_bf16 v[136:139], v[216:219], a[108:111], v[136:139]
	v_mfma_f32_16x16x32_bf16 v[140:143], v[220:223], a[108:111], v[140:143]
	s_add_u32 s29, s38, 0x261e000
	buffer_load_dword v255, v14, s[8:11], s29 offen sc1
	s_add_u32 s88, s53, 0x17e9000
	buffer_load_dwordx4 a[148:151], v1, s[8:11], s88 offen offset:3072 sc1
	v_mfma_f32_16x16x32_bf16 v[144:147], v[224:227], a[108:111], v[144:147]
	v_mfma_f32_16x16x32_bf16 v[148:151], v[228:231], a[108:111], v[148:151]
	s_waitcnt vmcnt(11)
	v_mfma_f32_16x16x32_bf16 v[72:75], v[232:235], a[112:115], v[72:75]
	v_mfma_f32_16x16x32_bf16 v[76:79], v[236:239], a[112:115], v[76:79]
	v_mfma_f32_16x16x32_bf16 v[80:83], v[240:243], a[112:115], v[80:83]
	s_add_u32 s88, s54, 0x17e9000
	buffer_load_dwordx4 a[152:155], v1, s[8:11], s88 offen offset:3072 sc1
	v_mfma_f32_16x16x32_bf16 v[84:87], v[244:247], a[112:115], v[84:87]
	v_mfma_f32_16x16x32_bf16 v[88:91], a[160:163], a[112:115], v[88:91]
	s_waitcnt vmcnt(11)
	v_mfma_f32_16x16x32_bf16 v[92:95], v[232:235], a[116:119], v[92:95]
	s_add_u32 s88, s55, 0x17e9000
	buffer_load_dwordx4 a[156:159], v1, s[8:11], s88 offen offset:3072 sc1
	v_mfma_f32_16x16x32_bf16 v[96:99], v[236:239], a[116:119], v[96:99]
	v_mfma_f32_16x16x32_bf16 v[100:103], v[240:243], a[116:119], v[100:103]
	v_mfma_f32_16x16x32_bf16 v[104:107], v[244:247], a[116:119], v[104:107]
	v_mfma_f32_16x16x32_bf16 v[108:111], a[160:163], a[116:119], v[108:111]
	s_add_u32 s88, s52, 0x17ea000
	buffer_load_dwordx4 a[48:51], v1, s[8:11], s88 offen offset:2048 sc1
	s_waitcnt vmcnt(11)
	v_mfma_f32_16x16x32_bf16 v[112:115], v[232:235], a[120:123], v[112:115]
	v_mfma_f32_16x16x32_bf16 v[116:119], v[236:239], a[120:123], v[116:119]
	v_mfma_f32_16x16x32_bf16 v[120:123], v[240:243], a[120:123], v[120:123]
	v_mfma_f32_16x16x32_bf16 v[124:127], v[244:247], a[120:123], v[124:127]
	v_mfma_f32_16x16x32_bf16 v[128:131], a[160:163], a[120:123], v[128:131]
	s_add_u32 s88, s53, 0x17ea000
	buffer_load_dwordx4 a[52:55], v1, s[8:11], s88 offen offset:2048 sc1
	s_waitcnt vmcnt(11)
	v_mfma_f32_16x16x32_bf16 v[132:135], v[232:235], a[124:127], v[132:135]
	v_mfma_f32_16x16x32_bf16 v[136:139], v[236:239], a[124:127], v[136:139]
	v_mfma_f32_16x16x32_bf16 v[140:143], v[240:243], a[124:127], v[140:143]
	v_mfma_f32_16x16x32_bf16 v[144:147], v[244:247], a[124:127], v[144:147]
	v_mfma_f32_16x16x32_bf16 v[148:151], a[160:163], a[124:127], v[148:151]
	s_waitcnt vmcnt(5)
	v_cmp_gt_u32 vcc, 3, v255
	s_cbranch_vccnz chkpoll_82
chkok_83:
	s_cmp_eq_u32 s25, 0
	s_cbranch_scc1 acq_84
acqb_85:
	s_add_u32 s88, s54, 0x17ea000
	buffer_load_dwordx4 a[56:59], v1, s[8:11], s88 offen offset:2048 sc1
	v_mfma_f32_16x16x32_bf16 v[72:75], a[164:167], a[128:131], v[72:75]
	s_add_u32 s88, s55, 0x17ea000
	buffer_load_dwordx4 a[60:63], v1, s[8:11], s88 offen offset:2048 sc1
	v_mfma_f32_16x16x32_bf16 v[76:79], a[168:171], a[128:131], v[76:79]
	v_mfma_f32_16x16x32_bf16 v[80:83], a[172:175], a[128:131], v[80:83]
	s_add_u32 s88, s52, 0x17e8000
	buffer_load_dwordx4 a[64:67], v1, s[8:11], s88 offen offset:2048 sc1
	v_mfma_f32_16x16x32_bf16 v[84:87], a[176:179], a[128:131], v[84:87]
	v_mfma_f32_16x16x32_bf16 v[88:91], a[180:183], a[128:131], v[88:91]
	s_add_u32 s88, s53, 0x17e8000
	buffer_load_dwordx4 a[68:71], v1, s[8:11], s88 offen offset:2048 sc1
	v_mfma_f32_16x16x32_bf16 v[92:95], a[164:167], a[132:135], v[92:95]
	s_add_u32 s88, s54, 0x17e8000
	buffer_load_dwordx4 a[72:75], v1, s[8:11], s88 offen offset:2048 sc1
	v_mfma_f32_16x16x32_bf16 v[96:99], a[168:171], a[132:135], v[96:99]
	v_mfma_f32_16x16x32_bf16 v[100:103], a[172:175], a[132:135], v[100:103]
	v_mfma_f32_16x16x32_bf16 v[104:107], a[176:179], a[132:135], v[104:107]
	v_mfma_f32_16x16x32_bf16 v[108:111], a[180:183], a[132:135], v[108:111]
	s_add_u32 s88, s55, 0x17e8000
	buffer_load_dwordx4 a[76:79], v1, s[8:11], s88 offen offset:2048 sc1
	v_mfma_f32_16x16x32_bf16 v[112:115], a[164:167], a[136:139], v[112:115]
	v_mfma_f32_16x16x32_bf16 v[116:119], a[168:171], a[136:139], v[116:119]
	v_mfma_f32_16x16x32_bf16 v[120:123], a[172:175], a[136:139], v[120:123]
	v_mfma_f32_16x16x32_bf16 v[124:127], a[176:179], a[136:139], v[124:127]
	v_mfma_f32_16x16x32_bf16 v[128:131], a[180:183], a[136:139], v[128:131]
	s_add_u32 s88, s52, 0x17e9000
	buffer_load_dwordx4 a[80:83], v1, s[8:11], s88 offen offset:1024 sc1
	v_mfma_f32_16x16x32_bf16 v[132:135], a[164:167], a[140:143], v[132:135]
	v_mfma_f32_16x16x32_bf16 v[136:139], a[168:171], a[140:143], v[136:139]
	v_mfma_f32_16x16x32_bf16 v[140:143], a[172:175], a[140:143], v[140:143]
	s_add_u32 s88, s53, 0x17e9000
	buffer_load_dwordx4 a[84:87], v1, s[8:11], s88 offen offset:1024 sc1
	v_mfma_f32_16x16x32_bf16 v[144:147], a[176:179], a[140:143], v[144:147]
	v_mfma_f32_16x16x32_bf16 v[148:151], a[180:183], a[140:143], v[148:151]
	v_mfma_f32_16x16x32_bf16 v[72:75], a[184:187], a[144:147], v[72:75]
	v_mfma_f32_16x16x32_bf16 v[76:79], a[188:191], a[144:147], v[76:79]
	v_mfma_f32_16x16x32_bf16 v[80:83], a[192:195], a[144:147], v[80:83]
	s_add_u32 s88, s54, 0x17e9000
	buffer_load_dwordx4 a[88:91], v1, s[8:11], s88 offen offset:1024 sc1
	v_mfma_f32_16x16x32_bf16 v[84:87], a[196:199], a[144:147], v[84:87]
	v_mfma_f32_16x16x32_bf16 v[88:91], a[200:203], a[144:147], v[88:91]
	s_waitcnt vmcnt(13)
	v_mfma_f32_16x16x32_bf16 v[92:95], a[184:187], a[148:151], v[92:95]
	v_mfma_f32_16x16x32_bf16 v[96:99], a[188:191], a[148:151], v[96:99]
	v_mfma_f32_16x16x32_bf16 v[100:103], a[192:195], a[148:151], v[100:103]
	s_add_u32 s88, s55, 0x17e9000
	buffer_load_dwordx4 a[92:95], v1, s[8:11], s88 offen offset:1024 sc1
	v_mfma_f32_16x16x32_bf16 v[104:107], a[196:199], a[148:151], v[104:107]
	v_mfma_f32_16x16x32_bf16 v[108:111], a[200:203], a[148:151], v[108:111]
	s_waitcnt vmcnt(13)
	v_mfma_f32_16x16x32_bf16 v[112:115], a[184:187], a[152:155], v[112:115]
	s_add_u32 s88, s53, 0x17ea000
	buffer_load_dwordx4 a[100:103], v1, s[8:11], s88 offen offset:0 sc1
	v_mfma_f32_16x16x32_bf16 v[116:119], a[188:191], a[152:155], v[116:119]
	v_mfma_f32_16x16x32_bf16 v[120:123], a[192:195], a[152:155], v[120:123]
	v_mfma_f32_16x16x32_bf16 v[124:127], a[196:199], a[152:155], v[124:127]
	v_mfma_f32_16x16x32_bf16 v[128:131], a[200:203], a[152:155], v[128:131]
	s_add_u32 s88, s54, 0x17ea000
	buffer_load_dwordx4 a[104:107], v1, s[8:11], s88 offen offset:0 sc1
	s_waitcnt vmcnt(14)
	v_mfma_f32_16x16x32_bf16 v[132:135], a[184:187], a[156:159], v[132:135]
	v_mfma_f32_16x16x32_bf16 v[136:139], a[188:191], a[156:159], v[136:139]
	v_mfma_f32_16x16x32_bf16 v[140:143], a[192:195], a[156:159], v[140:143]
	v_mfma_f32_16x16x32_bf16 v[144:147], a[196:199], a[156:159], v[144:147]
	v_mfma_f32_16x16x32_bf16 v[148:151], a[200:203], a[156:159], v[148:151]
	s_add_u32 s88, s55, 0x17ea000
	buffer_load_dwordx4 a[108:111], v1, s[8:11], s88 offen offset:0 sc1
	s_waitcnt vmcnt(14)
	v_mfma_f32_16x16x32_bf16 v[72:75], a[204:207], a[48:51], v[72:75]
	v_mfma_f32_16x16x32_bf16 v[76:79], a[208:211], a[48:51], v[76:79]
	v_mfma_f32_16x16x32_bf16 v[80:83], a[212:215], a[48:51], v[80:83]
	v_mfma_f32_16x16x32_bf16 v[84:87], a[216:219], a[48:51], v[84:87]
	v_mfma_f32_16x16x32_bf16 v[88:91], a[220:223], a[48:51], v[88:91]
	s_add_u32 s88, s52, 0x17ea000
	buffer_load_dwordx4 a[96:99], v1, s[8:11], s88 offen offset:0 sc1
	s_waitcnt vmcnt(14)
	v_mfma_f32_16x16x32_bf16 v[92:95], a[204:207], a[52:55], v[92:95]
	v_mfma_f32_16x16x32_bf16 v[96:99], a[208:211], a[52:55], v[96:99]
	v_mfma_f32_16x16x32_bf16 v[100:103], a[212:215], a[52:55], v[100:103]
	s_add_u32 s88, s53, 0x17ea000
	buffer_load_dwordx4 a[116:119], v1, s[8:11], s88 offen offset:3072 sc1
	v_mfma_f32_16x16x32_bf16 v[104:107], a[216:219], a[52:55], v[104:107]
	v_mfma_f32_16x16x32_bf16 v[108:111], a[220:223], a[52:55], v[108:111]
	s_waitcnt vmcnt(14)
	v_mfma_f32_16x16x32_bf16 v[112:115], a[204:207], a[56:59], v[112:115]
	v_mfma_f32_16x16x32_bf16 v[116:119], a[208:211], a[56:59], v[116:119]
	v_mfma_f32_16x16x32_bf16 v[120:123], a[212:215], a[56:59], v[120:123]
	s_add_u32 s88, s54, 0x17ea000
	buffer_load_dwordx4 a[120:123], v1, s[8:11], s88 offen offset:3072 sc1
	v_mfma_f32_16x16x32_bf16 v[124:127], a[216:219], a[56:59], v[124:127]
	v_mfma_f32_16x16x32_bf16 v[128:131], a[220:223], a[56:59], v[128:131]
	s_waitcnt vmcnt(14)
	v_mfma_f32_16x16x32_bf16 v[132:135], a[204:207], a[60:63], v[132:135]
	s_add_u32 s88, s55, 0x17ea000
	buffer_load_dwordx4 a[124:127], v1, s[8:11], s88 offen offset:3072 sc1
	v_mfma_f32_16x16x32_bf16 v[136:139], a[208:211], a[60:63], v[136:139]
	v_mfma_f32_16x16x32_bf16 v[140:143], a[212:215], a[60:63], v[140:143]
	v_mfma_f32_16x16x32_bf16 v[144:147], a[216:219], a[60:63], v[144:147]
	v_mfma_f32_16x16x32_bf16 v[148:151], a[220:223], a[60:63], v[148:151]
	s_waitcnt vmcnt(14)
	v_mfma_f32_16x16x32_bf16 v[72:75], a[224:227], a[64:67], v[72:75]
	s_add_u32 s88, s52, 0x17ea000
	buffer_load_dwordx4 a[112:115], v1, s[8:11], s88 offen offset:3072 sc1
	v_mfma_f32_16x16x32_bf16 v[76:79], a[228:231], a[64:67], v[76:79]
	v_mfma_f32_16x16x32_bf16 v[80:83], a[232:235], a[64:67], v[80:83]
	v_mfma_f32_16x16x32_bf16 v[84:87], a[236:239], a[64:67], v[84:87]
	v_mfma_f32_16x16x32_bf16 v[88:91], a[240:243], a[64:67], v[88:91]
	s_waitcnt vmcnt(14)
	v_mfma_f32_16x16x32_bf16 v[92:95], a[224:227], a[68:71], v[92:95]
	v_mfma_f32_16x16x32_bf16 v[96:99], a[228:231], a[68:71], v[96:99]
	v_mfma_f32_16x16x32_bf16 v[100:103], a[232:235], a[68:71], v[100:103]
	v_mfma_f32_16x16x32_bf16 v[104:107], a[236:239], a[68:71], v[104:107]
	v_mfma_f32_16x16x32_bf16 v[108:111], a[240:243], a[68:71], v[108:111]
	s_waitcnt vmcnt(13)
	v_mfma_f32_16x16x32_bf16 v[112:115], a[224:227], a[72:75], v[112:115]
	v_mfma_f32_16x16x32_bf16 v[116:119], a[228:231], a[72:75], v[116:119]
	v_mfma_f32_16x16x32_bf16 v[120:123], a[232:235], a[72:75], v[120:123]
	v_mfma_f32_16x16x32_bf16 v[124:127], a[236:239], a[72:75], v[124:127]
	v_mfma_f32_16x16x32_bf16 v[128:131], a[240:243], a[72:75], v[128:131]
	s_waitcnt vmcnt(12)
	v_mfma_f32_16x16x32_bf16 v[132:135], a[224:227], a[76:79], v[132:135]
	v_mfma_f32_16x16x32_bf16 v[136:139], a[228:231], a[76:79], v[136:139]
	v_mfma_f32_16x16x32_bf16 v[140:143], a[232:235], a[76:79], v[140:143]
	v_mfma_f32_16x16x32_bf16 v[144:147], a[236:239], a[76:79], v[144:147]
	v_mfma_f32_16x16x32_bf16 v[148:151], a[240:243], a[76:79], v[148:151]
	s_waitcnt vmcnt(11)
	v_mfma_f32_16x16x32_bf16 v[72:75], a[244:247], a[80:83], v[72:75]
	v_mfma_f32_16x16x32_bf16 v[76:79], a[248:251], a[80:83], v[76:79]
	v_mfma_f32_16x16x32_bf16 v[80:83], a[252:255], a[80:83], v[80:83]
	v_mfma_f32_16x16x32_bf16 v[84:87], a[0:3], a[80:83], v[84:87]
	v_mfma_f32_16x16x32_bf16 v[88:91], a[4:7], a[80:83], v[88:91]
	s_waitcnt vmcnt(10)
	v_mfma_f32_16x16x32_bf16 v[92:95], a[244:247], a[84:87], v[92:95]
	v_mfma_f32_16x16x32_bf16 v[96:99], a[248:251], a[84:87], v[96:99]
	v_mfma_f32_16x16x32_bf16 v[100:103], a[252:255], a[84:87], v[100:103]
	v_mfma_f32_16x16x32_bf16 v[104:107], a[0:3], a[84:87], v[104:107]
	v_mfma_f32_16x16x32_bf16 v[108:111], a[4:7], a[84:87], v[108:111]
	s_waitcnt vmcnt(9)
	v_mfma_f32_16x16x32_bf16 v[112:115], a[244:247], a[88:91], v[112:115]
	v_mfma_f32_16x16x32_bf16 v[116:119], a[248:251], a[88:91], v[116:119]
	v_mfma_f32_16x16x32_bf16 v[120:123], a[252:255], a[88:91], v[120:123]
	v_mfma_f32_16x16x32_bf16 v[124:127], a[0:3], a[88:91], v[124:127]
	v_mfma_f32_16x16x32_bf16 v[128:131], a[4:7], a[88:91], v[128:131]
	s_waitcnt vmcnt(8)
	v_mfma_f32_16x16x32_bf16 v[132:135], a[244:247], a[92:95], v[132:135]
	v_mfma_f32_16x16x32_bf16 v[136:139], a[248:251], a[92:95], v[136:139]
	v_mfma_f32_16x16x32_bf16 v[140:143], a[252:255], a[92:95], v[140:143]
	v_mfma_f32_16x16x32_bf16 v[144:147], a[0:3], a[92:95], v[144:147]
	v_mfma_f32_16x16x32_bf16 v[148:151], a[4:7], a[92:95], v[148:151]
	s_waitcnt vmcnt(0)
	s_cmp_lg_u32 s44, s38
	s_cbranch_scc1 nowb_86
	s_bitcmp1_b32 s21, 0
	s_cbranch_scc1 nowb_86
	buffer_wbl2 sc1
nowb_86:
	v_mfma_f32_16x16x32_bf16 v[92:95], a[8:11], a[100:103], v[92:95]
	v_mfma_f32_16x16x32_bf16 v[96:99], a[12:15], a[100:103], v[96:99]
	v_mfma_f32_16x16x32_bf16 v[100:103], a[16:19], a[100:103], v[100:103]
	v_mfma_f32_16x16x32_bf16 v[104:107], a[20:23], a[100:103], v[104:107]
	v_mfma_f32_16x16x32_bf16 v[108:111], a[24:27], a[100:103], v[108:111]
	v_mfma_f32_16x16x32_bf16 v[92:95], a[28:31], a[116:119], v[92:95]
	v_mfma_f32_16x16x32_bf16 v[96:99], a[32:35], a[116:119], v[96:99]
	v_mfma_f32_16x16x32_bf16 v[100:103], a[36:39], a[116:119], v[100:103]
	v_mfma_f32_16x16x32_bf16 v[104:107], a[40:43], a[116:119], v[104:107]
	v_mfma_f32_16x16x32_bf16 v[108:111], a[44:47], a[116:119], v[108:111]
	v_mfma_f32_16x16x32_bf16 v[112:115], a[8:11], a[104:107], v[112:115]
	s_nop 2
	ds_write_b64 v28, v[92:93] offset:0
	v_mfma_f32_16x16x32_bf16 v[116:119], a[12:15], a[104:107], v[116:119]
	ds_write_b64 v28, v[94:95] offset:8
	v_mfma_f32_16x16x32_bf16 v[120:123], a[16:19], a[104:107], v[120:123]
	ds_write_b64 v28, v[96:97] offset:1024
	v_mfma_f32_16x16x32_bf16 v[124:127], a[20:23], a[104:107], v[124:127]
	ds_write_b64 v28, v[98:99] offset:1032
	v_mfma_f32_16x16x32_bf16 v[128:131], a[24:27], a[104:107], v[128:131]
	ds_write_b64 v28, v[100:101] offset:2048
	v_mfma_f32_16x16x32_bf16 v[112:115], a[28:31], a[120:123], v[112:115]
	ds_write_b64 v28, v[102:103] offset:2056
	v_mfma_f32_16x16x32_bf16 v[116:119], a[32:35], a[120:123], v[116:119]
	ds_write_b64 v28, v[104:105] offset:3072
	v_mfma_f32_16x16x32_bf16 v[120:123], a[36:39], a[120:123], v[120:123]
	ds_write_b64 v28, v[106:107] offset:3080
	v_mfma_f32_16x16x32_bf16 v[124:127], a[40:43], a[120:123], v[124:127]
	ds_write_b64 v28, v[108:109] offset:4096
	v_mfma_f32_16x16x32_bf16 v[128:131], a[44:47], a[120:123], v[128:131]
	ds_write_b64 v28, v[110:111] offset:4104
	v_mfma_f32_16x16x32_bf16 v[132:135], a[8:11], a[108:111], v[132:135]
	ds_write_b64 v29, v[112:113] offset:0
	v_mfma_f32_16x16x32_bf16 v[136:139], a[12:15], a[108:111], v[136:139]
	ds_write_b64 v29, v[114:115] offset:8
	v_mfma_f32_16x16x32_bf16 v[140:143], a[16:19], a[108:111], v[140:143]
	ds_write_b64 v29, v[116:117] offset:1024
	v_mfma_f32_16x16x32_bf16 v[144:147], a[20:23], a[108:111], v[144:147]
	ds_write_b64 v29, v[118:119] offset:1032
	v_mfma_f32_16x16x32_bf16 v[148:151], a[24:27], a[108:111], v[148:151]
	ds_write_b64 v29, v[120:121] offset:2048
	v_mfma_f32_16x16x32_bf16 v[132:135], a[28:31], a[124:127], v[132:135]
	ds_write_b64 v29, v[122:123] offset:2056
	v_mfma_f32_16x16x32_bf16 v[136:139], a[32:35], a[124:127], v[136:139]
	ds_write_b64 v29, v[124:125] offset:3072
	v_mfma_f32_16x16x32_bf16 v[140:143], a[36:39], a[124:127], v[140:143]
	ds_write_b64 v29, v[126:127] offset:3080
	v_mfma_f32_16x16x32_bf16 v[144:147], a[40:43], a[124:127], v[144:147]
	ds_write_b64 v29, v[128:129] offset:4096
	v_mfma_f32_16x16x32_bf16 v[148:151], a[44:47], a[124:127], v[148:151]
	ds_write_b64 v29, v[130:131] offset:4104
	v_mfma_f32_16x16x32_bf16 v[72:75], a[8:11], a[96:99], v[72:75]
	ds_write_b64 v30, v[132:133] offset:0
	v_mfma_f32_16x16x32_bf16 v[76:79], a[12:15], a[96:99], v[76:79]
	ds_write_b64 v30, v[134:135] offset:8
	v_mfma_f32_16x16x32_bf16 v[80:83], a[16:19], a[96:99], v[80:83]
	ds_write_b64 v30, v[136:137] offset:1024
	v_mfma_f32_16x16x32_bf16 v[84:87], a[20:23], a[96:99], v[84:87]
	ds_write_b64 v30, v[138:139] offset:1032
	v_mfma_f32_16x16x32_bf16 v[88:91], a[24:27], a[96:99], v[88:91]
	ds_write_b64 v30, v[140:141] offset:2048
	v_mfma_f32_16x16x32_bf16 v[72:75], a[28:31], a[112:115], v[72:75]
	ds_write_b64 v30, v[142:143] offset:2056
	v_mfma_f32_16x16x32_bf16 v[76:79], a[32:35], a[112:115], v[76:79]
	ds_write_b64 v30, v[144:145] offset:3072
	v_mfma_f32_16x16x32_bf16 v[80:83], a[36:39], a[112:115], v[80:83]
	ds_write_b64 v30, v[146:147] offset:3080
	v_mfma_f32_16x16x32_bf16 v[84:87], a[40:43], a[112:115], v[84:87]
	ds_write_b64 v30, v[148:149] offset:4096
	v_mfma_f32_16x16x32_bf16 v[88:91], a[44:47], a[112:115], v[88:91]
	ds_write_b64 v30, v[150:151] offset:4104
	s_waitcnt lgkmcnt(0)
	s_barrier
	ds_read_b128 v[92:95], v26 offset:0
	ds_read_b128 v[112:115], v26 offset:5120
	ds_read_b128 v[132:135], v26 offset:10240
	ds_read_b128 v[96:99], v26 offset:1024
	ds_read_b128 v[116:119], v26 offset:6144
	ds_read_b128 v[136:139], v26 offset:11264
	ds_read_b128 v[100:103], v26 offset:2048
	ds_read_b128 v[120:123], v26 offset:7168
	ds_read_b128 v[140:143], v26 offset:12288
	ds_read_b128 v[104:107], v26 offset:3072
	ds_read_b128 v[124:127], v26 offset:8192
	ds_read_b128 v[144:147], v26 offset:13312
	ds_read_b128 v[108:111], v26 offset:4096
	ds_read_b128 v[128:131], v26 offset:9216
	ds_read_b128 v[148:151], v26 offset:14336
	v_pk_add_f32 v[36:37], v[36:37], v[72:73]
	v_pk_add_f32 v[38:39], v[38:39], v[74:75]
	v_pk_add_f32 v[40:41], v[40:41], v[76:77]
	v_pk_add_f32 v[42:43], v[42:43], v[78:79]
	v_pk_add_f32 v[44:45], v[44:45], v[80:81]
	v_pk_add_f32 v[46:47], v[46:47], v[82:83]
	v_pk_add_f32 v[48:49], v[48:49], v[84:85]
	v_pk_add_f32 v[50:51], v[50:51], v[86:87]
	v_pk_add_f32 v[52:53], v[52:53], v[88:89]
	v_pk_add_f32 v[54:55], v[54:55], v[90:91]
	s_waitcnt lgkmcnt(12)
	v_pk_add_f32 v[92:93], v[92:93], v[112:113]
	v_pk_add_f32 v[36:37], v[36:37], v[132:133]
	v_pk_add_f32 v[94:95], v[94:95], v[114:115]
	v_pk_add_f32 v[38:39], v[38:39], v[134:135]
	v_pk_add_f32 v[36:37], v[36:37], v[92:93]
	v_pk_add_f32 v[38:39], v[38:39], v[94:95]
	v_cvt_pk_bf16_f32 v72, v36, v37
	v_cvt_pk_bf16_f32 v73, v38, v39
	s_waitcnt lgkmcnt(9)
	v_pk_add_f32 v[96:97], v[96:97], v[116:117]
	v_pk_add_f32 v[40:41], v[40:41], v[136:137]
	v_pk_add_f32 v[98:99], v[98:99], v[118:119]
	v_pk_add_f32 v[42:43], v[42:43], v[138:139]
	v_pk_add_f32 v[40:41], v[40:41], v[96:97]
	v_pk_add_f32 v[42:43], v[42:43], v[98:99]
	v_cvt_pk_bf16_f32 v74, v40, v41
	v_cvt_pk_bf16_f32 v75, v42, v43
	buffer_store_dwordx4 v[72:75], v12, s[12:15], 0 offen
	s_waitcnt lgkmcnt(6)
	v_pk_add_f32 v[100:101], v[100:101], v[120:121]
	v_pk_add_f32 v[44:45], v[44:45], v[140:141]
	v_pk_add_f32 v[102:103], v[102:103], v[122:123]
	v_pk_add_f32 v[46:47], v[46:47], v[142:143]
	v_pk_add_f32 v[44:45], v[44:45], v[100:101]
	v_pk_add_f32 v[46:47], v[46:47], v[102:103]
	v_cvt_pk_bf16_f32 v76, v44, v45
	v_cvt_pk_bf16_f32 v77, v46, v47
	s_waitcnt lgkmcnt(3)
	v_pk_add_f32 v[104:105], v[104:105], v[124:125]
	v_pk_add_f32 v[48:49], v[48:49], v[144:145]
	v_pk_add_f32 v[106:107], v[106:107], v[126:127]
	v_pk_add_f32 v[50:51], v[50:51], v[146:147]
	v_pk_add_f32 v[48:49], v[48:49], v[104:105]
	v_pk_add_f32 v[50:51], v[50:51], v[106:107]
	v_cvt_pk_bf16_f32 v78, v48, v49
	v_cvt_pk_bf16_f32 v79, v50, v51
	buffer_store_dwordx4 v[76:79], v12, s[12:15], 0 offen offset:64
	s_waitcnt lgkmcnt(0)
	v_pk_add_f32 v[108:109], v[108:109], v[128:129]
	v_pk_add_f32 v[52:53], v[52:53], v[148:149]
	v_pk_add_f32 v[110:111], v[110:111], v[130:131]
	v_pk_add_f32 v[54:55], v[54:55], v[150:151]
	v_pk_add_f32 v[52:53], v[52:53], v[108:109]
	v_pk_add_f32 v[54:55], v[54:55], v[110:111]
	v_cvt_pk_bf16_f32 v80, v52, v53
	v_cvt_pk_bf16_f32 v81, v54, v55
	buffer_store_dwordx2 v[80:81], v13, s[12:15], 0 offen
M_end:
	s_endpgm
xpoll_21:
	v_mov_b32 v252, 0
	s_mov_b32 s47, 0
xp_87:
	buffer_load_dwordx2 v[42:43], v252, s[8:11], s60 offen sc1
	s_add_u32 s47, s47, 1
	s_cmp_gt_u32 s47, 0x80000
	s_cbranch_scc1 xok_20
	s_waitcnt vmcnt(0)
	v_xor_b32 v253, s46, v43
	v_lshrrev_b32 v253, 4, v253
	v_xor_b32 v254, s90, v42
	v_or_b32 v253, v253, v254
	v_cmp_ne_u32 vcc, 0, v253
	s_cbranch_vccnz xp_87
	s_branch xok_20
pf1poll_24:
	s_mov_b32 s29, 0x2621000
	s_mov_b32 s47, 0
pfpoll_88:
	buffer_load_dwordx2 v[38:39], v37, s[8:11], s29 offen sc1
	s_add_u32 s47, s47, 1
	s_cmp_gt_u32 s47, 0x80000
	s_cbranch_scc1 pfx_89
	s_waitcnt vmcnt(0)
	v_xor_b32 v253, s46, v39
	v_lshrrev_b32 v253, 4, v253
	v_xor_b32 v254, s90, v38
	v_or_b32 v253, v253, v254
	v_cmp_ne_u32 vcc, 0, v253
	s_cbranch_vccnz pfpoll_88
pfx_89:
	s_waitcnt vmcnt(0)
	s_branch pf1ok_25
kvretry_27:
	v_and_b32 v253, 0xf0, v1
	v_mul_u32_u24 v253, 0xd8, v253
	s_lshl_b32 s29, s20, 10
	v_add_u32 v253, s29, v253
	s_add_u32 s29, s37, 0x2468000
kvlight_90:
	s_add_u32 s47, s47, 1
	s_cmp_gt_u32 s47, 0x80000
	s_cbranch_scc1 kvok_28
	s_sleep 2
	buffer_load_dword v254, v253, s[8:11], s29 offen sc1
	s_waitcnt vmcnt(0)
	v_cmp_eq_u32 vcc, -1, v254
	s_cbranch_vccnz kvlight_90
	s_add_u32 s29, s37, 0x2468000
	buffer_load_dwordx4 v[184:187], v19, s[8:11], s29 offen sc1
	s_add_u32 s29, s37, 0x2468d80
	buffer_load_dwordx4 v[188:191], v19, s[8:11], s29 offen sc1
	s_add_u32 s29, s37, 0x2469b00
	buffer_load_dwordx4 v[192:195], v19, s[8:11], s29 offen sc1
	s_add_u32 s29, s37, 0x246a880
	buffer_load_dwordx4 v[196:199], v19, s[8:11], s29 offen sc1
	s_add_u32 s29, s37, 0x246b600
	buffer_load_dwordx4 v[200:203], v19, s[8:11], s29 offen sc1
	s_add_u32 s29, s37, 0x246c380
	buffer_load_dwordx4 v[204:207], v19, s[8:11], s29 offen sc1
	s_add_u32 s29, s37, 0x246d100
	buffer_load_dwordx4 v[208:211], v19, s[8:11], s29 offen sc1
	s_add_u32 s29, s37, 0x246de80
	buffer_load_dwordx4 v[212:215], v19, s[8:11], s29 offen sc1
	s_add_u32 s29, s37, 0x246ec00
	buffer_load_dwordx4 v[216:219], v19, s[8:11], s29 offen sc1
	s_add_u32 s29, s37, 0x246f980
	buffer_load_dwordx4 v[220:223], v19, s[8:11], s29 offen sc1
	s_add_u32 s29, s37, 0x2470700
	buffer_load_dwordx4 v[224:227], v19, s[8:11], s29 offen sc1
	s_add_u32 s29, s37, 0x2471480
	buffer_load_dwordx4 v[228:231], v19, s[8:11], s29 offen sc1
	s_add_u32 s29, s37, 0x2472200
	buffer_load_dwordx4 v[232:235], v19, s[8:11], s29 offen sc1
	s_add_u32 s29, s37, 0x2472f80
	buffer_load_dwordx4 v[236:239], v19, s[8:11], s29 offen sc1
	s_add_u32 s29, s37, 0x2473d00
	buffer_load_dwordx4 v[240:243], v19, s[8:11], s29 offen sc1
	s_add_u32 s29, s37, 0x2474a80
	buffer_load_dwordx4 v[244:247], v19, s[8:11], s29 offen sc1
	s_waitcnt vmcnt(0)
	s_branch kvre_26
slow_29:
	buffer_wbl2 sc1
	s_waitcnt vmcnt(0)
	buffer_store_dword v254, v16, s[8:11], s29 offen sc1
	s_branch back_30
chkpoll_31:
	s_add_u32 s29, s38, 0x2618000
	s_mov_b32 s47, 0
poll_91:
	buffer_load_dword v255, v14, s[8:11], s29 offen sc1
	s_add_u32 s47, s47, 1
	s_cmp_gt_u32 s47, 0x80000
	s_cbranch_scc1 pollx_92
	s_waitcnt vmcnt(0)
	v_cmp_gt_u32 vcc, 1, v255
	s_cbranch_vccnz poll_91
pollx_92:
	s_waitcnt vmcnt(0)
	s_branch chkok_32
acq_33:
	buffer_inv sc1
	s_waitcnt vmcnt(0)
	s_branch acqb_34
slow_35:
	buffer_wbl2 sc1
	s_waitcnt vmcnt(0)
	buffer_store_dword v254, v16, s[8:11], s29 offen sc1
	s_branch back_36
chkpoll_37:
	s_add_u32 s29, s38, 0x2619000
	s_mov_b32 s47, 0
poll_93:
	buffer_load_dword v255, v15, s[8:11], s29 offen sc1
	s_add_u32 s47, s47, 1
	s_cmp_gt_u32 s47, 0x80000
	s_cbranch_scc1 pollx_94
	s_waitcnt vmcnt(0)
	v_cmp_gt_u32 vcc, 1, v255
	s_cbranch_vccnz poll_93
pollx_94:
	s_waitcnt vmcnt(0)
	s_branch chkok_38
acq_39:
	buffer_inv sc1
	s_waitcnt vmcnt(0)
	s_branch acqb_40
slow_41:
	buffer_wbl2 sc1
	s_waitcnt vmcnt(0)
	buffer_store_dword v254, v16, s[8:11], s29 offen sc1
	s_branch back_42
chkpoll_43:
	s_add_u32 s29, s38, 0x261a000
	s_mov_b32 s47, 0
poll_95:
	buffer_load_dword v255, v14, s[8:11], s29 offen sc1
	s_add_u32 s47, s47, 1
	s_cmp_gt_u32 s47, 0x80000
	s_cbranch_scc1 pollx_96
	s_waitcnt vmcnt(0)
	v_cmp_gt_u32 vcc, 2, v255
	s_cbranch_vccnz poll_95
pollx_96:
	s_waitcnt vmcnt(0)
	s_branch chkok_44
acq_45:
	buffer_inv sc1
	s_waitcnt vmcnt(0)
	s_branch acqb_46
slow_47:
	buffer_wbl2 sc1
	s_waitcnt vmcnt(0)
	buffer_store_dword v254, v16, s[8:11], s29 offen sc1
	s_branch back_48
chkpoll_49:
	s_add_u32 s29, s38, 0x261a000
	s_mov_b32 s47, 0
poll_97:
	buffer_load_dword v255, v14, s[8:11], s29 offen sc1
	s_add_u32 s47, s47, 1
	s_cmp_gt_u32 s47, 0x80000
	s_cbranch_scc1 pollx_98
	s_waitcnt vmcnt(0)
	v_cmp_gt_u32 vcc, 3, v255
	s_cbranch_vccnz poll_97
pollx_98:
	s_waitcnt vmcnt(0)
	s_branch chkok_50
acq_51:
	buffer_inv sc1
	s_waitcnt vmcnt(0)
	s_branch acqb_52
slow_53:
	buffer_wbl2 sc1
	s_waitcnt vmcnt(0)
	buffer_store_dword v254, v16, s[8:11], s29 offen sc1
	s_branch back_54
chkpoll_55:
	s_add_u32 s29, s38, 0x261f000
	s_mov_b32 s47, 0
poll_99:
	buffer_load_dword v255, v15, s[8:11], s29 offen sc1
	s_add_u32 s47, s47, 1
	s_cmp_gt_u32 s47, 0x80000
	s_cbranch_scc1 pollx_100
	s_waitcnt vmcnt(0)
	v_cmp_gt_u32 vcc, 1, v255
	s_cbranch_vccnz poll_99
pollx_100:
	s_waitcnt vmcnt(0)
	s_branch chkok_56
acq_57:
	buffer_inv sc1
	s_waitcnt vmcnt(0)
	s_branch acqb_58
kvretry_60:
	v_and_b32 v253, 0xf0, v1
	v_mul_u32_u24 v253, 0xd8, v253
	s_lshl_b32 s29, s20, 10
	v_add_u32 v253, s29, v253
	s_add_u32 s29, s37, 0x2540000
kvlight_101:
	s_add_u32 s47, s47, 1
	s_cmp_gt_u32 s47, 0x80000
	s_cbranch_scc1 kvok_61
	s_sleep 2
	buffer_load_dword v254, v253, s[8:11], s29 offen sc1
	s_waitcnt vmcnt(0)
	v_cmp_eq_u32 vcc, -1, v254
	s_cbranch_vccnz kvlight_101
	s_add_u32 s29, s37, 0x2540000
	buffer_load_dwordx4 v[184:187], v19, s[8:11], s29 offen sc1
	s_add_u32 s29, s37, 0x2540d80
	buffer_load_dwordx4 v[188:191], v19, s[8:11], s29 offen sc1
	s_add_u32 s29, s37, 0x2541b00
	buffer_load_dwordx4 v[192:195], v19, s[8:11], s29 offen sc1
	s_add_u32 s29, s37, 0x2542880
	buffer_load_dwordx4 v[196:199], v19, s[8:11], s29 offen sc1
	s_add_u32 s29, s37, 0x2543600
	buffer_load_dwordx4 v[200:203], v19, s[8:11], s29 offen sc1
	s_add_u32 s29, s37, 0x2544380
	buffer_load_dwordx4 v[204:207], v19, s[8:11], s29 offen sc1
	s_add_u32 s29, s37, 0x2545100
	buffer_load_dwordx4 v[208:211], v19, s[8:11], s29 offen sc1
	s_add_u32 s29, s37, 0x2545e80
	buffer_load_dwordx4 v[212:215], v19, s[8:11], s29 offen sc1
	s_add_u32 s29, s37, 0x2546c00
	buffer_load_dwordx4 v[216:219], v19, s[8:11], s29 offen sc1
	s_add_u32 s29, s37, 0x2547980
	buffer_load_dwordx4 v[220:223], v19, s[8:11], s29 offen sc1
	s_add_u32 s29, s37, 0x2548700
	buffer_load_dwordx4 v[224:227], v19, s[8:11], s29 offen sc1
	s_add_u32 s29, s37, 0x2549480
	buffer_load_dwordx4 v[228:231], v19, s[8:11], s29 offen sc1
	s_add_u32 s29, s37, 0x254a200
	buffer_load_dwordx4 v[232:235], v19, s[8:11], s29 offen sc1
	s_add_u32 s29, s37, 0x254af80
	buffer_load_dwordx4 v[236:239], v19, s[8:11], s29 offen sc1
	s_add_u32 s29, s37, 0x254bd00
	buffer_load_dwordx4 v[240:243], v19, s[8:11], s29 offen sc1
	s_add_u32 s29, s37, 0x254ca80
	buffer_load_dwordx4 v[244:247], v19, s[8:11], s29 offen sc1
	s_waitcnt vmcnt(0)
	s_branch kvre_59
slow_62:
	buffer_wbl2 sc1
	s_waitcnt vmcnt(0)
	buffer_store_dword v254, v16, s[8:11], s29 offen sc1
	s_branch back_63
chkpoll_64:
	s_add_u32 s29, s38, 0x261c000
	s_mov_b32 s47, 0
poll_102:
	buffer_load_dword v255, v14, s[8:11], s29 offen sc1
	s_add_u32 s47, s47, 1
	s_cmp_gt_u32 s47, 0x80000
	s_cbranch_scc1 pollx_103
	s_waitcnt vmcnt(0)
	v_cmp_gt_u32 vcc, 1, v255
	s_cbranch_vccnz poll_102
pollx_103:
	s_waitcnt vmcnt(0)
	s_branch chkok_65
acq_66:
	buffer_inv sc1
	s_waitcnt vmcnt(0)
	s_branch acqb_67
slow_68:
	buffer_wbl2 sc1
	s_waitcnt vmcnt(0)
	buffer_store_dword v254, v16, s[8:11], s29 offen sc1
	s_branch back_69
chkpoll_70:
	s_add_u32 s29, s38, 0x261d000
	s_mov_b32 s47, 0
poll_104:
	buffer_load_dword v255, v15, s[8:11], s29 offen sc1
	s_add_u32 s47, s47, 1
	s_cmp_gt_u32 s47, 0x80000
	s_cbranch_scc1 pollx_105
	s_waitcnt vmcnt(0)
	v_cmp_gt_u32 vcc, 1, v255
	s_cbranch_vccnz poll_104
pollx_105:
	s_waitcnt vmcnt(0)
	s_branch chkok_71
acq_72:
	buffer_inv sc1
	s_waitcnt vmcnt(0)
	s_branch acqb_73
slow_74:
	buffer_wbl2 sc1
	s_waitcnt vmcnt(0)
	buffer_store_dword v254, v16, s[8:11], s29 offen sc1
	s_branch back_75
chkpoll_76:
	s_add_u32 s29, s38, 0x261e000
	s_mov_b32 s47, 0
poll_106:
	buffer_load_dword v255, v14, s[8:11], s29 offen sc1
	s_add_u32 s47, s47, 1
	s_cmp_gt_u32 s47, 0x80000
	s_cbranch_scc1 pollx_107
	s_waitcnt vmcnt(0)
	v_cmp_gt_u32 vcc, 2, v255
	s_cbranch_vccnz poll_106
pollx_107:
	s_waitcnt vmcnt(0)
	s_branch chkok_77
acq_78:
	buffer_inv sc1
	s_waitcnt vmcnt(0)
	s_branch acqb_79
slow_80:
	buffer_wbl2 sc1
	s_waitcnt vmcnt(0)
	buffer_store_dword v254, v16, s[8:11], s29 offen sc1
	s_branch back_81
chkpoll_82:
	s_add_u32 s29, s38, 0x261e000
	s_mov_b32 s47, 0
poll_108:
	buffer_load_dword v255, v14, s[8:11], s29 offen sc1
	s_add_u32 s47, s47, 1
	s_cmp_gt_u32 s47, 0x80000
	s_cbranch_scc1 pollx_109
	s_waitcnt vmcnt(0)
	v_cmp_gt_u32 vcc, 3, v255
	s_cbranch_vccnz poll_108
pollx_109:
	s_waitcnt vmcnt(0)
	s_branch chkok_83
acq_84:
	buffer_inv sc1
	s_waitcnt vmcnt(0)
	s_branch acqb_85
M_codeend:
	s_endpgm
.section .rodata,"a"
.p2align 6
.amdhsa_kernel interleave_layers__linear_kernel_hedgehog__glu_gated_reglu__prompt_kernel
  .amdhsa_next_free_vgpr 512
  .amdhsa_next_free_sgpr 102
  .amdhsa_accum_offset 256
  .amdhsa_group_segment_fixed_size 0
  .amdhsa_kernarg_size 88
  .amdhsa_user_sgpr_count 2
  .amdhsa_user_sgpr_kernarg_segment_ptr 1
  .amdhsa_system_sgpr_workgroup_id_x 1
.end_amdhsa_kernel
```
